```python
import torch

def _softmax(x, axis=-1):
    return torch.softmax(x, dim=axis)
def _gelu(x):
    return torch.nn.functional.gelu(x, approximate="tanh")
def _silu(x):
    return torch.nn.functional.silu(x)
def _sigmoid(x):
    return torch.sigmoid(x)
def _layernorm(x, axis=-1, eps=1e-5):
    m = x.mean(dim=axis, keepdim=True)
    v = x.var(dim=axis, keepdim=True, unbiased=False)
    return (x - m) / torch.sqrt(v + eps)
def _scatter_add(tgt, idx, src, axis=0):
    return tgt.clone().index_add_(axis, idx, src)
def _segment_sum(src, seg, n):
    out = torch.zeros((n,) + src.shape[1:], dtype=src.dtype)
    return out.index_add_(0, seg, src)
def _pad(x, pw):
    flat = tuple(v for pair in reversed(pw) for v in pair)
    return torch.nn.functional.pad(x, flat)

kernel_name = 'sequential_preLN__compressed_kv_cla__dense_activation_squared_relu__prompt'

def setup_inputs():

    _w = (lambda a: (lambda t: t.to(torch.bfloat16) if t.is_floating_point() else t)(torch.as_tensor(a)))
    def _A_setup():
        B, H, Sq, Sk, D, M = 1, 32, 2048, 2048, 128, 576
        Dc = 4 * D
        return {
            "x": _w((lambda *s: torch.randn(*s, dtype=torch.bfloat16) * 0.05)(B, Sq, M)),
            "c_kv": _w((lambda *s: torch.randn(*s, dtype=torch.bfloat16) * 0.4)(B, Sk, Dc)),
            "w_q": _w((lambda *s: torch.randn(*s, dtype=torch.bfloat16) * 3.2)(M, H, D) * (M ** -0.5)),
            "w_uk": _w((lambda *s: torch.randn(*s, dtype=torch.bfloat16) * 3.2)(Dc, H, D) * (Dc ** -0.5)),
            "w_uv": _w((lambda *s: torch.randn(*s, dtype=torch.bfloat16) * 0.4)(Dc, H, D) * (Dc ** -0.5)),
            "w_o": _w((lambda *s: torch.randn(*s, dtype=torch.bfloat16) * 0.4)(H, D, M) * ((H * D) ** -0.5)),
        }
    _A_in = _A_setup()

    def _B_setup():
        B, S, D, F = 1, 2048, 576, 4608
        return {
            "x": _w((lambda *s: torch.randn(*s, dtype=torch.bfloat16) * 0.05)(B, S, D)),
            "w1": _w((lambda *s: torch.randn(*s, dtype=torch.bfloat16) * 0.05)(D, F)),
            "b1": _w((lambda *s: torch.randn(*s, dtype=torch.bfloat16) * 0.4)(F)),
            "w2": _w((lambda *s: torch.randn(*s, dtype=torch.bfloat16) * 0.05)(F, D)),
            "b2": _w((lambda *s: torch.randn(*s, dtype=torch.bfloat16) * 3.2)(D)),
        }
    _B_in = _B_setup()

    return {
        "A_x": _A_in["x"],
        "A_c_kv": _A_in["c_kv"],
        "A_w_q": _A_in["w_q"],
        "A_w_uk": _A_in["w_uk"],
        "A_w_uv": _A_in["w_uv"],
        "A_w_o": _A_in["w_o"],
        "B_x": _B_in["x"],
        "B_w1": _B_in["w1"],
        "B_b1": _B_in["b1"],
        "B_w2": _B_in["w2"],
        "B_b2": _B_in["b2"],
    }

def reference(A_x, A_c_kv, A_w_q, A_w_uk, A_w_uv, A_w_o, B_x, B_w1, B_b1, B_w2, B_b2):
    def _A_ref(x, c_kv, w_q, w_uk, w_uv, w_o):
        B, Sq, M = x.shape[0], x.shape[1], x.shape[2]
        Sk = c_kv.shape[1]
        H, D = w_q.shape[1], w_q.shape[2]
        q = torch.einsum("bqm,mhd->bhqd", x, w_q)
        k = torch.einsum("bkc,chd->bhkd", c_kv, w_uk)
        v = torch.einsum("bkc,chd->bhkd", c_kv, w_uv)
        scores = torch.einsum("bhqd,bhkd->bhqk", q, k) * (D ** -0.5)
        off = Sk - Sq
        qi = torch.arange(Sq)[:, None]
        kj = torch.arange(Sk)[None, :]
        cmask = kj <= (qi + off)
        scores = torch.where(cmask[None, None], scores, -1e9)
        p = _softmax(scores, axis=-1)
        ctx = torch.einsum("bhqk,bhkd->bhqd", p, v)
        return torch.einsum("bhqd,hdm->bqm", ctx, w_o)

    def _B_ref(x, w1, b1, w2, b2):
        h = torch.einsum("bsd,df->bsf", x, w1) + b1
        zero = torch.zeros_like(h)
        r = torch.where(h > zero, h, zero)
        h = r * r
        out = torch.einsum("bsf,fd->bsd", h, w2) + b2
        return out

    x = A_x
    h = x + _A_ref(_layernorm(x, axis=-1), A_c_kv, A_w_q, A_w_uk, A_w_uv, A_w_o)
    h2 = h + _B_ref(_layernorm(h, axis=-1), B_w1, B_b1, B_w2, B_b2)
    return h2
```

```asm
; @launch kernel=kvproj_kernel grid=(256,1,1) block=(512,1,1) lds=131072
; @launch kernel=attn_kernel grid=(256,1,1) block=(512,1,1) lds=163840
; @launch kernel=oproj_kernel grid=(256,1,1) block=(512,1,1) lds=139264
; @launch kernel=red1_kernel grid=(256,1,1) block=(512,1,1) lds=0
; @launch kernel=ffn1_kernel grid=(256,1,1) block=(512,1,1) lds=153600
; @launch kernel=ffn2_kernel grid=(256,1,1) block=(512,1,1) lds=139264
; @launch kernel=red2_kernel grid=(256,1,1) block=(512,1,1) lds=0
.amdgcn_target "amdgcn-amd-amdhsa--gfx950"
.text
.globl kvproj_kernel
.p2align 8
.type kvproj_kernel,@function
kvproj_kernel:
  s_cmp_ge_u32 s2, 256
  s_cbranch_scc1 kvproj_kernel_end
  v_and_b32 v1, 63, v0
  v_lshrrev_b32 v2, 6, v0
  s_nop 0
  v_readfirstlane_b32 s20, v2
  s_load_dwordx2 s[34:35], s[0:1], 8
  s_load_dwordx4 s[36:39], s[0:1], 24
  s_load_dwordx2 s[40:41], s[0:1], 104
  s_load_dwordx2 s[42:43], s[0:1], 0
  s_load_dwordx2 s[56:57], s[0:1], 16
  s_and_b32 s44, s2, 7
  s_lshr_b32 s45, s2, 3
  s_and_b32 s46, s45, 3
  s_lshl_b32 s44, s44, 2
  s_add_u32 s44, s44, s46
  s_lshr_b32 s45, s45, 2
  s_waitcnt lgkmcnt(0)
  s_mul_i32 s46, s45, 262144
  s_sub_u32 s47, 2097152, s46
  s_mov_b32 s4, s34
  s_mov_b32 s5, s35
  s_add_u32 s4, s4, s46
  s_addc_u32 s5, s5, 0
  s_mov_b32 s6, s47
  s_mov_b32 s7, 0x00020000
  s_cmp_lt_u32 s44, 16
  s_cselect_b32 s36, s36, s38
  s_cselect_b32 s37, s37, s39
  s_cselect_b32 s27, 0, 1
  s_cselect_b32 s26, 0, 0x1000000
  s_add_u32 s26, s26, 0x240000
  s_and_b32 s44, s44, 15
  s_lshl_b32 s46, s44, 9
  s_sub_u32 s47, 4194304, s46
  s_mov_b32 s8, s36
  s_mov_b32 s9, s37
  s_add_u32 s8, s8, s46
  s_addc_u32 s9, s9, 0
  s_mov_b32 s10, s47
  s_mov_b32 s11, 0x00020000
  s_mul_i32 s47, s45, 2097152
  s_add_u32 s46, s46, s47
  s_lshl_b32 s47, s44, 20
  s_lshl_b32 s48, s45, 9
  s_add_u32 s47, s47, s48
  s_cmp_eq_u32 s27, 0
  s_cselect_b32 s46, s46, s47
  s_sub_u32 s47, 16777216, s46
  s_add_u32 s46, s46, s26
  s_mov_b32 s12, s40
  s_mov_b32 s13, s41
  s_add_u32 s12, s12, s46
  s_addc_u32 s13, s13, 0
  s_mov_b32 s14, s47
  s_mov_b32 s15, 0x00020000
  s_lshl_b32 s21, s20, 10
  s_and_b32 s22, s20, 3
  s_lshr_b32 s23, s20, 2
  s_and_b32 s24, s23, 1
  s_lshr_b32 s25, s23, 1
  s_and_b32 s28, s20, 1
  s_lshl_b32 s28, s28, 2
  v_lshrrev_b32 v2, 4, v1
  v_add_u32 v2, s28, v2
  v_xor_b32 v2, v2, v1
  v_and_b32 v2, 7, v2
  v_lshlrev_b32 v2, 4, v2
  v_lshrrev_b32 v3, 3, v1
  s_lshl_b32 s28, s20, 3
  v_add_u32 v3, s28, v3
  s_mov_b32 s28, 1024
  v_mul_lo_u32 v3, v3, s28
  v_add_u32 v5, v3, v2
  v_add_u32 v6, 0x10000, v5
  v_add_u32 v7, 0x20000, v5
  v_add_u32 v8, 0x30000, v5
  s_mov_b32 s29, 8192
  v_lshrrev_b32 v3, 5, v1
  s_lshl_b32 s28, s20, 1
  v_add_u32 v3, s28, v3
  v_and_b32 v2, 3, v3
  v_lshrrev_b32 v4, 3, v3
  v_lshl_or_b32 v2, v4, 2, v2
  v_lshlrev_b32 v2, 1, v2
  v_xor_b32 v2, v2, v1
  v_and_b32 v2, 31, v2
  v_lshlrev_b32 v2, 4, v2
  v_mul_lo_u32 v3, v3, s29
  v_add_u32 v9, v3, v2
  v_add_u32 v10, 0x20000, v9
  v_add_u32 v11, 0x40000, v9
  v_add_u32 v12, 0x60000, v9
  s_mov_b32 s30, 0
  s_mov_b32 s31, 0
  v_lshrrev_b32 v13, 4, v1
  v_and_b32 v2, 15, v1
  v_lshrrev_b32 v3, 1, v2
  v_xor_b32 v3, v3, v13
  v_lshlrev_b32 v3, 4, v3
  s_mul_i32 s28, s24, 16384
  v_lshl_add_u32 v3, v2, 7, v3
  v_add_u32 v14, s28, v3
  v_xor_b32 v15, 64, v14
  v_bfe_u32 v2, v1, 2, 2
  v_and_b32 v3, 3, v1
  v_lshlrev_b32 v3, 3, v3
  v_lshl_add_u32 v4, v13, 3, v2
  v_lshl_add_u32 v3, v4, 9, v3
  v_and_b32 v4, 1, v13
  v_lshl_or_b32 v4, v4, 2, v2
  s_lshl_b32 s28, s22, 2
  v_xor_b32 v4, s28, v4
  v_xor_b32 v2, 0, v4
  v_lshl_add_u32 v2, v2, 5, v3
  v_add_u32 v16, 0x10000, v2
  v_xor_b32 v2, 1, v4
  v_lshl_add_u32 v2, v2, 5, v3
  v_add_u32 v17, 0x10000, v2
  v_xor_b32 v2, 2, v4
  v_lshl_add_u32 v2, v2, 5, v3
  v_add_u32 v18, 0x10000, v2
  v_xor_b32 v2, 3, v4
  v_lshl_add_u32 v2, v2, 5, v3
  v_add_u32 v19, 0x10000, v2
  s_lshl_b32 s44, s2, 3
  s_add_u32 s44, s44, s20
  s_mul_i32 s44, s44, 1152
  s_mov_b32 s16, s42
  s_mov_b32 s17, s43
  s_add_u32 s16, s16, s44
  s_addc_u32 s17, s17, 0
  s_mov_b32 s18, 0x480
  s_mov_b32 s19, 0x00020000
  v_and_b32 v20, 63, v0
  v_lshlrev_b32 v20, 3, v20
  v_cmp_gt_u32 vcc, 384, v20
  s_mov_b64 s[46:47], vcc
  s_mov_b64 exec, vcc
  buffer_load_dwordx2 v[22:23], v20, s[16:19], 0 offen offset:0
  buffer_load_dwordx2 v[24:25], v20, s[16:19], 0 offen offset:384
  buffer_load_dwordx2 v[26:27], v20, s[16:19], 0 offen offset:768
  s_mov_b64 exec, -1
  s_add_u32 m0, s21, 0x0
  s_nop 0
  buffer_load_dwordx4 v5, s[4:7], s30 offen lds
  s_add_u32 m0, s21, 0x2000
  s_nop 0
  buffer_load_dwordx4 v6, s[4:7], s30 offen lds
  s_add_u32 m0, s21, 0x4000
  s_nop 0
  buffer_load_dwordx4 v7, s[4:7], s30 offen lds
  s_add_u32 m0, s21, 0x6000
  s_nop 0
  buffer_load_dwordx4 v8, s[4:7], s30 offen lds
  s_add_u32 s30, s30, 128
  s_add_u32 m0, s21, 0x10000
  s_nop 0
  buffer_load_dwordx4 v9, s[8:11], s31 offen lds
  s_add_u32 m0, s21, 0x12000
  s_nop 0
  buffer_load_dwordx4 v10, s[8:11], s31 offen lds
  s_add_u32 m0, s21, 0x14000
  s_nop 0
  buffer_load_dwordx4 v11, s[8:11], s31 offen lds
  s_add_u32 m0, s21, 0x16000
  s_nop 0
  buffer_load_dwordx4 v12, s[8:11], s31 offen lds
  s_add_u32 s31, s31, 0x80000
  s_add_u32 m0, s21, 0x8000
  s_nop 0
  buffer_load_dwordx4 v5, s[4:7], s30 offen lds
  s_add_u32 m0, s21, 0xa000
  s_nop 0
  buffer_load_dwordx4 v6, s[4:7], s30 offen lds
  s_add_u32 m0, s21, 0xc000
  s_nop 0
  buffer_load_dwordx4 v7, s[4:7], s30 offen lds
  s_add_u32 m0, s21, 0xe000
  s_nop 0
  buffer_load_dwordx4 v8, s[4:7], s30 offen lds
  s_add_u32 s30, s30, 128
  s_add_u32 m0, s21, 0x18000
  s_nop 0
  buffer_load_dwordx4 v9, s[8:11], s31 offen lds
  s_add_u32 m0, s21, 0x1a000
  s_nop 0
  buffer_load_dwordx4 v10, s[8:11], s31 offen lds
  s_add_u32 m0, s21, 0x1c000
  s_nop 0
  buffer_load_dwordx4 v11, s[8:11], s31 offen lds
  s_add_u32 m0, s21, 0x1e000
  s_nop 0
  buffer_load_dwordx4 v12, s[8:11], s31 offen lds
  s_add_u32 s31, s31, 0x80000
  s_waitcnt vmcnt(16)
  s_mov_b64 exec, s[46:47]
  v_lshlrev_b32 v28, 16, v22
  v_and_b32 v29, 0xffff0000, v22
  v_lshlrev_b32 v30, 16, v23
  v_and_b32 v31, 0xffff0000, v23
  v_lshlrev_b32 v32, 16, v24
  v_and_b32 v33, 0xffff0000, v24
  v_lshlrev_b32 v34, 16, v25
  v_and_b32 v35, 0xffff0000, v25
  v_lshlrev_b32 v36, 16, v26
  v_and_b32 v37, 0xffff0000, v26
  v_lshlrev_b32 v38, 16, v27
  v_and_b32 v39, 0xffff0000, v27
  s_mov_b64 exec, -1
  v_mov_b32 v40, 0
  s_mov_b64 exec, s[46:47]
  v_add_f32 v40, v40, v28
  v_add_f32 v40, v40, v29
  v_add_f32 v40, v40, v30
  v_add_f32 v40, v40, v31
  v_add_f32 v40, v40, v32
  v_add_f32 v40, v40, v33
  v_add_f32 v40, v40, v34
  v_add_f32 v40, v40, v35
  v_add_f32 v40, v40, v36
  v_add_f32 v40, v40, v37
  v_add_f32 v40, v40, v38
  v_add_f32 v40, v40, v39
  s_mov_b64 exec, -1
  s_nop 1
  v_add_f32_dpp v40, v40, v40 quad_perm:[1,0,3,2] row_mask:0xf bank_mask:0xf
  s_nop 1
  v_add_f32_dpp v40, v40, v40 quad_perm:[2,3,0,1] row_mask:0xf bank_mask:0xf
  s_nop 1
  v_add_f32_dpp v40, v40, v40 row_half_mirror row_mask:0xf bank_mask:0xf
  s_nop 1
  v_add_f32_dpp v40, v40, v40 row_mirror row_mask:0xf bank_mask:0xf
  v_mov_b32 v41, v40
  s_nop 1
  v_permlane16_swap_b32 v40, v41
  s_nop 1
  v_add_f32 v40, v40, v41
  v_mov_b32 v41, v40
  s_nop 1
  v_permlane32_swap_b32 v40, v41
  s_nop 1
  v_add_f32 v40, v40, v41
  v_mul_f32 v42, 0x3ae38e39, v40
  v_mov_b32 v40, 0
  s_mov_b64 exec, s[46:47]
  v_sub_f32 v43, v28, v42
  v_fmac_f32 v40, v43, v43
  v_sub_f32 v43, v29, v42
  v_fmac_f32 v40, v43, v43
  v_sub_f32 v43, v30, v42
  v_fmac_f32 v40, v43, v43
  v_sub_f32 v43, v31, v42
  v_fmac_f32 v40, v43, v43
  v_sub_f32 v43, v32, v42
  v_fmac_f32 v40, v43, v43
  v_sub_f32 v43, v33, v42
  v_fmac_f32 v40, v43, v43
  v_sub_f32 v43, v34, v42
  v_fmac_f32 v40, v43, v43
  v_sub_f32 v43, v35, v42
  v_fmac_f32 v40, v43, v43
  v_sub_f32 v43, v36, v42
  v_fmac_f32 v40, v43, v43
  v_sub_f32 v43, v37, v42
  v_fmac_f32 v40, v43, v43
  v_sub_f32 v43, v38, v42
  v_fmac_f32 v40, v43, v43
  v_sub_f32 v43, v39, v42
  v_fmac_f32 v40, v43, v43
  s_mov_b64 exec, -1
  s_nop 1
  v_add_f32_dpp v40, v40, v40 quad_perm:[1,0,3,2] row_mask:0xf bank_mask:0xf
  s_nop 1
  v_add_f32_dpp v40, v40, v40 quad_perm:[2,3,0,1] row_mask:0xf bank_mask:0xf
  s_nop 1
  v_add_f32_dpp v40, v40, v40 row_half_mirror row_mask:0xf bank_mask:0xf
  s_nop 1
  v_add_f32_dpp v40, v40, v40 row_mirror row_mask:0xf bank_mask:0xf
  v_mov_b32 v41, v40
  s_nop 1
  v_permlane16_swap_b32 v40, v41
  s_nop 1
  v_add_f32 v40, v40, v41
  v_mov_b32 v41, v40
  s_nop 1
  v_permlane32_swap_b32 v40, v41
  s_nop 1
  v_add_f32 v40, v40, v41
  v_mul_f32 v40, 0x3ae38e39, v40
  v_cvt_pk_bf16_f32 v40, v40, v40
  v_and_b32 v40, 0xffff0000, v40
  v_cvt_pk_bf16_f32 v42, v42, v42
  v_and_b32 v42, 0xffff0000, v42
  v_add_f32 v40, 0x3727c5ac, v40
  v_cvt_pk_bf16_f32 v40, v40, v40
  v_and_b32 v40, 0xffff0000, v40
  v_sqrt_f32 v40, v40
  s_nop 0
  v_cvt_pk_bf16_f32 v40, v40, v40
  v_and_b32 v40, 0xffff0000, v40
  v_rcp_f32 v40, v40
  s_mov_b64 exec, s[46:47]
  v_sub_f32 v28, v28, v42
  v_cvt_pk_bf16_f32 v28, v28, v28
  v_and_b32 v28, 0xffff0000, v28
  v_mul_f32 v28, v28, v40
  v_sub_f32 v29, v29, v42
  v_cvt_pk_bf16_f32 v29, v29, v29
  v_and_b32 v29, 0xffff0000, v29
  v_mul_f32 v29, v29, v40
  v_sub_f32 v30, v30, v42
  v_cvt_pk_bf16_f32 v30, v30, v30
  v_and_b32 v30, 0xffff0000, v30
  v_mul_f32 v30, v30, v40
  v_sub_f32 v31, v31, v42
  v_cvt_pk_bf16_f32 v31, v31, v31
  v_and_b32 v31, 0xffff0000, v31
  v_mul_f32 v31, v31, v40
  v_sub_f32 v32, v32, v42
  v_cvt_pk_bf16_f32 v32, v32, v32
  v_and_b32 v32, 0xffff0000, v32
  v_mul_f32 v32, v32, v40
  v_sub_f32 v33, v33, v42
  v_cvt_pk_bf16_f32 v33, v33, v33
  v_and_b32 v33, 0xffff0000, v33
  v_mul_f32 v33, v33, v40
  v_sub_f32 v34, v34, v42
  v_cvt_pk_bf16_f32 v34, v34, v34
  v_and_b32 v34, 0xffff0000, v34
  v_mul_f32 v34, v34, v40
  v_sub_f32 v35, v35, v42
  v_cvt_pk_bf16_f32 v35, v35, v35
  v_and_b32 v35, 0xffff0000, v35
  v_mul_f32 v35, v35, v40
  v_sub_f32 v36, v36, v42
  v_cvt_pk_bf16_f32 v36, v36, v36
  v_and_b32 v36, 0xffff0000, v36
  v_mul_f32 v36, v36, v40
  v_sub_f32 v37, v37, v42
  v_cvt_pk_bf16_f32 v37, v37, v37
  v_and_b32 v37, 0xffff0000, v37
  v_mul_f32 v37, v37, v40
  v_sub_f32 v38, v38, v42
  v_cvt_pk_bf16_f32 v38, v38, v38
  v_and_b32 v38, 0xffff0000, v38
  v_mul_f32 v38, v38, v40
  v_sub_f32 v39, v39, v42
  v_cvt_pk_bf16_f32 v39, v39, v39
  v_and_b32 v39, 0xffff0000, v39
  v_mul_f32 v39, v39, v40
  v_cvt_pk_bf16_f32 v22, v28, v29
  v_cvt_pk_bf16_f32 v23, v30, v31
  v_cvt_pk_bf16_f32 v24, v32, v33
  v_cvt_pk_bf16_f32 v25, v34, v35
  v_cvt_pk_bf16_f32 v26, v36, v37
  v_cvt_pk_bf16_f32 v27, v38, v39
  s_mov_b32 s16, s40
  s_mov_b32 s17, s41
  s_add_u32 s16, s16, s44
  s_addc_u32 s17, s17, 0
  s_mov_b32 s18, 0x480
  s_mov_b32 s19, 0x00020000
  buffer_store_dwordx2 v[22:23], v20, s[16:19], 0 offen offset:0 sc1
  buffer_store_dwordx2 v[24:25], v20, s[16:19], 0 offen offset:384 sc1
  buffer_store_dwordx2 v[26:27], v20, s[16:19], 0 offen offset:768 sc1
  s_mov_b64 exec, -1
  s_cmp_eq_u32 s27, 0
  s_cbranch_scc0 kvproj_kernel_alt1
  s_waitcnt vmcnt(11)
  s_barrier
  s_lshl_b32 s44, s2, 3
  s_add_u32 s44, s44, s20
  s_mul_i32 s44, s44, 3072
  v_and_b32 v20, 63, v0
  v_lshlrev_b32 v20, 4, v20
  s_mov_b32 s16, s56
  s_mov_b32 s17, s57
  s_mov_b32 s18, 0x480000
  s_mov_b32 s19, 0x00020000
  buffer_load_dwordx4 v[204:207], v20, s[16:19], s44 offen offset:0
  buffer_load_dwordx4 v[204:207], v20, s[16:19], s44 offen offset:1024
  buffer_load_dwordx4 v[204:207], v20, s[16:19], s44 offen offset:2048
  ds_read_b64_tr_b16 v[172:173], v16 offset:0
  ds_read_b64_tr_b16 v[174:175], v16 offset:2048
  ds_read_b128 v[156:159], v14 offset:0
  ds_read_b64_tr_b16 v[176:177], v17 offset:0
  ds_read_b64_tr_b16 v[178:179], v17 offset:2048
  ds_read_b64_tr_b16 v[180:181], v18 offset:0
  ds_read_b64_tr_b16 v[182:183], v18 offset:2048
  ds_read_b64_tr_b16 v[184:185], v19 offset:0
  ds_read_b64_tr_b16 v[186:187], v19 offset:2048
  ds_read_b128 v[160:163], v14 offset:2048
  ds_read_b128 v[164:167], v14 offset:4096
  s_waitcnt lgkmcnt(8)
  v_mfma_f32_16x16x32_bf16 v[28:31], v[172:175], v[156:159], 0
  ds_read_b64_tr_b16 v[188:189], v16 offset:16384
  ds_read_b64_tr_b16 v[190:191], v16 offset:18432
  s_waitcnt lgkmcnt(8)
  v_mfma_f32_16x16x32_bf16 v[32:35], v[176:179], v[156:159], 0
  s_waitcnt lgkmcnt(6)
  v_mfma_f32_16x16x32_bf16 v[36:39], v[180:183], v[156:159], 0
  s_waitcnt lgkmcnt(4)
  v_mfma_f32_16x16x32_bf16 v[40:43], v[184:187], v[156:159], 0
  ds_read_b128 v[168:171], v14 offset:6144
  s_waitcnt lgkmcnt(4)
  v_mfma_f32_16x16x32_bf16 v[44:47], v[172:175], v[160:163], 0
  v_mfma_f32_16x16x32_bf16 v[48:51], v[176:179], v[160:163], 0
  v_mfma_f32_16x16x32_bf16 v[52:55], v[180:183], v[160:163], 0
  v_mfma_f32_16x16x32_bf16 v[56:59], v[184:187], v[160:163], 0
  ds_read_b128 v[156:159], v14 offset:8192
  ds_read_b64_tr_b16 v[192:193], v17 offset:16384
  ds_read_b64_tr_b16 v[194:195], v17 offset:18432
  s_waitcnt lgkmcnt(6)
  v_mfma_f32_16x16x32_bf16 v[60:63], v[172:175], v[164:167], 0
  v_mfma_f32_16x16x32_bf16 v[64:67], v[176:179], v[164:167], 0
  v_mfma_f32_16x16x32_bf16 v[68:71], v[180:183], v[164:167], 0
  v_mfma_f32_16x16x32_bf16 v[72:75], v[184:187], v[164:167], 0
  ds_read_b128 v[160:163], v14 offset:10240
  s_waitcnt lgkmcnt(4)
  v_mfma_f32_16x16x32_bf16 v[76:79], v[172:175], v[168:171], 0
  v_mfma_f32_16x16x32_bf16 v[80:83], v[176:179], v[168:171], 0
  v_mfma_f32_16x16x32_bf16 v[84:87], v[180:183], v[168:171], 0
  ds_read_b64_tr_b16 v[196:197], v18 offset:16384
  ds_read_b64_tr_b16 v[198:199], v18 offset:18432
  v_mfma_f32_16x16x32_bf16 v[88:91], v[184:187], v[168:171], 0
  ds_read_b128 v[164:167], v14 offset:12288
  s_waitcnt lgkmcnt(6)
  v_mfma_f32_16x16x32_bf16 v[92:95], v[172:175], v[156:159], 0
  v_mfma_f32_16x16x32_bf16 v[96:99], v[176:179], v[156:159], 0
  v_mfma_f32_16x16x32_bf16 v[100:103], v[180:183], v[156:159], 0
  v_mfma_f32_16x16x32_bf16 v[104:107], v[184:187], v[156:159], 0
  ds_read_b128 v[168:171], v14 offset:14336
  s_waitcnt lgkmcnt(4)
  v_mfma_f32_16x16x32_bf16 v[108:111], v[172:175], v[160:163], 0
  v_mfma_f32_16x16x32_bf16 v[112:115], v[176:179], v[160:163], 0
  ds_read_b64_tr_b16 v[200:201], v19 offset:16384
  ds_read_b64_tr_b16 v[202:203], v19 offset:18432
  v_mfma_f32_16x16x32_bf16 v[116:119], v[180:183], v[160:163], 0
  v_mfma_f32_16x16x32_bf16 v[120:123], v[184:187], v[160:163], 0
  ds_read_b128 v[156:159], v15 offset:0
  s_waitcnt lgkmcnt(4)
  v_mfma_f32_16x16x32_bf16 v[124:127], v[172:175], v[164:167], 0
  v_mfma_f32_16x16x32_bf16 v[128:131], v[176:179], v[164:167], 0
  v_mfma_f32_16x16x32_bf16 v[132:135], v[180:183], v[164:167], 0
  v_mfma_f32_16x16x32_bf16 v[136:139], v[184:187], v[164:167], 0
  ds_read_b128 v[160:163], v15 offset:2048
  s_waitcnt lgkmcnt(4)
  v_mfma_f32_16x16x32_bf16 v[140:143], v[172:175], v[168:171], 0
  v_mfma_f32_16x16x32_bf16 v[144:147], v[176:179], v[168:171], 0
  v_mfma_f32_16x16x32_bf16 v[148:151], v[180:183], v[168:171], 0
  v_mfma_f32_16x16x32_bf16 v[152:155], v[184:187], v[168:171], 0
  ds_read_b128 v[164:167], v15 offset:4096
  s_waitcnt lgkmcnt(2)
  v_mfma_f32_16x16x32_bf16 v[28:31], v[188:191], v[156:159], v[28:31]
  v_mfma_f32_16x16x32_bf16 v[32:35], v[192:195], v[156:159], v[32:35]
  v_mfma_f32_16x16x32_bf16 v[36:39], v[196:199], v[156:159], v[36:39]
  v_mfma_f32_16x16x32_bf16 v[40:43], v[200:203], v[156:159], v[40:43]
  ds_read_b128 v[168:171], v15 offset:6144
  s_waitcnt lgkmcnt(2)
  v_mfma_f32_16x16x32_bf16 v[44:47], v[188:191], v[160:163], v[44:47]
  v_mfma_f32_16x16x32_bf16 v[48:51], v[192:195], v[160:163], v[48:51]
  v_mfma_f32_16x16x32_bf16 v[52:55], v[196:199], v[160:163], v[52:55]
  v_mfma_f32_16x16x32_bf16 v[56:59], v[200:203], v[160:163], v[56:59]
  ds_read_b128 v[156:159], v15 offset:8192
  s_waitcnt lgkmcnt(2)
  v_mfma_f32_16x16x32_bf16 v[60:63], v[188:191], v[164:167], v[60:63]
  v_mfma_f32_16x16x32_bf16 v[64:67], v[192:195], v[164:167], v[64:67]
  v_mfma_f32_16x16x32_bf16 v[68:71], v[196:199], v[164:167], v[68:71]
  v_mfma_f32_16x16x32_bf16 v[72:75], v[200:203], v[164:167], v[72:75]
  ds_read_b128 v[160:163], v15 offset:10240
  s_waitcnt lgkmcnt(2)
  v_mfma_f32_16x16x32_bf16 v[76:79], v[188:191], v[168:171], v[76:79]
  v_mfma_f32_16x16x32_bf16 v[80:83], v[192:195], v[168:171], v[80:83]
  v_mfma_f32_16x16x32_bf16 v[84:87], v[196:199], v[168:171], v[84:87]
  v_mfma_f32_16x16x32_bf16 v[88:91], v[200:203], v[168:171], v[88:91]
  ds_read_b128 v[164:167], v15 offset:12288
  s_waitcnt lgkmcnt(2)
  v_mfma_f32_16x16x32_bf16 v[92:95], v[188:191], v[156:159], v[92:95]
  v_mfma_f32_16x16x32_bf16 v[96:99], v[192:195], v[156:159], v[96:99]
  v_mfma_f32_16x16x32_bf16 v[100:103], v[196:199], v[156:159], v[100:103]
  v_mfma_f32_16x16x32_bf16 v[104:107], v[200:203], v[156:159], v[104:107]
  ds_read_b128 v[168:171], v15 offset:14336
  s_waitcnt lgkmcnt(2)
  v_mfma_f32_16x16x32_bf16 v[108:111], v[188:191], v[160:163], v[108:111]
  v_mfma_f32_16x16x32_bf16 v[112:115], v[192:195], v[160:163], v[112:115]
  v_mfma_f32_16x16x32_bf16 v[116:119], v[196:199], v[160:163], v[116:119]
  v_mfma_f32_16x16x32_bf16 v[120:123], v[200:203], v[160:163], v[120:123]
  s_waitcnt vmcnt(3) lgkmcnt(0)
  s_barrier
  v_add_u32 v14, 0x8000, v14
  v_add_u32 v15, 0x8000, v15
  v_add_u32 v16, 0x8000, v16
  v_add_u32 v17, 0x8000, v17
  v_add_u32 v18, 0x8000, v18
  v_add_u32 v19, 0x8000, v19
  ds_read_b64_tr_b16 v[172:173], v16 offset:0
  ds_read_b64_tr_b16 v[174:175], v16 offset:2048
  ds_read_b128 v[156:159], v14 offset:0
  ds_read_b64_tr_b16 v[176:177], v17 offset:0
  ds_read_b64_tr_b16 v[178:179], v17 offset:2048
  ds_read_b64_tr_b16 v[180:181], v18 offset:0
  ds_read_b64_tr_b16 v[182:183], v18 offset:2048
  ds_read_b64_tr_b16 v[184:185], v19 offset:0
  ds_read_b64_tr_b16 v[186:187], v19 offset:2048
  v_mfma_f32_16x16x32_bf16 v[124:127], v[188:191], v[164:167], v[124:127]
  s_add_u32 m0, s21, 0x0
  s_nop 0
  buffer_load_dwordx4 v5, s[4:7], s30 offen lds
  v_mfma_f32_16x16x32_bf16 v[128:131], v[192:195], v[164:167], v[128:131]
  s_add_u32 m0, s21, 0x2000
  s_nop 0
  buffer_load_dwordx4 v6, s[4:7], s30 offen lds
  v_mfma_f32_16x16x32_bf16 v[132:135], v[196:199], v[164:167], v[132:135]
  s_add_u32 m0, s21, 0x4000
  s_nop 0
  buffer_load_dwordx4 v7, s[4:7], s30 offen lds
  v_mfma_f32_16x16x32_bf16 v[136:139], v[200:203], v[164:167], v[136:139]
  s_add_u32 m0, s21, 0x6000
  s_nop 0
  buffer_load_dwordx4 v8, s[4:7], s30 offen lds
  s_add_u32 s30, s30, 128
  ds_read_b128 v[160:163], v14 offset:2048
  v_mfma_f32_16x16x32_bf16 v[140:143], v[188:191], v[168:171], v[140:143]
  s_add_u32 m0, s21, 0x10000
  s_nop 0
  buffer_load_dwordx4 v9, s[8:11], s31 offen lds
  v_mfma_f32_16x16x32_bf16 v[144:147], v[192:195], v[168:171], v[144:147]
  s_add_u32 m0, s21, 0x12000
  s_nop 0
  buffer_load_dwordx4 v10, s[8:11], s31 offen lds
  v_mfma_f32_16x16x32_bf16 v[148:151], v[196:199], v[168:171], v[148:151]
  s_add_u32 m0, s21, 0x14000
  s_nop 0
  buffer_load_dwordx4 v11, s[8:11], s31 offen lds
  v_mfma_f32_16x16x32_bf16 v[152:155], v[200:203], v[168:171], v[152:155]
  s_add_u32 m0, s21, 0x16000
  s_nop 0
  buffer_load_dwordx4 v12, s[8:11], s31 offen lds
  s_add_u32 s31, s31, 0x80000
  ds_read_b128 v[164:167], v14 offset:4096
  s_waitcnt lgkmcnt(8)
  v_mfma_f32_16x16x32_bf16 v[28:31], v[172:175], v[156:159], v[28:31]
  ds_read_b64_tr_b16 v[188:189], v16 offset:16384
  ds_read_b64_tr_b16 v[190:191], v16 offset:18432
  s_waitcnt lgkmcnt(8)
  v_mfma_f32_16x16x32_bf16 v[32:35], v[176:179], v[156:159], v[32:35]
  s_waitcnt lgkmcnt(6)
  v_mfma_f32_16x16x32_bf16 v[36:39], v[180:183], v[156:159], v[36:39]
  s_waitcnt lgkmcnt(4)
  v_mfma_f32_16x16x32_bf16 v[40:43], v[184:187], v[156:159], v[40:43]
  ds_read_b128 v[168:171], v14 offset:6144
  s_waitcnt lgkmcnt(4)
  v_mfma_f32_16x16x32_bf16 v[44:47], v[172:175], v[160:163], v[44:47]
  v_mfma_f32_16x16x32_bf16 v[48:51], v[176:179], v[160:163], v[48:51]
  v_mfma_f32_16x16x32_bf16 v[52:55], v[180:183], v[160:163], v[52:55]
  v_mfma_f32_16x16x32_bf16 v[56:59], v[184:187], v[160:163], v[56:59]
  ds_read_b128 v[156:159], v14 offset:8192
  ds_read_b64_tr_b16 v[192:193], v17 offset:16384
  ds_read_b64_tr_b16 v[194:195], v17 offset:18432
  s_waitcnt lgkmcnt(6)
  v_mfma_f32_16x16x32_bf16 v[60:63], v[172:175], v[164:167], v[60:63]
  v_mfma_f32_16x16x32_bf16 v[64:67], v[176:179], v[164:167], v[64:67]
  v_mfma_f32_16x16x32_bf16 v[68:71], v[180:183], v[164:167], v[68:71]
  v_mfma_f32_16x16x32_bf16 v[72:75], v[184:187], v[164:167], v[72:75]
  ds_read_b128 v[160:163], v14 offset:10240
  s_waitcnt lgkmcnt(4)
  v_mfma_f32_16x16x32_bf16 v[76:79], v[172:175], v[168:171], v[76:79]
  v_mfma_f32_16x16x32_bf16 v[80:83], v[176:179], v[168:171], v[80:83]
  v_mfma_f32_16x16x32_bf16 v[84:87], v[180:183], v[168:171], v[84:87]
  ds_read_b64_tr_b16 v[196:197], v18 offset:16384
  ds_read_b64_tr_b16 v[198:199], v18 offset:18432
  v_mfma_f32_16x16x32_bf16 v[88:91], v[184:187], v[168:171], v[88:91]
  ds_read_b128 v[164:167], v14 offset:12288
  s_waitcnt lgkmcnt(6)
  v_mfma_f32_16x16x32_bf16 v[92:95], v[172:175], v[156:159], v[92:95]
  v_mfma_f32_16x16x32_bf16 v[96:99], v[176:179], v[156:159], v[96:99]
  v_mfma_f32_16x16x32_bf16 v[100:103], v[180:183], v[156:159], v[100:103]
  v_mfma_f32_16x16x32_bf16 v[104:107], v[184:187], v[156:159], v[104:107]
  ds_read_b128 v[168:171], v14 offset:14336
  s_waitcnt lgkmcnt(4)
  v_mfma_f32_16x16x32_bf16 v[108:111], v[172:175], v[160:163], v[108:111]
  v_mfma_f32_16x16x32_bf16 v[112:115], v[176:179], v[160:163], v[112:115]
  ds_read_b64_tr_b16 v[200:201], v19 offset:16384
  ds_read_b64_tr_b16 v[202:203], v19 offset:18432
  v_mfma_f32_16x16x32_bf16 v[116:119], v[180:183], v[160:163], v[116:119]
  v_mfma_f32_16x16x32_bf16 v[120:123], v[184:187], v[160:163], v[120:123]
  ds_read_b128 v[156:159], v15 offset:0
  s_waitcnt lgkmcnt(4)
  v_mfma_f32_16x16x32_bf16 v[124:127], v[172:175], v[164:167], v[124:127]
  v_mfma_f32_16x16x32_bf16 v[128:131], v[176:179], v[164:167], v[128:131]
  v_mfma_f32_16x16x32_bf16 v[132:135], v[180:183], v[164:167], v[132:135]
  v_mfma_f32_16x16x32_bf16 v[136:139], v[184:187], v[164:167], v[136:139]
  ds_read_b128 v[160:163], v15 offset:2048
  s_waitcnt lgkmcnt(4)
  v_mfma_f32_16x16x32_bf16 v[140:143], v[172:175], v[168:171], v[140:143]
  v_mfma_f32_16x16x32_bf16 v[144:147], v[176:179], v[168:171], v[144:147]
  v_mfma_f32_16x16x32_bf16 v[148:151], v[180:183], v[168:171], v[148:151]
  v_mfma_f32_16x16x32_bf16 v[152:155], v[184:187], v[168:171], v[152:155]
  ds_read_b128 v[164:167], v15 offset:4096
  s_waitcnt lgkmcnt(2)
  v_mfma_f32_16x16x32_bf16 v[28:31], v[188:191], v[156:159], v[28:31]
  v_mfma_f32_16x16x32_bf16 v[32:35], v[192:195], v[156:159], v[32:35]
  v_mfma_f32_16x16x32_bf16 v[36:39], v[196:199], v[156:159], v[36:39]
  v_mfma_f32_16x16x32_bf16 v[40:43], v[200:203], v[156:159], v[40:43]
  ds_read_b128 v[168:171], v15 offset:6144
  s_waitcnt lgkmcnt(2)
  v_mfma_f32_16x16x32_bf16 v[44:47], v[188:191], v[160:163], v[44:47]
  v_mfma_f32_16x16x32_bf16 v[48:51], v[192:195], v[160:163], v[48:51]
  v_mfma_f32_16x16x32_bf16 v[52:55], v[196:199], v[160:163], v[52:55]
  v_mfma_f32_16x16x32_bf16 v[56:59], v[200:203], v[160:163], v[56:59]
  ds_read_b128 v[156:159], v15 offset:8192
  s_waitcnt lgkmcnt(2)
  v_mfma_f32_16x16x32_bf16 v[60:63], v[188:191], v[164:167], v[60:63]
  v_mfma_f32_16x16x32_bf16 v[64:67], v[192:195], v[164:167], v[64:67]
  v_mfma_f32_16x16x32_bf16 v[68:71], v[196:199], v[164:167], v[68:71]
  v_mfma_f32_16x16x32_bf16 v[72:75], v[200:203], v[164:167], v[72:75]
  ds_read_b128 v[160:163], v15 offset:10240
  s_waitcnt lgkmcnt(2)
  v_mfma_f32_16x16x32_bf16 v[76:79], v[188:191], v[168:171], v[76:79]
  v_mfma_f32_16x16x32_bf16 v[80:83], v[192:195], v[168:171], v[80:83]
  v_mfma_f32_16x16x32_bf16 v[84:87], v[196:199], v[168:171], v[84:87]
  v_mfma_f32_16x16x32_bf16 v[88:91], v[200:203], v[168:171], v[88:91]
  ds_read_b128 v[164:167], v15 offset:12288
  s_waitcnt lgkmcnt(2)
  v_mfma_f32_16x16x32_bf16 v[92:95], v[188:191], v[156:159], v[92:95]
  v_mfma_f32_16x16x32_bf16 v[96:99], v[192:195], v[156:159], v[96:99]
  v_mfma_f32_16x16x32_bf16 v[100:103], v[196:199], v[156:159], v[100:103]
  v_mfma_f32_16x16x32_bf16 v[104:107], v[200:203], v[156:159], v[104:107]
  ds_read_b128 v[168:171], v15 offset:14336
  s_waitcnt lgkmcnt(2)
  v_mfma_f32_16x16x32_bf16 v[108:111], v[188:191], v[160:163], v[108:111]
  v_mfma_f32_16x16x32_bf16 v[112:115], v[192:195], v[160:163], v[112:115]
  v_mfma_f32_16x16x32_bf16 v[116:119], v[196:199], v[160:163], v[116:119]
  v_mfma_f32_16x16x32_bf16 v[120:123], v[200:203], v[160:163], v[120:123]
  s_mov_b32 s33, 2
kvproj_kernel_loop2:
  s_waitcnt vmcnt(0) lgkmcnt(0)
  s_barrier
  v_subrev_u32 v14, 0x8000, v14
  v_subrev_u32 v15, 0x8000, v15
  v_subrev_u32 v16, 0x8000, v16
  v_subrev_u32 v17, 0x8000, v17
  v_subrev_u32 v18, 0x8000, v18
  v_subrev_u32 v19, 0x8000, v19
  ds_read_b64_tr_b16 v[172:173], v16 offset:0
  ds_read_b64_tr_b16 v[174:175], v16 offset:2048
  ds_read_b128 v[156:159], v14 offset:0
  ds_read_b64_tr_b16 v[176:177], v17 offset:0
  ds_read_b64_tr_b16 v[178:179], v17 offset:2048
  ds_read_b64_tr_b16 v[180:181], v18 offset:0
  ds_read_b64_tr_b16 v[182:183], v18 offset:2048
  ds_read_b64_tr_b16 v[184:185], v19 offset:0
  ds_read_b64_tr_b16 v[186:187], v19 offset:2048
  v_mfma_f32_16x16x32_bf16 v[124:127], v[188:191], v[164:167], v[124:127]
  s_add_u32 m0, s21, 0x8000
  s_nop 0
  buffer_load_dwordx4 v5, s[4:7], s30 offen lds
  v_mfma_f32_16x16x32_bf16 v[128:131], v[192:195], v[164:167], v[128:131]
  s_add_u32 m0, s21, 0xa000
  s_nop 0
  buffer_load_dwordx4 v6, s[4:7], s30 offen lds
  v_mfma_f32_16x16x32_bf16 v[132:135], v[196:199], v[164:167], v[132:135]
  s_add_u32 m0, s21, 0xc000
  s_nop 0
  buffer_load_dwordx4 v7, s[4:7], s30 offen lds
  v_mfma_f32_16x16x32_bf16 v[136:139], v[200:203], v[164:167], v[136:139]
  s_add_u32 m0, s21, 0xe000
  s_nop 0
  buffer_load_dwordx4 v8, s[4:7], s30 offen lds
  s_add_u32 s30, s30, 128
  ds_read_b128 v[160:163], v14 offset:2048
  v_mfma_f32_16x16x32_bf16 v[140:143], v[188:191], v[168:171], v[140:143]
  s_add_u32 m0, s21, 0x18000
  s_nop 0
  buffer_load_dwordx4 v9, s[8:11], s31 offen lds
  v_mfma_f32_16x16x32_bf16 v[144:147], v[192:195], v[168:171], v[144:147]
  s_add_u32 m0, s21, 0x1a000
  s_nop 0
  buffer_load_dwordx4 v10, s[8:11], s31 offen lds
  v_mfma_f32_16x16x32_bf16 v[148:151], v[196:199], v[168:171], v[148:151]
  s_add_u32 m0, s21, 0x1c000
  s_nop 0
  buffer_load_dwordx4 v11, s[8:11], s31 offen lds
  v_mfma_f32_16x16x32_bf16 v[152:155], v[200:203], v[168:171], v[152:155]
  s_add_u32 m0, s21, 0x1e000
  s_nop 0
  buffer_load_dwordx4 v12, s[8:11], s31 offen lds
  s_add_u32 s31, s31, 0x80000
  ds_read_b128 v[164:167], v14 offset:4096
  s_waitcnt lgkmcnt(8)
  v_mfma_f32_16x16x32_bf16 v[28:31], v[172:175], v[156:159], v[28:31]
  ds_read_b64_tr_b16 v[188:189], v16 offset:16384
  ds_read_b64_tr_b16 v[190:191], v16 offset:18432
  s_waitcnt lgkmcnt(8)
  v_mfma_f32_16x16x32_bf16 v[32:35], v[176:179], v[156:159], v[32:35]
  s_waitcnt lgkmcnt(6)
  v_mfma_f32_16x16x32_bf16 v[36:39], v[180:183], v[156:159], v[36:39]
  s_waitcnt lgkmcnt(4)
  v_mfma_f32_16x16x32_bf16 v[40:43], v[184:187], v[156:159], v[40:43]
  ds_read_b128 v[168:171], v14 offset:6144
  s_waitcnt lgkmcnt(4)
  v_mfma_f32_16x16x32_bf16 v[44:47], v[172:175], v[160:163], v[44:47]
  v_mfma_f32_16x16x32_bf16 v[48:51], v[176:179], v[160:163], v[48:51]
  v_mfma_f32_16x16x32_bf16 v[52:55], v[180:183], v[160:163], v[52:55]
  v_mfma_f32_16x16x32_bf16 v[56:59], v[184:187], v[160:163], v[56:59]
  ds_read_b128 v[156:159], v14 offset:8192
  ds_read_b64_tr_b16 v[192:193], v17 offset:16384
  ds_read_b64_tr_b16 v[194:195], v17 offset:18432
  s_waitcnt lgkmcnt(6)
  v_mfma_f32_16x16x32_bf16 v[60:63], v[172:175], v[164:167], v[60:63]
  v_mfma_f32_16x16x32_bf16 v[64:67], v[176:179], v[164:167], v[64:67]
  v_mfma_f32_16x16x32_bf16 v[68:71], v[180:183], v[164:167], v[68:71]
  v_mfma_f32_16x16x32_bf16 v[72:75], v[184:187], v[164:167], v[72:75]
  ds_read_b128 v[160:163], v14 offset:10240
  s_waitcnt lgkmcnt(4)
  v_mfma_f32_16x16x32_bf16 v[76:79], v[172:175], v[168:171], v[76:79]
  v_mfma_f32_16x16x32_bf16 v[80:83], v[176:179], v[168:171], v[80:83]
  v_mfma_f32_16x16x32_bf16 v[84:87], v[180:183], v[168:171], v[84:87]
  ds_read_b64_tr_b16 v[196:197], v18 offset:16384
  ds_read_b64_tr_b16 v[198:199], v18 offset:18432
  v_mfma_f32_16x16x32_bf16 v[88:91], v[184:187], v[168:171], v[88:91]
  ds_read_b128 v[164:167], v14 offset:12288
  s_waitcnt lgkmcnt(6)
  v_mfma_f32_16x16x32_bf16 v[92:95], v[172:175], v[156:159], v[92:95]
  v_mfma_f32_16x16x32_bf16 v[96:99], v[176:179], v[156:159], v[96:99]
  v_mfma_f32_16x16x32_bf16 v[100:103], v[180:183], v[156:159], v[100:103]
  v_mfma_f32_16x16x32_bf16 v[104:107], v[184:187], v[156:159], v[104:107]
  ds_read_b128 v[168:171], v14 offset:14336
  s_waitcnt lgkmcnt(4)
  v_mfma_f32_16x16x32_bf16 v[108:111], v[172:175], v[160:163], v[108:111]
  v_mfma_f32_16x16x32_bf16 v[112:115], v[176:179], v[160:163], v[112:115]
  ds_read_b64_tr_b16 v[200:201], v19 offset:16384
  ds_read_b64_tr_b16 v[202:203], v19 offset:18432
  v_mfma_f32_16x16x32_bf16 v[116:119], v[180:183], v[160:163], v[116:119]
  v_mfma_f32_16x16x32_bf16 v[120:123], v[184:187], v[160:163], v[120:123]
  ds_read_b128 v[156:159], v15 offset:0
  s_waitcnt lgkmcnt(4)
  v_mfma_f32_16x16x32_bf16 v[124:127], v[172:175], v[164:167], v[124:127]
  v_mfma_f32_16x16x32_bf16 v[128:131], v[176:179], v[164:167], v[128:131]
  v_mfma_f32_16x16x32_bf16 v[132:135], v[180:183], v[164:167], v[132:135]
  v_mfma_f32_16x16x32_bf16 v[136:139], v[184:187], v[164:167], v[136:139]
  ds_read_b128 v[160:163], v15 offset:2048
  s_waitcnt lgkmcnt(4)
  v_mfma_f32_16x16x32_bf16 v[140:143], v[172:175], v[168:171], v[140:143]
  v_mfma_f32_16x16x32_bf16 v[144:147], v[176:179], v[168:171], v[144:147]
  v_mfma_f32_16x16x32_bf16 v[148:151], v[180:183], v[168:171], v[148:151]
  v_mfma_f32_16x16x32_bf16 v[152:155], v[184:187], v[168:171], v[152:155]
  ds_read_b128 v[164:167], v15 offset:4096
  s_waitcnt lgkmcnt(2)
  v_mfma_f32_16x16x32_bf16 v[28:31], v[188:191], v[156:159], v[28:31]
  v_mfma_f32_16x16x32_bf16 v[32:35], v[192:195], v[156:159], v[32:35]
  v_mfma_f32_16x16x32_bf16 v[36:39], v[196:199], v[156:159], v[36:39]
  v_mfma_f32_16x16x32_bf16 v[40:43], v[200:203], v[156:159], v[40:43]
  ds_read_b128 v[168:171], v15 offset:6144
  s_waitcnt lgkmcnt(2)
  v_mfma_f32_16x16x32_bf16 v[44:47], v[188:191], v[160:163], v[44:47]
  v_mfma_f32_16x16x32_bf16 v[48:51], v[192:195], v[160:163], v[48:51]
  v_mfma_f32_16x16x32_bf16 v[52:55], v[196:199], v[160:163], v[52:55]
  v_mfma_f32_16x16x32_bf16 v[56:59], v[200:203], v[160:163], v[56:59]
  ds_read_b128 v[156:159], v15 offset:8192
  s_waitcnt lgkmcnt(2)
  v_mfma_f32_16x16x32_bf16 v[60:63], v[188:191], v[164:167], v[60:63]
  v_mfma_f32_16x16x32_bf16 v[64:67], v[192:195], v[164:167], v[64:67]
  v_mfma_f32_16x16x32_bf16 v[68:71], v[196:199], v[164:167], v[68:71]
  v_mfma_f32_16x16x32_bf16 v[72:75], v[200:203], v[164:167], v[72:75]
  ds_read_b128 v[160:163], v15 offset:10240
  s_waitcnt lgkmcnt(2)
  v_mfma_f32_16x16x32_bf16 v[76:79], v[188:191], v[168:171], v[76:79]
  v_mfma_f32_16x16x32_bf16 v[80:83], v[192:195], v[168:171], v[80:83]
  v_mfma_f32_16x16x32_bf16 v[84:87], v[196:199], v[168:171], v[84:87]
  v_mfma_f32_16x16x32_bf16 v[88:91], v[200:203], v[168:171], v[88:91]
  ds_read_b128 v[164:167], v15 offset:12288
  s_waitcnt lgkmcnt(2)
  v_mfma_f32_16x16x32_bf16 v[92:95], v[188:191], v[156:159], v[92:95]
  v_mfma_f32_16x16x32_bf16 v[96:99], v[192:195], v[156:159], v[96:99]
  v_mfma_f32_16x16x32_bf16 v[100:103], v[196:199], v[156:159], v[100:103]
  v_mfma_f32_16x16x32_bf16 v[104:107], v[200:203], v[156:159], v[104:107]
  ds_read_b128 v[168:171], v15 offset:14336
  s_waitcnt lgkmcnt(2)
  v_mfma_f32_16x16x32_bf16 v[108:111], v[188:191], v[160:163], v[108:111]
  v_mfma_f32_16x16x32_bf16 v[112:115], v[192:195], v[160:163], v[112:115]
  v_mfma_f32_16x16x32_bf16 v[116:119], v[196:199], v[160:163], v[116:119]
  v_mfma_f32_16x16x32_bf16 v[120:123], v[200:203], v[160:163], v[120:123]
  s_waitcnt vmcnt(0) lgkmcnt(0)
  s_barrier
  v_add_u32 v14, 0x8000, v14
  v_add_u32 v15, 0x8000, v15
  v_add_u32 v16, 0x8000, v16
  v_add_u32 v17, 0x8000, v17
  v_add_u32 v18, 0x8000, v18
  v_add_u32 v19, 0x8000, v19
  ds_read_b64_tr_b16 v[172:173], v16 offset:0
  ds_read_b64_tr_b16 v[174:175], v16 offset:2048
  ds_read_b128 v[156:159], v14 offset:0
  ds_read_b64_tr_b16 v[176:177], v17 offset:0
  ds_read_b64_tr_b16 v[178:179], v17 offset:2048
  ds_read_b64_tr_b16 v[180:181], v18 offset:0
  ds_read_b64_tr_b16 v[182:183], v18 offset:2048
  ds_read_b64_tr_b16 v[184:185], v19 offset:0
  ds_read_b64_tr_b16 v[186:187], v19 offset:2048
  v_mfma_f32_16x16x32_bf16 v[124:127], v[188:191], v[164:167], v[124:127]
  s_add_u32 m0, s21, 0x0
  s_nop 0
  buffer_load_dwordx4 v5, s[4:7], s30 offen lds
  v_mfma_f32_16x16x32_bf16 v[128:131], v[192:195], v[164:167], v[128:131]
  s_add_u32 m0, s21, 0x2000
  s_nop 0
  buffer_load_dwordx4 v6, s[4:7], s30 offen lds
  v_mfma_f32_16x16x32_bf16 v[132:135], v[196:199], v[164:167], v[132:135]
  s_add_u32 m0, s21, 0x4000
  s_nop 0
  buffer_load_dwordx4 v7, s[4:7], s30 offen lds
  v_mfma_f32_16x16x32_bf16 v[136:139], v[200:203], v[164:167], v[136:139]
  s_add_u32 m0, s21, 0x6000
  s_nop 0
  buffer_load_dwordx4 v8, s[4:7], s30 offen lds
  s_add_u32 s30, s30, 128
  ds_read_b128 v[160:163], v14 offset:2048
  v_mfma_f32_16x16x32_bf16 v[140:143], v[188:191], v[168:171], v[140:143]
  s_add_u32 m0, s21, 0x10000
  s_nop 0
  buffer_load_dwordx4 v9, s[8:11], s31 offen lds
  v_mfma_f32_16x16x32_bf16 v[144:147], v[192:195], v[168:171], v[144:147]
  s_add_u32 m0, s21, 0x12000
  s_nop 0
  buffer_load_dwordx4 v10, s[8:11], s31 offen lds
  v_mfma_f32_16x16x32_bf16 v[148:151], v[196:199], v[168:171], v[148:151]
  s_add_u32 m0, s21, 0x14000
  s_nop 0
  buffer_load_dwordx4 v11, s[8:11], s31 offen lds
  v_mfma_f32_16x16x32_bf16 v[152:155], v[200:203], v[168:171], v[152:155]
  s_add_u32 m0, s21, 0x16000
  s_nop 0
  buffer_load_dwordx4 v12, s[8:11], s31 offen lds
  s_add_u32 s31, s31, 0x80000
  ds_read_b128 v[164:167], v14 offset:4096
  s_waitcnt lgkmcnt(8)
  v_mfma_f32_16x16x32_bf16 v[28:31], v[172:175], v[156:159], v[28:31]
  ds_read_b64_tr_b16 v[188:189], v16 offset:16384
  ds_read_b64_tr_b16 v[190:191], v16 offset:18432
  s_waitcnt lgkmcnt(8)
  v_mfma_f32_16x16x32_bf16 v[32:35], v[176:179], v[156:159], v[32:35]
  s_waitcnt lgkmcnt(6)
  v_mfma_f32_16x16x32_bf16 v[36:39], v[180:183], v[156:159], v[36:39]
  s_waitcnt lgkmcnt(4)
  v_mfma_f32_16x16x32_bf16 v[40:43], v[184:187], v[156:159], v[40:43]
  ds_read_b128 v[168:171], v14 offset:6144
  s_waitcnt lgkmcnt(4)
  v_mfma_f32_16x16x32_bf16 v[44:47], v[172:175], v[160:163], v[44:47]
  v_mfma_f32_16x16x32_bf16 v[48:51], v[176:179], v[160:163], v[48:51]
  v_mfma_f32_16x16x32_bf16 v[52:55], v[180:183], v[160:163], v[52:55]
  v_mfma_f32_16x16x32_bf16 v[56:59], v[184:187], v[160:163], v[56:59]
  ds_read_b128 v[156:159], v14 offset:8192
  ds_read_b64_tr_b16 v[192:193], v17 offset:16384
  ds_read_b64_tr_b16 v[194:195], v17 offset:18432
  s_waitcnt lgkmcnt(6)
  v_mfma_f32_16x16x32_bf16 v[60:63], v[172:175], v[164:167], v[60:63]
  v_mfma_f32_16x16x32_bf16 v[64:67], v[176:179], v[164:167], v[64:67]
  v_mfma_f32_16x16x32_bf16 v[68:71], v[180:183], v[164:167], v[68:71]
  v_mfma_f32_16x16x32_bf16 v[72:75], v[184:187], v[164:167], v[72:75]
  ds_read_b128 v[160:163], v14 offset:10240
  s_waitcnt lgkmcnt(4)
  v_mfma_f32_16x16x32_bf16 v[76:79], v[172:175], v[168:171], v[76:79]
  v_mfma_f32_16x16x32_bf16 v[80:83], v[176:179], v[168:171], v[80:83]
  v_mfma_f32_16x16x32_bf16 v[84:87], v[180:183], v[168:171], v[84:87]
  ds_read_b64_tr_b16 v[196:197], v18 offset:16384
  ds_read_b64_tr_b16 v[198:199], v18 offset:18432
  v_mfma_f32_16x16x32_bf16 v[88:91], v[184:187], v[168:171], v[88:91]
  ds_read_b128 v[164:167], v14 offset:12288
  s_waitcnt lgkmcnt(6)
  v_mfma_f32_16x16x32_bf16 v[92:95], v[172:175], v[156:159], v[92:95]
  v_mfma_f32_16x16x32_bf16 v[96:99], v[176:179], v[156:159], v[96:99]
  v_mfma_f32_16x16x32_bf16 v[100:103], v[180:183], v[156:159], v[100:103]
  v_mfma_f32_16x16x32_bf16 v[104:107], v[184:187], v[156:159], v[104:107]
  ds_read_b128 v[168:171], v14 offset:14336
  s_waitcnt lgkmcnt(4)
  v_mfma_f32_16x16x32_bf16 v[108:111], v[172:175], v[160:163], v[108:111]
  v_mfma_f32_16x16x32_bf16 v[112:115], v[176:179], v[160:163], v[112:115]
  ds_read_b64_tr_b16 v[200:201], v19 offset:16384
  ds_read_b64_tr_b16 v[202:203], v19 offset:18432
  v_mfma_f32_16x16x32_bf16 v[116:119], v[180:183], v[160:163], v[116:119]
  v_mfma_f32_16x16x32_bf16 v[120:123], v[184:187], v[160:163], v[120:123]
  ds_read_b128 v[156:159], v15 offset:0
  s_waitcnt lgkmcnt(4)
  v_mfma_f32_16x16x32_bf16 v[124:127], v[172:175], v[164:167], v[124:127]
  v_mfma_f32_16x16x32_bf16 v[128:131], v[176:179], v[164:167], v[128:131]
  v_mfma_f32_16x16x32_bf16 v[132:135], v[180:183], v[164:167], v[132:135]
  v_mfma_f32_16x16x32_bf16 v[136:139], v[184:187], v[164:167], v[136:139]
  ds_read_b128 v[160:163], v15 offset:2048
  s_waitcnt lgkmcnt(4)
  v_mfma_f32_16x16x32_bf16 v[140:143], v[172:175], v[168:171], v[140:143]
  v_mfma_f32_16x16x32_bf16 v[144:147], v[176:179], v[168:171], v[144:147]
  v_mfma_f32_16x16x32_bf16 v[148:151], v[180:183], v[168:171], v[148:151]
  v_mfma_f32_16x16x32_bf16 v[152:155], v[184:187], v[168:171], v[152:155]
  ds_read_b128 v[164:167], v15 offset:4096
  s_waitcnt lgkmcnt(2)
  v_mfma_f32_16x16x32_bf16 v[28:31], v[188:191], v[156:159], v[28:31]
  v_mfma_f32_16x16x32_bf16 v[32:35], v[192:195], v[156:159], v[32:35]
  v_mfma_f32_16x16x32_bf16 v[36:39], v[196:199], v[156:159], v[36:39]
  v_mfma_f32_16x16x32_bf16 v[40:43], v[200:203], v[156:159], v[40:43]
  ds_read_b128 v[168:171], v15 offset:6144
  s_waitcnt lgkmcnt(2)
  v_mfma_f32_16x16x32_bf16 v[44:47], v[188:191], v[160:163], v[44:47]
  v_mfma_f32_16x16x32_bf16 v[48:51], v[192:195], v[160:163], v[48:51]
  v_mfma_f32_16x16x32_bf16 v[52:55], v[196:199], v[160:163], v[52:55]
  v_mfma_f32_16x16x32_bf16 v[56:59], v[200:203], v[160:163], v[56:59]
  ds_read_b128 v[156:159], v15 offset:8192
  s_waitcnt lgkmcnt(2)
  v_mfma_f32_16x16x32_bf16 v[60:63], v[188:191], v[164:167], v[60:63]
  v_mfma_f32_16x16x32_bf16 v[64:67], v[192:195], v[164:167], v[64:67]
  v_mfma_f32_16x16x32_bf16 v[68:71], v[196:199], v[164:167], v[68:71]
  v_mfma_f32_16x16x32_bf16 v[72:75], v[200:203], v[164:167], v[72:75]
  ds_read_b128 v[160:163], v15 offset:10240
  s_waitcnt lgkmcnt(2)
  v_mfma_f32_16x16x32_bf16 v[76:79], v[188:191], v[168:171], v[76:79]
  v_mfma_f32_16x16x32_bf16 v[80:83], v[192:195], v[168:171], v[80:83]
  v_mfma_f32_16x16x32_bf16 v[84:87], v[196:199], v[168:171], v[84:87]
  v_mfma_f32_16x16x32_bf16 v[88:91], v[200:203], v[168:171], v[88:91]
  ds_read_b128 v[164:167], v15 offset:12288
  s_waitcnt lgkmcnt(2)
  v_mfma_f32_16x16x32_bf16 v[92:95], v[188:191], v[156:159], v[92:95]
  v_mfma_f32_16x16x32_bf16 v[96:99], v[192:195], v[156:159], v[96:99]
  v_mfma_f32_16x16x32_bf16 v[100:103], v[196:199], v[156:159], v[100:103]
  v_mfma_f32_16x16x32_bf16 v[104:107], v[200:203], v[156:159], v[104:107]
  ds_read_b128 v[168:171], v15 offset:14336
  s_waitcnt lgkmcnt(2)
  v_mfma_f32_16x16x32_bf16 v[108:111], v[188:191], v[160:163], v[108:111]
  v_mfma_f32_16x16x32_bf16 v[112:115], v[192:195], v[160:163], v[112:115]
  v_mfma_f32_16x16x32_bf16 v[116:119], v[196:199], v[160:163], v[116:119]
  v_mfma_f32_16x16x32_bf16 v[120:123], v[200:203], v[160:163], v[120:123]
  s_sub_u32 s33, s33, 1
  s_cmp_lg_u32 s33, 0
  s_cbranch_scc1 kvproj_kernel_loop2
  s_waitcnt vmcnt(0) lgkmcnt(0)
  s_barrier
  v_subrev_u32 v14, 0x8000, v14
  v_subrev_u32 v15, 0x8000, v15
  v_subrev_u32 v16, 0x8000, v16
  v_subrev_u32 v17, 0x8000, v17
  v_subrev_u32 v18, 0x8000, v18
  v_subrev_u32 v19, 0x8000, v19
  ds_read_b64_tr_b16 v[172:173], v16 offset:0
  ds_read_b64_tr_b16 v[174:175], v16 offset:2048
  ds_read_b128 v[156:159], v14 offset:0
  ds_read_b64_tr_b16 v[176:177], v17 offset:0
  ds_read_b64_tr_b16 v[178:179], v17 offset:2048
  ds_read_b64_tr_b16 v[180:181], v18 offset:0
  ds_read_b64_tr_b16 v[182:183], v18 offset:2048
  ds_read_b64_tr_b16 v[184:185], v19 offset:0
  ds_read_b64_tr_b16 v[186:187], v19 offset:2048
  v_mfma_f32_16x16x32_bf16 v[124:127], v[188:191], v[164:167], v[124:127]
  s_add_u32 m0, s21, 0x8000
  s_nop 0
  buffer_load_dwordx4 v5, s[4:7], s30 offen lds
  v_mfma_f32_16x16x32_bf16 v[128:131], v[192:195], v[164:167], v[128:131]
  s_add_u32 m0, s21, 0xa000
  s_nop 0
  buffer_load_dwordx4 v6, s[4:7], s30 offen lds
  v_mfma_f32_16x16x32_bf16 v[132:135], v[196:199], v[164:167], v[132:135]
  s_add_u32 m0, s21, 0xc000
  s_nop 0
  buffer_load_dwordx4 v7, s[4:7], s30 offen lds
  v_mfma_f32_16x16x32_bf16 v[136:139], v[200:203], v[164:167], v[136:139]
  s_add_u32 m0, s21, 0xe000
  s_nop 0
  buffer_load_dwordx4 v8, s[4:7], s30 offen lds
  s_add_u32 s30, s30, 128
  ds_read_b128 v[160:163], v14 offset:2048
  v_mfma_f32_16x16x32_bf16 v[140:143], v[188:191], v[168:171], v[140:143]
  s_add_u32 m0, s21, 0x18000
  s_nop 0
  buffer_load_dwordx4 v9, s[8:11], s31 offen lds
  v_mfma_f32_16x16x32_bf16 v[144:147], v[192:195], v[168:171], v[144:147]
  s_add_u32 m0, s21, 0x1a000
  s_nop 0
  buffer_load_dwordx4 v10, s[8:11], s31 offen lds
  v_mfma_f32_16x16x32_bf16 v[148:151], v[196:199], v[168:171], v[148:151]
  s_add_u32 m0, s21, 0x1c000
  s_nop 0
  buffer_load_dwordx4 v11, s[8:11], s31 offen lds
  v_mfma_f32_16x16x32_bf16 v[152:155], v[200:203], v[168:171], v[152:155]
  s_add_u32 m0, s21, 0x1e000
  s_nop 0
  buffer_load_dwordx4 v12, s[8:11], s31 offen lds
  s_add_u32 s31, s31, 0x80000
  ds_read_b128 v[164:167], v14 offset:4096
  s_waitcnt lgkmcnt(8)
  v_mfma_f32_16x16x32_bf16 v[28:31], v[172:175], v[156:159], v[28:31]
  ds_read_b64_tr_b16 v[188:189], v16 offset:16384
  ds_read_b64_tr_b16 v[190:191], v16 offset:18432
  s_waitcnt lgkmcnt(8)
  v_mfma_f32_16x16x32_bf16 v[32:35], v[176:179], v[156:159], v[32:35]
  s_waitcnt lgkmcnt(6)
  v_mfma_f32_16x16x32_bf16 v[36:39], v[180:183], v[156:159], v[36:39]
  s_waitcnt lgkmcnt(4)
  v_mfma_f32_16x16x32_bf16 v[40:43], v[184:187], v[156:159], v[40:43]
  ds_read_b128 v[168:171], v14 offset:6144
  s_waitcnt lgkmcnt(4)
  v_mfma_f32_16x16x32_bf16 v[44:47], v[172:175], v[160:163], v[44:47]
  v_mfma_f32_16x16x32_bf16 v[48:51], v[176:179], v[160:163], v[48:51]
  v_mfma_f32_16x16x32_bf16 v[52:55], v[180:183], v[160:163], v[52:55]
  v_mfma_f32_16x16x32_bf16 v[56:59], v[184:187], v[160:163], v[56:59]
  ds_read_b128 v[156:159], v14 offset:8192
  ds_read_b64_tr_b16 v[192:193], v17 offset:16384
  ds_read_b64_tr_b16 v[194:195], v17 offset:18432
  s_waitcnt lgkmcnt(6)
  v_mfma_f32_16x16x32_bf16 v[60:63], v[172:175], v[164:167], v[60:63]
  v_mfma_f32_16x16x32_bf16 v[64:67], v[176:179], v[164:167], v[64:67]
  v_mfma_f32_16x16x32_bf16 v[68:71], v[180:183], v[164:167], v[68:71]
  v_mfma_f32_16x16x32_bf16 v[72:75], v[184:187], v[164:167], v[72:75]
  ds_read_b128 v[160:163], v14 offset:10240
  s_waitcnt lgkmcnt(4)
  v_mfma_f32_16x16x32_bf16 v[76:79], v[172:175], v[168:171], v[76:79]
  v_mfma_f32_16x16x32_bf16 v[80:83], v[176:179], v[168:171], v[80:83]
  v_mfma_f32_16x16x32_bf16 v[84:87], v[180:183], v[168:171], v[84:87]
  ds_read_b64_tr_b16 v[196:197], v18 offset:16384
  ds_read_b64_tr_b16 v[198:199], v18 offset:18432
  v_mfma_f32_16x16x32_bf16 v[88:91], v[184:187], v[168:171], v[88:91]
  ds_read_b128 v[164:167], v14 offset:12288
  s_waitcnt lgkmcnt(6)
  v_mfma_f32_16x16x32_bf16 v[92:95], v[172:175], v[156:159], v[92:95]
  v_mfma_f32_16x16x32_bf16 v[96:99], v[176:179], v[156:159], v[96:99]
  v_mfma_f32_16x16x32_bf16 v[100:103], v[180:183], v[156:159], v[100:103]
  v_mfma_f32_16x16x32_bf16 v[104:107], v[184:187], v[156:159], v[104:107]
  ds_read_b128 v[168:171], v14 offset:14336
  s_waitcnt lgkmcnt(4)
  v_mfma_f32_16x16x32_bf16 v[108:111], v[172:175], v[160:163], v[108:111]
  v_mfma_f32_16x16x32_bf16 v[112:115], v[176:179], v[160:163], v[112:115]
  ds_read_b64_tr_b16 v[200:201], v19 offset:16384
  ds_read_b64_tr_b16 v[202:203], v19 offset:18432
  v_mfma_f32_16x16x32_bf16 v[116:119], v[180:183], v[160:163], v[116:119]
  v_mfma_f32_16x16x32_bf16 v[120:123], v[184:187], v[160:163], v[120:123]
  ds_read_b128 v[156:159], v15 offset:0
  s_waitcnt lgkmcnt(4)
  v_mfma_f32_16x16x32_bf16 v[124:127], v[172:175], v[164:167], v[124:127]
  v_mfma_f32_16x16x32_bf16 v[128:131], v[176:179], v[164:167], v[128:131]
  v_mfma_f32_16x16x32_bf16 v[132:135], v[180:183], v[164:167], v[132:135]
  v_mfma_f32_16x16x32_bf16 v[136:139], v[184:187], v[164:167], v[136:139]
  ds_read_b128 v[160:163], v15 offset:2048
  s_waitcnt lgkmcnt(4)
  v_mfma_f32_16x16x32_bf16 v[140:143], v[172:175], v[168:171], v[140:143]
  v_mfma_f32_16x16x32_bf16 v[144:147], v[176:179], v[168:171], v[144:147]
  v_mfma_f32_16x16x32_bf16 v[148:151], v[180:183], v[168:171], v[148:151]
  v_mfma_f32_16x16x32_bf16 v[152:155], v[184:187], v[168:171], v[152:155]
  ds_read_b128 v[164:167], v15 offset:4096
  s_waitcnt lgkmcnt(2)
  v_mfma_f32_16x16x32_bf16 v[28:31], v[188:191], v[156:159], v[28:31]
  v_mfma_f32_16x16x32_bf16 v[32:35], v[192:195], v[156:159], v[32:35]
  v_mfma_f32_16x16x32_bf16 v[36:39], v[196:199], v[156:159], v[36:39]
  v_mfma_f32_16x16x32_bf16 v[40:43], v[200:203], v[156:159], v[40:43]
  ds_read_b128 v[168:171], v15 offset:6144
  s_waitcnt lgkmcnt(2)
  v_mfma_f32_16x16x32_bf16 v[44:47], v[188:191], v[160:163], v[44:47]
  v_mfma_f32_16x16x32_bf16 v[48:51], v[192:195], v[160:163], v[48:51]
  v_mfma_f32_16x16x32_bf16 v[52:55], v[196:199], v[160:163], v[52:55]
  v_mfma_f32_16x16x32_bf16 v[56:59], v[200:203], v[160:163], v[56:59]
  ds_read_b128 v[156:159], v15 offset:8192
  s_waitcnt lgkmcnt(2)
  v_mfma_f32_16x16x32_bf16 v[60:63], v[188:191], v[164:167], v[60:63]
  v_mfma_f32_16x16x32_bf16 v[64:67], v[192:195], v[164:167], v[64:67]
  v_mfma_f32_16x16x32_bf16 v[68:71], v[196:199], v[164:167], v[68:71]
  v_mfma_f32_16x16x32_bf16 v[72:75], v[200:203], v[164:167], v[72:75]
  ds_read_b128 v[160:163], v15 offset:10240
  s_waitcnt lgkmcnt(2)
  v_mfma_f32_16x16x32_bf16 v[76:79], v[188:191], v[168:171], v[76:79]
  v_mfma_f32_16x16x32_bf16 v[80:83], v[192:195], v[168:171], v[80:83]
  v_mfma_f32_16x16x32_bf16 v[84:87], v[196:199], v[168:171], v[84:87]
  v_mfma_f32_16x16x32_bf16 v[88:91], v[200:203], v[168:171], v[88:91]
  ds_read_b128 v[164:167], v15 offset:12288
  s_waitcnt lgkmcnt(2)
  v_mfma_f32_16x16x32_bf16 v[92:95], v[188:191], v[156:159], v[92:95]
  v_mfma_f32_16x16x32_bf16 v[96:99], v[192:195], v[156:159], v[96:99]
  v_mfma_f32_16x16x32_bf16 v[100:103], v[196:199], v[156:159], v[100:103]
  v_mfma_f32_16x16x32_bf16 v[104:107], v[200:203], v[156:159], v[104:107]
  ds_read_b128 v[168:171], v15 offset:14336
  s_waitcnt lgkmcnt(2)
  v_mfma_f32_16x16x32_bf16 v[108:111], v[188:191], v[160:163], v[108:111]
  v_mfma_f32_16x16x32_bf16 v[112:115], v[192:195], v[160:163], v[112:115]
  v_mfma_f32_16x16x32_bf16 v[116:119], v[196:199], v[160:163], v[116:119]
  v_mfma_f32_16x16x32_bf16 v[120:123], v[200:203], v[160:163], v[120:123]
  s_waitcnt vmcnt(0) lgkmcnt(0)
  s_barrier
  v_add_u32 v14, 0x8000, v14
  v_add_u32 v15, 0x8000, v15
  v_add_u32 v16, 0x8000, v16
  v_add_u32 v17, 0x8000, v17
  v_add_u32 v18, 0x8000, v18
  v_add_u32 v19, 0x8000, v19
  ds_read_b64_tr_b16 v[172:173], v16 offset:0
  ds_read_b64_tr_b16 v[174:175], v16 offset:2048
  ds_read_b128 v[156:159], v14 offset:0
  ds_read_b64_tr_b16 v[176:177], v17 offset:0
  ds_read_b64_tr_b16 v[178:179], v17 offset:2048
  ds_read_b64_tr_b16 v[180:181], v18 offset:0
  ds_read_b64_tr_b16 v[182:183], v18 offset:2048
  ds_read_b64_tr_b16 v[184:185], v19 offset:0
  ds_read_b64_tr_b16 v[186:187], v19 offset:2048
  v_mfma_f32_16x16x32_bf16 v[124:127], v[188:191], v[164:167], v[124:127]
  v_mfma_f32_16x16x32_bf16 v[128:131], v[192:195], v[164:167], v[128:131]
  v_mfma_f32_16x16x32_bf16 v[132:135], v[196:199], v[164:167], v[132:135]
  v_mfma_f32_16x16x32_bf16 v[136:139], v[200:203], v[164:167], v[136:139]
  ds_read_b128 v[160:163], v14 offset:2048
  v_mfma_f32_16x16x32_bf16 v[140:143], v[188:191], v[168:171], v[140:143]
  v_mfma_f32_16x16x32_bf16 v[144:147], v[192:195], v[168:171], v[144:147]
  v_mfma_f32_16x16x32_bf16 v[148:151], v[196:199], v[168:171], v[148:151]
  v_mfma_f32_16x16x32_bf16 v[152:155], v[200:203], v[168:171], v[152:155]
  ds_read_b128 v[164:167], v14 offset:4096
  s_waitcnt lgkmcnt(8)
  v_mfma_f32_16x16x32_bf16 v[28:31], v[172:175], v[156:159], v[28:31]
  ds_read_b64_tr_b16 v[188:189], v16 offset:16384
  ds_read_b64_tr_b16 v[190:191], v16 offset:18432
  s_waitcnt lgkmcnt(8)
  v_mfma_f32_16x16x32_bf16 v[32:35], v[176:179], v[156:159], v[32:35]
  s_waitcnt lgkmcnt(6)
  v_mfma_f32_16x16x32_bf16 v[36:39], v[180:183], v[156:159], v[36:39]
  s_waitcnt lgkmcnt(4)
  v_mfma_f32_16x16x32_bf16 v[40:43], v[184:187], v[156:159], v[40:43]
  ds_read_b128 v[168:171], v14 offset:6144
  s_waitcnt lgkmcnt(4)
  v_mfma_f32_16x16x32_bf16 v[44:47], v[172:175], v[160:163], v[44:47]
  v_mfma_f32_16x16x32_bf16 v[48:51], v[176:179], v[160:163], v[48:51]
  v_mfma_f32_16x16x32_bf16 v[52:55], v[180:183], v[160:163], v[52:55]
  v_mfma_f32_16x16x32_bf16 v[56:59], v[184:187], v[160:163], v[56:59]
  ds_read_b128 v[156:159], v14 offset:8192
  ds_read_b64_tr_b16 v[192:193], v17 offset:16384
  ds_read_b64_tr_b16 v[194:195], v17 offset:18432
  s_waitcnt lgkmcnt(6)
  v_mfma_f32_16x16x32_bf16 v[60:63], v[172:175], v[164:167], v[60:63]
  v_mfma_f32_16x16x32_bf16 v[64:67], v[176:179], v[164:167], v[64:67]
  v_mfma_f32_16x16x32_bf16 v[68:71], v[180:183], v[164:167], v[68:71]
  v_mfma_f32_16x16x32_bf16 v[72:75], v[184:187], v[164:167], v[72:75]
  ds_read_b128 v[160:163], v14 offset:10240
  s_waitcnt lgkmcnt(4)
  v_mfma_f32_16x16x32_bf16 v[76:79], v[172:175], v[168:171], v[76:79]
  v_mfma_f32_16x16x32_bf16 v[80:83], v[176:179], v[168:171], v[80:83]
  v_mfma_f32_16x16x32_bf16 v[84:87], v[180:183], v[168:171], v[84:87]
  ds_read_b64_tr_b16 v[196:197], v18 offset:16384
  ds_read_b64_tr_b16 v[198:199], v18 offset:18432
  v_mfma_f32_16x16x32_bf16 v[88:91], v[184:187], v[168:171], v[88:91]
  ds_read_b128 v[164:167], v14 offset:12288
  s_waitcnt lgkmcnt(6)
  v_mfma_f32_16x16x32_bf16 v[92:95], v[172:175], v[156:159], v[92:95]
  v_mfma_f32_16x16x32_bf16 v[96:99], v[176:179], v[156:159], v[96:99]
  v_mfma_f32_16x16x32_bf16 v[100:103], v[180:183], v[156:159], v[100:103]
  v_mfma_f32_16x16x32_bf16 v[104:107], v[184:187], v[156:159], v[104:107]
  ds_read_b128 v[168:171], v14 offset:14336
  s_waitcnt lgkmcnt(4)
  v_mfma_f32_16x16x32_bf16 v[108:111], v[172:175], v[160:163], v[108:111]
  v_mfma_f32_16x16x32_bf16 v[112:115], v[176:179], v[160:163], v[112:115]
  ds_read_b64_tr_b16 v[200:201], v19 offset:16384
  ds_read_b64_tr_b16 v[202:203], v19 offset:18432
  v_mfma_f32_16x16x32_bf16 v[116:119], v[180:183], v[160:163], v[116:119]
  v_mfma_f32_16x16x32_bf16 v[120:123], v[184:187], v[160:163], v[120:123]
  ds_read_b128 v[156:159], v15 offset:0
  s_waitcnt lgkmcnt(4)
  v_mfma_f32_16x16x32_bf16 v[124:127], v[172:175], v[164:167], v[124:127]
  v_mfma_f32_16x16x32_bf16 v[128:131], v[176:179], v[164:167], v[128:131]
  v_mfma_f32_16x16x32_bf16 v[132:135], v[180:183], v[164:167], v[132:135]
  v_mfma_f32_16x16x32_bf16 v[136:139], v[184:187], v[164:167], v[136:139]
  ds_read_b128 v[160:163], v15 offset:2048
  s_waitcnt lgkmcnt(4)
  v_mfma_f32_16x16x32_bf16 v[140:143], v[172:175], v[168:171], v[140:143]
  v_mfma_f32_16x16x32_bf16 v[144:147], v[176:179], v[168:171], v[144:147]
  v_mfma_f32_16x16x32_bf16 v[148:151], v[180:183], v[168:171], v[148:151]
  v_mfma_f32_16x16x32_bf16 v[152:155], v[184:187], v[168:171], v[152:155]
  ds_read_b128 v[164:167], v15 offset:4096
  s_waitcnt lgkmcnt(2)
  v_mfma_f32_16x16x32_bf16 v[28:31], v[188:191], v[156:159], v[28:31]
  v_mfma_f32_16x16x32_bf16 v[32:35], v[192:195], v[156:159], v[32:35]
  v_mfma_f32_16x16x32_bf16 v[36:39], v[196:199], v[156:159], v[36:39]
  v_mfma_f32_16x16x32_bf16 v[40:43], v[200:203], v[156:159], v[40:43]
  ds_read_b128 v[168:171], v15 offset:6144
  s_waitcnt lgkmcnt(2)
  v_mfma_f32_16x16x32_bf16 v[44:47], v[188:191], v[160:163], v[44:47]
  v_mfma_f32_16x16x32_bf16 v[48:51], v[192:195], v[160:163], v[48:51]
  v_mfma_f32_16x16x32_bf16 v[52:55], v[196:199], v[160:163], v[52:55]
  v_mfma_f32_16x16x32_bf16 v[56:59], v[200:203], v[160:163], v[56:59]
  ds_read_b128 v[156:159], v15 offset:8192
  s_waitcnt lgkmcnt(2)
  v_mfma_f32_16x16x32_bf16 v[60:63], v[188:191], v[164:167], v[60:63]
  v_mfma_f32_16x16x32_bf16 v[64:67], v[192:195], v[164:167], v[64:67]
  v_mfma_f32_16x16x32_bf16 v[68:71], v[196:199], v[164:167], v[68:71]
  v_mfma_f32_16x16x32_bf16 v[72:75], v[200:203], v[164:167], v[72:75]
  ds_read_b128 v[160:163], v15 offset:10240
  s_waitcnt lgkmcnt(2)
  v_mfma_f32_16x16x32_bf16 v[76:79], v[188:191], v[168:171], v[76:79]
  v_mfma_f32_16x16x32_bf16 v[80:83], v[192:195], v[168:171], v[80:83]
  v_mfma_f32_16x16x32_bf16 v[84:87], v[196:199], v[168:171], v[84:87]
  v_mfma_f32_16x16x32_bf16 v[88:91], v[200:203], v[168:171], v[88:91]
  ds_read_b128 v[164:167], v15 offset:12288
  s_waitcnt lgkmcnt(2)
  v_mfma_f32_16x16x32_bf16 v[92:95], v[188:191], v[156:159], v[92:95]
  v_mfma_f32_16x16x32_bf16 v[96:99], v[192:195], v[156:159], v[96:99]
  v_mfma_f32_16x16x32_bf16 v[100:103], v[196:199], v[156:159], v[100:103]
  v_mfma_f32_16x16x32_bf16 v[104:107], v[200:203], v[156:159], v[104:107]
  ds_read_b128 v[168:171], v15 offset:14336
  s_waitcnt lgkmcnt(2)
  v_mfma_f32_16x16x32_bf16 v[108:111], v[188:191], v[160:163], v[108:111]
  v_mfma_f32_16x16x32_bf16 v[112:115], v[192:195], v[160:163], v[112:115]
  v_mfma_f32_16x16x32_bf16 v[116:119], v[196:199], v[160:163], v[116:119]
  v_mfma_f32_16x16x32_bf16 v[120:123], v[200:203], v[160:163], v[120:123]
  s_waitcnt lgkmcnt(1)
  v_mfma_f32_16x16x32_bf16 v[124:127], v[188:191], v[164:167], v[124:127]
  v_mfma_f32_16x16x32_bf16 v[128:131], v[192:195], v[164:167], v[128:131]
  v_mfma_f32_16x16x32_bf16 v[132:135], v[196:199], v[164:167], v[132:135]
  v_mfma_f32_16x16x32_bf16 v[136:139], v[200:203], v[164:167], v[136:139]
  s_waitcnt lgkmcnt(0)
  v_mfma_f32_16x16x32_bf16 v[140:143], v[188:191], v[168:171], v[140:143]
  v_mfma_f32_16x16x32_bf16 v[144:147], v[192:195], v[168:171], v[144:147]
  v_mfma_f32_16x16x32_bf16 v[148:151], v[196:199], v[168:171], v[148:151]
  v_mfma_f32_16x16x32_bf16 v[152:155], v[200:203], v[168:171], v[152:155]
  s_nop 15
  v_and_b32 v2, 15, v1
  v_lshlrev_b32 v2, 13, v2
  v_lshl_add_u32 v2, v13, 4, v2
  s_mul_i32 s28, s24, 1048576
  s_mul_i32 s29, s22, 128
  s_add_u32 s28, s28, s29
  v_add_u32 v2, s28, v2
  s_mov_b32 s28, 0x0
  v_cvt_pk_bf16_f32 v28, v28, v29
  v_cvt_pk_bf16_f32 v29, v30, v31
  v_cvt_pk_bf16_f32 v30, v32, v33
  v_cvt_pk_bf16_f32 v31, v34, v35
  buffer_store_dwordx4 v[28:31], v2, s[12:15], s28 offen offset:0 sc1
  v_cvt_pk_bf16_f32 v36, v36, v37
  v_cvt_pk_bf16_f32 v37, v38, v39
  v_cvt_pk_bf16_f32 v38, v40, v41
  v_cvt_pk_bf16_f32 v39, v42, v43
  buffer_store_dwordx4 v[36:39], v2, s[12:15], s28 offen offset:64 sc1
  s_mov_b32 s28, 0x20000
  v_cvt_pk_bf16_f32 v44, v44, v45
  v_cvt_pk_bf16_f32 v45, v46, v47
  v_cvt_pk_bf16_f32 v46, v48, v49
  v_cvt_pk_bf16_f32 v47, v50, v51
  buffer_store_dwordx4 v[44:47], v2, s[12:15], s28 offen offset:0 sc1
  v_cvt_pk_bf16_f32 v52, v52, v53
  v_cvt_pk_bf16_f32 v53, v54, v55
  v_cvt_pk_bf16_f32 v54, v56, v57
  v_cvt_pk_bf16_f32 v55, v58, v59
  buffer_store_dwordx4 v[52:55], v2, s[12:15], s28 offen offset:64 sc1
  s_mov_b32 s28, 0x40000
  v_cvt_pk_bf16_f32 v60, v60, v61
  v_cvt_pk_bf16_f32 v61, v62, v63
  v_cvt_pk_bf16_f32 v62, v64, v65
  v_cvt_pk_bf16_f32 v63, v66, v67
  buffer_store_dwordx4 v[60:63], v2, s[12:15], s28 offen offset:0 sc1
  v_cvt_pk_bf16_f32 v68, v68, v69
  v_cvt_pk_bf16_f32 v69, v70, v71
  v_cvt_pk_bf16_f32 v70, v72, v73
  v_cvt_pk_bf16_f32 v71, v74, v75
  buffer_store_dwordx4 v[68:71], v2, s[12:15], s28 offen offset:64 sc1
  s_mov_b32 s28, 0x60000
  v_cvt_pk_bf16_f32 v76, v76, v77
  v_cvt_pk_bf16_f32 v77, v78, v79
  v_cvt_pk_bf16_f32 v78, v80, v81
  v_cvt_pk_bf16_f32 v79, v82, v83
  buffer_store_dwordx4 v[76:79], v2, s[12:15], s28 offen offset:0 sc1
  v_cvt_pk_bf16_f32 v84, v84, v85
  v_cvt_pk_bf16_f32 v85, v86, v87
  v_cvt_pk_bf16_f32 v86, v88, v89
  v_cvt_pk_bf16_f32 v87, v90, v91
  buffer_store_dwordx4 v[84:87], v2, s[12:15], s28 offen offset:64 sc1
  s_mov_b32 s28, 0x80000
  v_cvt_pk_bf16_f32 v92, v92, v93
  v_cvt_pk_bf16_f32 v93, v94, v95
  v_cvt_pk_bf16_f32 v94, v96, v97
  v_cvt_pk_bf16_f32 v95, v98, v99
  buffer_store_dwordx4 v[92:95], v2, s[12:15], s28 offen offset:0 sc1
  v_cvt_pk_bf16_f32 v100, v100, v101
  v_cvt_pk_bf16_f32 v101, v102, v103
  v_cvt_pk_bf16_f32 v102, v104, v105
  v_cvt_pk_bf16_f32 v103, v106, v107
  buffer_store_dwordx4 v[100:103], v2, s[12:15], s28 offen offset:64 sc1
  s_mov_b32 s28, 0xa0000
  v_cvt_pk_bf16_f32 v108, v108, v109
  v_cvt_pk_bf16_f32 v109, v110, v111
  v_cvt_pk_bf16_f32 v110, v112, v113
  v_cvt_pk_bf16_f32 v111, v114, v115
  buffer_store_dwordx4 v[108:111], v2, s[12:15], s28 offen offset:0 sc1
  v_cvt_pk_bf16_f32 v116, v116, v117
  v_cvt_pk_bf16_f32 v117, v118, v119
  v_cvt_pk_bf16_f32 v118, v120, v121
  v_cvt_pk_bf16_f32 v119, v122, v123
  buffer_store_dwordx4 v[116:119], v2, s[12:15], s28 offen offset:64 sc1
  s_mov_b32 s28, 0xc0000
  v_cvt_pk_bf16_f32 v124, v124, v125
  v_cvt_pk_bf16_f32 v125, v126, v127
  v_cvt_pk_bf16_f32 v126, v128, v129
  v_cvt_pk_bf16_f32 v127, v130, v131
  buffer_store_dwordx4 v[124:127], v2, s[12:15], s28 offen offset:0 sc1
  v_cvt_pk_bf16_f32 v132, v132, v133
  v_cvt_pk_bf16_f32 v133, v134, v135
  v_cvt_pk_bf16_f32 v134, v136, v137
  v_cvt_pk_bf16_f32 v135, v138, v139
  buffer_store_dwordx4 v[132:135], v2, s[12:15], s28 offen offset:64 sc1
  s_mov_b32 s28, 0xe0000
  v_cvt_pk_bf16_f32 v140, v140, v141
  v_cvt_pk_bf16_f32 v141, v142, v143
  v_cvt_pk_bf16_f32 v142, v144, v145
  v_cvt_pk_bf16_f32 v143, v146, v147
  buffer_store_dwordx4 v[140:143], v2, s[12:15], s28 offen offset:0 sc1
  v_cvt_pk_bf16_f32 v148, v148, v149
  v_cvt_pk_bf16_f32 v149, v150, v151
  v_cvt_pk_bf16_f32 v150, v152, v153
  v_cvt_pk_bf16_f32 v151, v154, v155
  buffer_store_dwordx4 v[148:151], v2, s[12:15], s28 offen offset:64 sc1
  s_branch kvproj_kernel_end_d
kvproj_kernel_alt1:
  s_waitcnt vmcnt(11)
  s_barrier
  s_lshl_b32 s44, s2, 3
  s_add_u32 s44, s44, s20
  s_mul_i32 s44, s44, 3072
  v_and_b32 v20, 63, v0
  v_lshlrev_b32 v20, 4, v20
  s_mov_b32 s16, s56
  s_mov_b32 s17, s57
  s_mov_b32 s18, 0x480000
  s_mov_b32 s19, 0x00020000
  buffer_load_dwordx4 v[204:207], v20, s[16:19], s44 offen offset:0
  buffer_load_dwordx4 v[204:207], v20, s[16:19], s44 offen offset:1024
  buffer_load_dwordx4 v[204:207], v20, s[16:19], s44 offen offset:2048
  ds_read_b64_tr_b16 v[172:173], v16 offset:0
  ds_read_b64_tr_b16 v[174:175], v16 offset:2048
  ds_read_b128 v[156:159], v14 offset:0
  ds_read_b64_tr_b16 v[176:177], v17 offset:0
  ds_read_b64_tr_b16 v[178:179], v17 offset:2048
  ds_read_b64_tr_b16 v[180:181], v18 offset:0
  ds_read_b64_tr_b16 v[182:183], v18 offset:2048
  ds_read_b64_tr_b16 v[184:185], v19 offset:0
  ds_read_b64_tr_b16 v[186:187], v19 offset:2048
  ds_read_b128 v[160:163], v14 offset:2048
  ds_read_b128 v[164:167], v14 offset:4096
  s_waitcnt lgkmcnt(8)
  v_mfma_f32_16x16x32_bf16 v[28:31], v[156:159], v[172:175], 0
  ds_read_b64_tr_b16 v[188:189], v16 offset:16384
  ds_read_b64_tr_b16 v[190:191], v16 offset:18432
  s_waitcnt lgkmcnt(8)
  v_mfma_f32_16x16x32_bf16 v[32:35], v[156:159], v[176:179], 0
  s_waitcnt lgkmcnt(6)
  v_mfma_f32_16x16x32_bf16 v[36:39], v[156:159], v[180:183], 0
  s_waitcnt lgkmcnt(4)
  v_mfma_f32_16x16x32_bf16 v[40:43], v[156:159], v[184:187], 0
  ds_read_b128 v[168:171], v14 offset:6144
  s_waitcnt lgkmcnt(4)
  v_mfma_f32_16x16x32_bf16 v[44:47], v[160:163], v[172:175], 0
  v_mfma_f32_16x16x32_bf16 v[48:51], v[160:163], v[176:179], 0
  v_mfma_f32_16x16x32_bf16 v[52:55], v[160:163], v[180:183], 0
  v_mfma_f32_16x16x32_bf16 v[56:59], v[160:163], v[184:187], 0
  ds_read_b128 v[156:159], v14 offset:8192
  ds_read_b64_tr_b16 v[192:193], v17 offset:16384
  ds_read_b64_tr_b16 v[194:195], v17 offset:18432
  s_waitcnt lgkmcnt(6)
  v_mfma_f32_16x16x32_bf16 v[60:63], v[164:167], v[172:175], 0
  v_mfma_f32_16x16x32_bf16 v[64:67], v[164:167], v[176:179], 0
  v_mfma_f32_16x16x32_bf16 v[68:71], v[164:167], v[180:183], 0
  v_mfma_f32_16x16x32_bf16 v[72:75], v[164:167], v[184:187], 0
  ds_read_b128 v[160:163], v14 offset:10240
  s_waitcnt lgkmcnt(4)
  v_mfma_f32_16x16x32_bf16 v[76:79], v[168:171], v[172:175], 0
  v_mfma_f32_16x16x32_bf16 v[80:83], v[168:171], v[176:179], 0
  v_mfma_f32_16x16x32_bf16 v[84:87], v[168:171], v[180:183], 0
  ds_read_b64_tr_b16 v[196:197], v18 offset:16384
  ds_read_b64_tr_b16 v[198:199], v18 offset:18432
  v_mfma_f32_16x16x32_bf16 v[88:91], v[168:171], v[184:187], 0
  ds_read_b128 v[164:167], v14 offset:12288
  s_waitcnt lgkmcnt(6)
  v_mfma_f32_16x16x32_bf16 v[92:95], v[156:159], v[172:175], 0
  v_mfma_f32_16x16x32_bf16 v[96:99], v[156:159], v[176:179], 0
  v_mfma_f32_16x16x32_bf16 v[100:103], v[156:159], v[180:183], 0
  v_mfma_f32_16x16x32_bf16 v[104:107], v[156:159], v[184:187], 0
  ds_read_b128 v[168:171], v14 offset:14336
  s_waitcnt lgkmcnt(4)
  v_mfma_f32_16x16x32_bf16 v[108:111], v[160:163], v[172:175], 0
  v_mfma_f32_16x16x32_bf16 v[112:115], v[160:163], v[176:179], 0
  ds_read_b64_tr_b16 v[200:201], v19 offset:16384
  ds_read_b64_tr_b16 v[202:203], v19 offset:18432
  v_mfma_f32_16x16x32_bf16 v[116:119], v[160:163], v[180:183], 0
  v_mfma_f32_16x16x32_bf16 v[120:123], v[160:163], v[184:187], 0
  ds_read_b128 v[156:159], v15 offset:0
  s_waitcnt lgkmcnt(4)
  v_mfma_f32_16x16x32_bf16 v[124:127], v[164:167], v[172:175], 0
  v_mfma_f32_16x16x32_bf16 v[128:131], v[164:167], v[176:179], 0
  v_mfma_f32_16x16x32_bf16 v[132:135], v[164:167], v[180:183], 0
  v_mfma_f32_16x16x32_bf16 v[136:139], v[164:167], v[184:187], 0
  ds_read_b128 v[160:163], v15 offset:2048
  s_waitcnt lgkmcnt(4)
  v_mfma_f32_16x16x32_bf16 v[140:143], v[168:171], v[172:175], 0
  v_mfma_f32_16x16x32_bf16 v[144:147], v[168:171], v[176:179], 0
  v_mfma_f32_16x16x32_bf16 v[148:151], v[168:171], v[180:183], 0
  v_mfma_f32_16x16x32_bf16 v[152:155], v[168:171], v[184:187], 0
  ds_read_b128 v[164:167], v15 offset:4096
  s_waitcnt lgkmcnt(2)
  v_mfma_f32_16x16x32_bf16 v[28:31], v[156:159], v[188:191], v[28:31]
  v_mfma_f32_16x16x32_bf16 v[32:35], v[156:159], v[192:195], v[32:35]
  v_mfma_f32_16x16x32_bf16 v[36:39], v[156:159], v[196:199], v[36:39]
  v_mfma_f32_16x16x32_bf16 v[40:43], v[156:159], v[200:203], v[40:43]
  ds_read_b128 v[168:171], v15 offset:6144
  s_waitcnt lgkmcnt(2)
  v_mfma_f32_16x16x32_bf16 v[44:47], v[160:163], v[188:191], v[44:47]
  v_mfma_f32_16x16x32_bf16 v[48:51], v[160:163], v[192:195], v[48:51]
  v_mfma_f32_16x16x32_bf16 v[52:55], v[160:163], v[196:199], v[52:55]
  v_mfma_f32_16x16x32_bf16 v[56:59], v[160:163], v[200:203], v[56:59]
  ds_read_b128 v[156:159], v15 offset:8192
  s_waitcnt lgkmcnt(2)
  v_mfma_f32_16x16x32_bf16 v[60:63], v[164:167], v[188:191], v[60:63]
  v_mfma_f32_16x16x32_bf16 v[64:67], v[164:167], v[192:195], v[64:67]
  v_mfma_f32_16x16x32_bf16 v[68:71], v[164:167], v[196:199], v[68:71]
  v_mfma_f32_16x16x32_bf16 v[72:75], v[164:167], v[200:203], v[72:75]
  ds_read_b128 v[160:163], v15 offset:10240
  s_waitcnt lgkmcnt(2)
  v_mfma_f32_16x16x32_bf16 v[76:79], v[168:171], v[188:191], v[76:79]
  v_mfma_f32_16x16x32_bf16 v[80:83], v[168:171], v[192:195], v[80:83]
  v_mfma_f32_16x16x32_bf16 v[84:87], v[168:171], v[196:199], v[84:87]
  v_mfma_f32_16x16x32_bf16 v[88:91], v[168:171], v[200:203], v[88:91]
  ds_read_b128 v[164:167], v15 offset:12288
  s_waitcnt lgkmcnt(2)
  v_mfma_f32_16x16x32_bf16 v[92:95], v[156:159], v[188:191], v[92:95]
  v_mfma_f32_16x16x32_bf16 v[96:99], v[156:159], v[192:195], v[96:99]
  v_mfma_f32_16x16x32_bf16 v[100:103], v[156:159], v[196:199], v[100:103]
  v_mfma_f32_16x16x32_bf16 v[104:107], v[156:159], v[200:203], v[104:107]
  ds_read_b128 v[168:171], v15 offset:14336
  s_waitcnt lgkmcnt(2)
  v_mfma_f32_16x16x32_bf16 v[108:111], v[160:163], v[188:191], v[108:111]
  v_mfma_f32_16x16x32_bf16 v[112:115], v[160:163], v[192:195], v[112:115]
  v_mfma_f32_16x16x32_bf16 v[116:119], v[160:163], v[196:199], v[116:119]
  v_mfma_f32_16x16x32_bf16 v[120:123], v[160:163], v[200:203], v[120:123]
  s_waitcnt vmcnt(3) lgkmcnt(0)
  s_barrier
  v_add_u32 v14, 0x8000, v14
  v_add_u32 v15, 0x8000, v15
  v_add_u32 v16, 0x8000, v16
  v_add_u32 v17, 0x8000, v17
  v_add_u32 v18, 0x8000, v18
  v_add_u32 v19, 0x8000, v19
  ds_read_b64_tr_b16 v[172:173], v16 offset:0
  ds_read_b64_tr_b16 v[174:175], v16 offset:2048
  ds_read_b128 v[156:159], v14 offset:0
  ds_read_b64_tr_b16 v[176:177], v17 offset:0
  ds_read_b64_tr_b16 v[178:179], v17 offset:2048
  ds_read_b64_tr_b16 v[180:181], v18 offset:0
  ds_read_b64_tr_b16 v[182:183], v18 offset:2048
  ds_read_b64_tr_b16 v[184:185], v19 offset:0
  ds_read_b64_tr_b16 v[186:187], v19 offset:2048
  v_mfma_f32_16x16x32_bf16 v[124:127], v[164:167], v[188:191], v[124:127]
  s_add_u32 m0, s21, 0x0
  s_nop 0
  buffer_load_dwordx4 v5, s[4:7], s30 offen lds
  v_mfma_f32_16x16x32_bf16 v[128:131], v[164:167], v[192:195], v[128:131]
  s_add_u32 m0, s21, 0x2000
  s_nop 0
  buffer_load_dwordx4 v6, s[4:7], s30 offen lds
  v_mfma_f32_16x16x32_bf16 v[132:135], v[164:167], v[196:199], v[132:135]
  s_add_u32 m0, s21, 0x4000
  s_nop 0
  buffer_load_dwordx4 v7, s[4:7], s30 offen lds
  v_mfma_f32_16x16x32_bf16 v[136:139], v[164:167], v[200:203], v[136:139]
  s_add_u32 m0, s21, 0x6000
  s_nop 0
  buffer_load_dwordx4 v8, s[4:7], s30 offen lds
  s_add_u32 s30, s30, 128
  ds_read_b128 v[160:163], v14 offset:2048
  v_mfma_f32_16x16x32_bf16 v[140:143], v[168:171], v[188:191], v[140:143]
  s_add_u32 m0, s21, 0x10000
  s_nop 0
  buffer_load_dwordx4 v9, s[8:11], s31 offen lds
  v_mfma_f32_16x16x32_bf16 v[144:147], v[168:171], v[192:195], v[144:147]
  s_add_u32 m0, s21, 0x12000
  s_nop 0
  buffer_load_dwordx4 v10, s[8:11], s31 offen lds
  v_mfma_f32_16x16x32_bf16 v[148:151], v[168:171], v[196:199], v[148:151]
  s_add_u32 m0, s21, 0x14000
  s_nop 0
  buffer_load_dwordx4 v11, s[8:11], s31 offen lds
  v_mfma_f32_16x16x32_bf16 v[152:155], v[168:171], v[200:203], v[152:155]
  s_add_u32 m0, s21, 0x16000
  s_nop 0
  buffer_load_dwordx4 v12, s[8:11], s31 offen lds
  s_add_u32 s31, s31, 0x80000
  ds_read_b128 v[164:167], v14 offset:4096
  s_waitcnt lgkmcnt(8)
  v_mfma_f32_16x16x32_bf16 v[28:31], v[156:159], v[172:175], v[28:31]
  ds_read_b64_tr_b16 v[188:189], v16 offset:16384
  ds_read_b64_tr_b16 v[190:191], v16 offset:18432
  s_waitcnt lgkmcnt(8)
  v_mfma_f32_16x16x32_bf16 v[32:35], v[156:159], v[176:179], v[32:35]
  s_waitcnt lgkmcnt(6)
  v_mfma_f32_16x16x32_bf16 v[36:39], v[156:159], v[180:183], v[36:39]
  s_waitcnt lgkmcnt(4)
  v_mfma_f32_16x16x32_bf16 v[40:43], v[156:159], v[184:187], v[40:43]
  ds_read_b128 v[168:171], v14 offset:6144
  s_waitcnt lgkmcnt(4)
  v_mfma_f32_16x16x32_bf16 v[44:47], v[160:163], v[172:175], v[44:47]
  v_mfma_f32_16x16x32_bf16 v[48:51], v[160:163], v[176:179], v[48:51]
  v_mfma_f32_16x16x32_bf16 v[52:55], v[160:163], v[180:183], v[52:55]
  v_mfma_f32_16x16x32_bf16 v[56:59], v[160:163], v[184:187], v[56:59]
  ds_read_b128 v[156:159], v14 offset:8192
  ds_read_b64_tr_b16 v[192:193], v17 offset:16384
  ds_read_b64_tr_b16 v[194:195], v17 offset:18432
  s_waitcnt lgkmcnt(6)
  v_mfma_f32_16x16x32_bf16 v[60:63], v[164:167], v[172:175], v[60:63]
  v_mfma_f32_16x16x32_bf16 v[64:67], v[164:167], v[176:179], v[64:67]
  v_mfma_f32_16x16x32_bf16 v[68:71], v[164:167], v[180:183], v[68:71]
  v_mfma_f32_16x16x32_bf16 v[72:75], v[164:167], v[184:187], v[72:75]
  ds_read_b128 v[160:163], v14 offset:10240
  s_waitcnt lgkmcnt(4)
  v_mfma_f32_16x16x32_bf16 v[76:79], v[168:171], v[172:175], v[76:79]
  v_mfma_f32_16x16x32_bf16 v[80:83], v[168:171], v[176:179], v[80:83]
  v_mfma_f32_16x16x32_bf16 v[84:87], v[168:171], v[180:183], v[84:87]
  ds_read_b64_tr_b16 v[196:197], v18 offset:16384
  ds_read_b64_tr_b16 v[198:199], v18 offset:18432
  v_mfma_f32_16x16x32_bf16 v[88:91], v[168:171], v[184:187], v[88:91]
  ds_read_b128 v[164:167], v14 offset:12288
  s_waitcnt lgkmcnt(6)
  v_mfma_f32_16x16x32_bf16 v[92:95], v[156:159], v[172:175], v[92:95]
  v_mfma_f32_16x16x32_bf16 v[96:99], v[156:159], v[176:179], v[96:99]
  v_mfma_f32_16x16x32_bf16 v[100:103], v[156:159], v[180:183], v[100:103]
  v_mfma_f32_16x16x32_bf16 v[104:107], v[156:159], v[184:187], v[104:107]
  ds_read_b128 v[168:171], v14 offset:14336
  s_waitcnt lgkmcnt(4)
  v_mfma_f32_16x16x32_bf16 v[108:111], v[160:163], v[172:175], v[108:111]
  v_mfma_f32_16x16x32_bf16 v[112:115], v[160:163], v[176:179], v[112:115]
  ds_read_b64_tr_b16 v[200:201], v19 offset:16384
  ds_read_b64_tr_b16 v[202:203], v19 offset:18432
  v_mfma_f32_16x16x32_bf16 v[116:119], v[160:163], v[180:183], v[116:119]
  v_mfma_f32_16x16x32_bf16 v[120:123], v[160:163], v[184:187], v[120:123]
  ds_read_b128 v[156:159], v15 offset:0
  s_waitcnt lgkmcnt(4)
  v_mfma_f32_16x16x32_bf16 v[124:127], v[164:167], v[172:175], v[124:127]
  v_mfma_f32_16x16x32_bf16 v[128:131], v[164:167], v[176:179], v[128:131]
  v_mfma_f32_16x16x32_bf16 v[132:135], v[164:167], v[180:183], v[132:135]
  v_mfma_f32_16x16x32_bf16 v[136:139], v[164:167], v[184:187], v[136:139]
  ds_read_b128 v[160:163], v15 offset:2048
  s_waitcnt lgkmcnt(4)
  v_mfma_f32_16x16x32_bf16 v[140:143], v[168:171], v[172:175], v[140:143]
  v_mfma_f32_16x16x32_bf16 v[144:147], v[168:171], v[176:179], v[144:147]
  v_mfma_f32_16x16x32_bf16 v[148:151], v[168:171], v[180:183], v[148:151]
  v_mfma_f32_16x16x32_bf16 v[152:155], v[168:171], v[184:187], v[152:155]
  ds_read_b128 v[164:167], v15 offset:4096
  s_waitcnt lgkmcnt(2)
  v_mfma_f32_16x16x32_bf16 v[28:31], v[156:159], v[188:191], v[28:31]
  v_mfma_f32_16x16x32_bf16 v[32:35], v[156:159], v[192:195], v[32:35]
  v_mfma_f32_16x16x32_bf16 v[36:39], v[156:159], v[196:199], v[36:39]
  v_mfma_f32_16x16x32_bf16 v[40:43], v[156:159], v[200:203], v[40:43]
  ds_read_b128 v[168:171], v15 offset:6144
  s_waitcnt lgkmcnt(2)
  v_mfma_f32_16x16x32_bf16 v[44:47], v[160:163], v[188:191], v[44:47]
  v_mfma_f32_16x16x32_bf16 v[48:51], v[160:163], v[192:195], v[48:51]
  v_mfma_f32_16x16x32_bf16 v[52:55], v[160:163], v[196:199], v[52:55]
  v_mfma_f32_16x16x32_bf16 v[56:59], v[160:163], v[200:203], v[56:59]
  ds_read_b128 v[156:159], v15 offset:8192
  s_waitcnt lgkmcnt(2)
  v_mfma_f32_16x16x32_bf16 v[60:63], v[164:167], v[188:191], v[60:63]
  v_mfma_f32_16x16x32_bf16 v[64:67], v[164:167], v[192:195], v[64:67]
  v_mfma_f32_16x16x32_bf16 v[68:71], v[164:167], v[196:199], v[68:71]
  v_mfma_f32_16x16x32_bf16 v[72:75], v[164:167], v[200:203], v[72:75]
  ds_read_b128 v[160:163], v15 offset:10240
  s_waitcnt lgkmcnt(2)
  v_mfma_f32_16x16x32_bf16 v[76:79], v[168:171], v[188:191], v[76:79]
  v_mfma_f32_16x16x32_bf16 v[80:83], v[168:171], v[192:195], v[80:83]
  v_mfma_f32_16x16x32_bf16 v[84:87], v[168:171], v[196:199], v[84:87]
  v_mfma_f32_16x16x32_bf16 v[88:91], v[168:171], v[200:203], v[88:91]
  ds_read_b128 v[164:167], v15 offset:12288
  s_waitcnt lgkmcnt(2)
  v_mfma_f32_16x16x32_bf16 v[92:95], v[156:159], v[188:191], v[92:95]
  v_mfma_f32_16x16x32_bf16 v[96:99], v[156:159], v[192:195], v[96:99]
  v_mfma_f32_16x16x32_bf16 v[100:103], v[156:159], v[196:199], v[100:103]
  v_mfma_f32_16x16x32_bf16 v[104:107], v[156:159], v[200:203], v[104:107]
  ds_read_b128 v[168:171], v15 offset:14336
  s_waitcnt lgkmcnt(2)
  v_mfma_f32_16x16x32_bf16 v[108:111], v[160:163], v[188:191], v[108:111]
  v_mfma_f32_16x16x32_bf16 v[112:115], v[160:163], v[192:195], v[112:115]
  v_mfma_f32_16x16x32_bf16 v[116:119], v[160:163], v[196:199], v[116:119]
  v_mfma_f32_16x16x32_bf16 v[120:123], v[160:163], v[200:203], v[120:123]
  s_mov_b32 s33, 2
kvproj_kernel_loop3:
  s_waitcnt vmcnt(0) lgkmcnt(0)
  s_barrier
  v_subrev_u32 v14, 0x8000, v14
  v_subrev_u32 v15, 0x8000, v15
  v_subrev_u32 v16, 0x8000, v16
  v_subrev_u32 v17, 0x8000, v17
  v_subrev_u32 v18, 0x8000, v18
  v_subrev_u32 v19, 0x8000, v19
  ds_read_b64_tr_b16 v[172:173], v16 offset:0
  ds_read_b64_tr_b16 v[174:175], v16 offset:2048
  ds_read_b128 v[156:159], v14 offset:0
  ds_read_b64_tr_b16 v[176:177], v17 offset:0
  ds_read_b64_tr_b16 v[178:179], v17 offset:2048
  ds_read_b64_tr_b16 v[180:181], v18 offset:0
  ds_read_b64_tr_b16 v[182:183], v18 offset:2048
  ds_read_b64_tr_b16 v[184:185], v19 offset:0
  ds_read_b64_tr_b16 v[186:187], v19 offset:2048
  v_mfma_f32_16x16x32_bf16 v[124:127], v[164:167], v[188:191], v[124:127]
  s_add_u32 m0, s21, 0x8000
  s_nop 0
  buffer_load_dwordx4 v5, s[4:7], s30 offen lds
  v_mfma_f32_16x16x32_bf16 v[128:131], v[164:167], v[192:195], v[128:131]
  s_add_u32 m0, s21, 0xa000
  s_nop 0
  buffer_load_dwordx4 v6, s[4:7], s30 offen lds
  v_mfma_f32_16x16x32_bf16 v[132:135], v[164:167], v[196:199], v[132:135]
  s_add_u32 m0, s21, 0xc000
  s_nop 0
  buffer_load_dwordx4 v7, s[4:7], s30 offen lds
  v_mfma_f32_16x16x32_bf16 v[136:139], v[164:167], v[200:203], v[136:139]
  s_add_u32 m0, s21, 0xe000
  s_nop 0
  buffer_load_dwordx4 v8, s[4:7], s30 offen lds
  s_add_u32 s30, s30, 128
  ds_read_b128 v[160:163], v14 offset:2048
  v_mfma_f32_16x16x32_bf16 v[140:143], v[168:171], v[188:191], v[140:143]
  s_add_u32 m0, s21, 0x18000
  s_nop 0
  buffer_load_dwordx4 v9, s[8:11], s31 offen lds
  v_mfma_f32_16x16x32_bf16 v[144:147], v[168:171], v[192:195], v[144:147]
  s_add_u32 m0, s21, 0x1a000
  s_nop 0
  buffer_load_dwordx4 v10, s[8:11], s31 offen lds
  v_mfma_f32_16x16x32_bf16 v[148:151], v[168:171], v[196:199], v[148:151]
  s_add_u32 m0, s21, 0x1c000
  s_nop 0
  buffer_load_dwordx4 v11, s[8:11], s31 offen lds
  v_mfma_f32_16x16x32_bf16 v[152:155], v[168:171], v[200:203], v[152:155]
  s_add_u32 m0, s21, 0x1e000
  s_nop 0
  buffer_load_dwordx4 v12, s[8:11], s31 offen lds
  s_add_u32 s31, s31, 0x80000
  ds_read_b128 v[164:167], v14 offset:4096
  s_waitcnt lgkmcnt(8)
  v_mfma_f32_16x16x32_bf16 v[28:31], v[156:159], v[172:175], v[28:31]
  ds_read_b64_tr_b16 v[188:189], v16 offset:16384
  ds_read_b64_tr_b16 v[190:191], v16 offset:18432
  s_waitcnt lgkmcnt(8)
  v_mfma_f32_16x16x32_bf16 v[32:35], v[156:159], v[176:179], v[32:35]
  s_waitcnt lgkmcnt(6)
  v_mfma_f32_16x16x32_bf16 v[36:39], v[156:159], v[180:183], v[36:39]
  s_waitcnt lgkmcnt(4)
  v_mfma_f32_16x16x32_bf16 v[40:43], v[156:159], v[184:187], v[40:43]
  ds_read_b128 v[168:171], v14 offset:6144
  s_waitcnt lgkmcnt(4)
  v_mfma_f32_16x16x32_bf16 v[44:47], v[160:163], v[172:175], v[44:47]
  v_mfma_f32_16x16x32_bf16 v[48:51], v[160:163], v[176:179], v[48:51]
  v_mfma_f32_16x16x32_bf16 v[52:55], v[160:163], v[180:183], v[52:55]
  v_mfma_f32_16x16x32_bf16 v[56:59], v[160:163], v[184:187], v[56:59]
  ds_read_b128 v[156:159], v14 offset:8192
  ds_read_b64_tr_b16 v[192:193], v17 offset:16384
  ds_read_b64_tr_b16 v[194:195], v17 offset:18432
  s_waitcnt lgkmcnt(6)
  v_mfma_f32_16x16x32_bf16 v[60:63], v[164:167], v[172:175], v[60:63]
  v_mfma_f32_16x16x32_bf16 v[64:67], v[164:167], v[176:179], v[64:67]
  v_mfma_f32_16x16x32_bf16 v[68:71], v[164:167], v[180:183], v[68:71]
  v_mfma_f32_16x16x32_bf16 v[72:75], v[164:167], v[184:187], v[72:75]
  ds_read_b128 v[160:163], v14 offset:10240
  s_waitcnt lgkmcnt(4)
  v_mfma_f32_16x16x32_bf16 v[76:79], v[168:171], v[172:175], v[76:79]
  v_mfma_f32_16x16x32_bf16 v[80:83], v[168:171], v[176:179], v[80:83]
  v_mfma_f32_16x16x32_bf16 v[84:87], v[168:171], v[180:183], v[84:87]
  ds_read_b64_tr_b16 v[196:197], v18 offset:16384
  ds_read_b64_tr_b16 v[198:199], v18 offset:18432
  v_mfma_f32_16x16x32_bf16 v[88:91], v[168:171], v[184:187], v[88:91]
  ds_read_b128 v[164:167], v14 offset:12288
  s_waitcnt lgkmcnt(6)
  v_mfma_f32_16x16x32_bf16 v[92:95], v[156:159], v[172:175], v[92:95]
  v_mfma_f32_16x16x32_bf16 v[96:99], v[156:159], v[176:179], v[96:99]
  v_mfma_f32_16x16x32_bf16 v[100:103], v[156:159], v[180:183], v[100:103]
  v_mfma_f32_16x16x32_bf16 v[104:107], v[156:159], v[184:187], v[104:107]
  ds_read_b128 v[168:171], v14 offset:14336
  s_waitcnt lgkmcnt(4)
  v_mfma_f32_16x16x32_bf16 v[108:111], v[160:163], v[172:175], v[108:111]
  v_mfma_f32_16x16x32_bf16 v[112:115], v[160:163], v[176:179], v[112:115]
  ds_read_b64_tr_b16 v[200:201], v19 offset:16384
  ds_read_b64_tr_b16 v[202:203], v19 offset:18432
  v_mfma_f32_16x16x32_bf16 v[116:119], v[160:163], v[180:183], v[116:119]
  v_mfma_f32_16x16x32_bf16 v[120:123], v[160:163], v[184:187], v[120:123]
  ds_read_b128 v[156:159], v15 offset:0
  s_waitcnt lgkmcnt(4)
  v_mfma_f32_16x16x32_bf16 v[124:127], v[164:167], v[172:175], v[124:127]
  v_mfma_f32_16x16x32_bf16 v[128:131], v[164:167], v[176:179], v[128:131]
  v_mfma_f32_16x16x32_bf16 v[132:135], v[164:167], v[180:183], v[132:135]
  v_mfma_f32_16x16x32_bf16 v[136:139], v[164:167], v[184:187], v[136:139]
  ds_read_b128 v[160:163], v15 offset:2048
  s_waitcnt lgkmcnt(4)
  v_mfma_f32_16x16x32_bf16 v[140:143], v[168:171], v[172:175], v[140:143]
  v_mfma_f32_16x16x32_bf16 v[144:147], v[168:171], v[176:179], v[144:147]
  v_mfma_f32_16x16x32_bf16 v[148:151], v[168:171], v[180:183], v[148:151]
  v_mfma_f32_16x16x32_bf16 v[152:155], v[168:171], v[184:187], v[152:155]
  ds_read_b128 v[164:167], v15 offset:4096
  s_waitcnt lgkmcnt(2)
  v_mfma_f32_16x16x32_bf16 v[28:31], v[156:159], v[188:191], v[28:31]
  v_mfma_f32_16x16x32_bf16 v[32:35], v[156:159], v[192:195], v[32:35]
  v_mfma_f32_16x16x32_bf16 v[36:39], v[156:159], v[196:199], v[36:39]
  v_mfma_f32_16x16x32_bf16 v[40:43], v[156:159], v[200:203], v[40:43]
  ds_read_b128 v[168:171], v15 offset:6144
  s_waitcnt lgkmcnt(2)
  v_mfma_f32_16x16x32_bf16 v[44:47], v[160:163], v[188:191], v[44:47]
  v_mfma_f32_16x16x32_bf16 v[48:51], v[160:163], v[192:195], v[48:51]
  v_mfma_f32_16x16x32_bf16 v[52:55], v[160:163], v[196:199], v[52:55]
  v_mfma_f32_16x16x32_bf16 v[56:59], v[160:163], v[200:203], v[56:59]
  ds_read_b128 v[156:159], v15 offset:8192
  s_waitcnt lgkmcnt(2)
  v_mfma_f32_16x16x32_bf16 v[60:63], v[164:167], v[188:191], v[60:63]
  v_mfma_f32_16x16x32_bf16 v[64:67], v[164:167], v[192:195], v[64:67]
  v_mfma_f32_16x16x32_bf16 v[68:71], v[164:167], v[196:199], v[68:71]
  v_mfma_f32_16x16x32_bf16 v[72:75], v[164:167], v[200:203], v[72:75]
  ds_read_b128 v[160:163], v15 offset:10240
  s_waitcnt lgkmcnt(2)
  v_mfma_f32_16x16x32_bf16 v[76:79], v[168:171], v[188:191], v[76:79]
  v_mfma_f32_16x16x32_bf16 v[80:83], v[168:171], v[192:195], v[80:83]
  v_mfma_f32_16x16x32_bf16 v[84:87], v[168:171], v[196:199], v[84:87]
  v_mfma_f32_16x16x32_bf16 v[88:91], v[168:171], v[200:203], v[88:91]
  ds_read_b128 v[164:167], v15 offset:12288
  s_waitcnt lgkmcnt(2)
  v_mfma_f32_16x16x32_bf16 v[92:95], v[156:159], v[188:191], v[92:95]
  v_mfma_f32_16x16x32_bf16 v[96:99], v[156:159], v[192:195], v[96:99]
  v_mfma_f32_16x16x32_bf16 v[100:103], v[156:159], v[196:199], v[100:103]
  v_mfma_f32_16x16x32_bf16 v[104:107], v[156:159], v[200:203], v[104:107]
  ds_read_b128 v[168:171], v15 offset:14336
  s_waitcnt lgkmcnt(2)
  v_mfma_f32_16x16x32_bf16 v[108:111], v[160:163], v[188:191], v[108:111]
  v_mfma_f32_16x16x32_bf16 v[112:115], v[160:163], v[192:195], v[112:115]
  v_mfma_f32_16x16x32_bf16 v[116:119], v[160:163], v[196:199], v[116:119]
  v_mfma_f32_16x16x32_bf16 v[120:123], v[160:163], v[200:203], v[120:123]
  s_waitcnt vmcnt(0) lgkmcnt(0)
  s_barrier
  v_add_u32 v14, 0x8000, v14
  v_add_u32 v15, 0x8000, v15
  v_add_u32 v16, 0x8000, v16
  v_add_u32 v17, 0x8000, v17
  v_add_u32 v18, 0x8000, v18
  v_add_u32 v19, 0x8000, v19
  ds_read_b64_tr_b16 v[172:173], v16 offset:0
  ds_read_b64_tr_b16 v[174:175], v16 offset:2048
  ds_read_b128 v[156:159], v14 offset:0
  ds_read_b64_tr_b16 v[176:177], v17 offset:0
  ds_read_b64_tr_b16 v[178:179], v17 offset:2048
  ds_read_b64_tr_b16 v[180:181], v18 offset:0
  ds_read_b64_tr_b16 v[182:183], v18 offset:2048
  ds_read_b64_tr_b16 v[184:185], v19 offset:0
  ds_read_b64_tr_b16 v[186:187], v19 offset:2048
  v_mfma_f32_16x16x32_bf16 v[124:127], v[164:167], v[188:191], v[124:127]
  s_add_u32 m0, s21, 0x0
  s_nop 0
  buffer_load_dwordx4 v5, s[4:7], s30 offen lds
  v_mfma_f32_16x16x32_bf16 v[128:131], v[164:167], v[192:195], v[128:131]
  s_add_u32 m0, s21, 0x2000
  s_nop 0
  buffer_load_dwordx4 v6, s[4:7], s30 offen lds
  v_mfma_f32_16x16x32_bf16 v[132:135], v[164:167], v[196:199], v[132:135]
  s_add_u32 m0, s21, 0x4000
  s_nop 0
  buffer_load_dwordx4 v7, s[4:7], s30 offen lds
  v_mfma_f32_16x16x32_bf16 v[136:139], v[164:167], v[200:203], v[136:139]
  s_add_u32 m0, s21, 0x6000
  s_nop 0
  buffer_load_dwordx4 v8, s[4:7], s30 offen lds
  s_add_u32 s30, s30, 128
  ds_read_b128 v[160:163], v14 offset:2048
  v_mfma_f32_16x16x32_bf16 v[140:143], v[168:171], v[188:191], v[140:143]
  s_add_u32 m0, s21, 0x10000
  s_nop 0
  buffer_load_dwordx4 v9, s[8:11], s31 offen lds
  v_mfma_f32_16x16x32_bf16 v[144:147], v[168:171], v[192:195], v[144:147]
  s_add_u32 m0, s21, 0x12000
  s_nop 0
  buffer_load_dwordx4 v10, s[8:11], s31 offen lds
  v_mfma_f32_16x16x32_bf16 v[148:151], v[168:171], v[196:199], v[148:151]
  s_add_u32 m0, s21, 0x14000
  s_nop 0
  buffer_load_dwordx4 v11, s[8:11], s31 offen lds
  v_mfma_f32_16x16x32_bf16 v[152:155], v[168:171], v[200:203], v[152:155]
  s_add_u32 m0, s21, 0x16000
  s_nop 0
  buffer_load_dwordx4 v12, s[8:11], s31 offen lds
  s_add_u32 s31, s31, 0x80000
  ds_read_b128 v[164:167], v14 offset:4096
  s_waitcnt lgkmcnt(8)
  v_mfma_f32_16x16x32_bf16 v[28:31], v[156:159], v[172:175], v[28:31]
  ds_read_b64_tr_b16 v[188:189], v16 offset:16384
  ds_read_b64_tr_b16 v[190:191], v16 offset:18432
  s_waitcnt lgkmcnt(8)
  v_mfma_f32_16x16x32_bf16 v[32:35], v[156:159], v[176:179], v[32:35]
  s_waitcnt lgkmcnt(6)
  v_mfma_f32_16x16x32_bf16 v[36:39], v[156:159], v[180:183], v[36:39]
  s_waitcnt lgkmcnt(4)
  v_mfma_f32_16x16x32_bf16 v[40:43], v[156:159], v[184:187], v[40:43]
  ds_read_b128 v[168:171], v14 offset:6144
  s_waitcnt lgkmcnt(4)
  v_mfma_f32_16x16x32_bf16 v[44:47], v[160:163], v[172:175], v[44:47]
  v_mfma_f32_16x16x32_bf16 v[48:51], v[160:163], v[176:179], v[48:51]
  v_mfma_f32_16x16x32_bf16 v[52:55], v[160:163], v[180:183], v[52:55]
  v_mfma_f32_16x16x32_bf16 v[56:59], v[160:163], v[184:187], v[56:59]
  ds_read_b128 v[156:159], v14 offset:8192
  ds_read_b64_tr_b16 v[192:193], v17 offset:16384
  ds_read_b64_tr_b16 v[194:195], v17 offset:18432
  s_waitcnt lgkmcnt(6)
  v_mfma_f32_16x16x32_bf16 v[60:63], v[164:167], v[172:175], v[60:63]
  v_mfma_f32_16x16x32_bf16 v[64:67], v[164:167], v[176:179], v[64:67]
  v_mfma_f32_16x16x32_bf16 v[68:71], v[164:167], v[180:183], v[68:71]
  v_mfma_f32_16x16x32_bf16 v[72:75], v[164:167], v[184:187], v[72:75]
  ds_read_b128 v[160:163], v14 offset:10240
  s_waitcnt lgkmcnt(4)
  v_mfma_f32_16x16x32_bf16 v[76:79], v[168:171], v[172:175], v[76:79]
  v_mfma_f32_16x16x32_bf16 v[80:83], v[168:171], v[176:179], v[80:83]
  v_mfma_f32_16x16x32_bf16 v[84:87], v[168:171], v[180:183], v[84:87]
  ds_read_b64_tr_b16 v[196:197], v18 offset:16384
  ds_read_b64_tr_b16 v[198:199], v18 offset:18432
  v_mfma_f32_16x16x32_bf16 v[88:91], v[168:171], v[184:187], v[88:91]
  ds_read_b128 v[164:167], v14 offset:12288
  s_waitcnt lgkmcnt(6)
  v_mfma_f32_16x16x32_bf16 v[92:95], v[156:159], v[172:175], v[92:95]
  v_mfma_f32_16x16x32_bf16 v[96:99], v[156:159], v[176:179], v[96:99]
  v_mfma_f32_16x16x32_bf16 v[100:103], v[156:159], v[180:183], v[100:103]
  v_mfma_f32_16x16x32_bf16 v[104:107], v[156:159], v[184:187], v[104:107]
  ds_read_b128 v[168:171], v14 offset:14336
  s_waitcnt lgkmcnt(4)
  v_mfma_f32_16x16x32_bf16 v[108:111], v[160:163], v[172:175], v[108:111]
  v_mfma_f32_16x16x32_bf16 v[112:115], v[160:163], v[176:179], v[112:115]
  ds_read_b64_tr_b16 v[200:201], v19 offset:16384
  ds_read_b64_tr_b16 v[202:203], v19 offset:18432
  v_mfma_f32_16x16x32_bf16 v[116:119], v[160:163], v[180:183], v[116:119]
  v_mfma_f32_16x16x32_bf16 v[120:123], v[160:163], v[184:187], v[120:123]
  ds_read_b128 v[156:159], v15 offset:0
  s_waitcnt lgkmcnt(4)
  v_mfma_f32_16x16x32_bf16 v[124:127], v[164:167], v[172:175], v[124:127]
  v_mfma_f32_16x16x32_bf16 v[128:131], v[164:167], v[176:179], v[128:131]
  v_mfma_f32_16x16x32_bf16 v[132:135], v[164:167], v[180:183], v[132:135]
  v_mfma_f32_16x16x32_bf16 v[136:139], v[164:167], v[184:187], v[136:139]
  ds_read_b128 v[160:163], v15 offset:2048
  s_waitcnt lgkmcnt(4)
  v_mfma_f32_16x16x32_bf16 v[140:143], v[168:171], v[172:175], v[140:143]
  v_mfma_f32_16x16x32_bf16 v[144:147], v[168:171], v[176:179], v[144:147]
  v_mfma_f32_16x16x32_bf16 v[148:151], v[168:171], v[180:183], v[148:151]
  v_mfma_f32_16x16x32_bf16 v[152:155], v[168:171], v[184:187], v[152:155]
  ds_read_b128 v[164:167], v15 offset:4096
  s_waitcnt lgkmcnt(2)
  v_mfma_f32_16x16x32_bf16 v[28:31], v[156:159], v[188:191], v[28:31]
  v_mfma_f32_16x16x32_bf16 v[32:35], v[156:159], v[192:195], v[32:35]
  v_mfma_f32_16x16x32_bf16 v[36:39], v[156:159], v[196:199], v[36:39]
  v_mfma_f32_16x16x32_bf16 v[40:43], v[156:159], v[200:203], v[40:43]
  ds_read_b128 v[168:171], v15 offset:6144
  s_waitcnt lgkmcnt(2)
  v_mfma_f32_16x16x32_bf16 v[44:47], v[160:163], v[188:191], v[44:47]
  v_mfma_f32_16x16x32_bf16 v[48:51], v[160:163], v[192:195], v[48:51]
  v_mfma_f32_16x16x32_bf16 v[52:55], v[160:163], v[196:199], v[52:55]
  v_mfma_f32_16x16x32_bf16 v[56:59], v[160:163], v[200:203], v[56:59]
  ds_read_b128 v[156:159], v15 offset:8192
  s_waitcnt lgkmcnt(2)
  v_mfma_f32_16x16x32_bf16 v[60:63], v[164:167], v[188:191], v[60:63]
  v_mfma_f32_16x16x32_bf16 v[64:67], v[164:167], v[192:195], v[64:67]
  v_mfma_f32_16x16x32_bf16 v[68:71], v[164:167], v[196:199], v[68:71]
  v_mfma_f32_16x16x32_bf16 v[72:75], v[164:167], v[200:203], v[72:75]
  ds_read_b128 v[160:163], v15 offset:10240
  s_waitcnt lgkmcnt(2)
  v_mfma_f32_16x16x32_bf16 v[76:79], v[168:171], v[188:191], v[76:79]
  v_mfma_f32_16x16x32_bf16 v[80:83], v[168:171], v[192:195], v[80:83]
  v_mfma_f32_16x16x32_bf16 v[84:87], v[168:171], v[196:199], v[84:87]
  v_mfma_f32_16x16x32_bf16 v[88:91], v[168:171], v[200:203], v[88:91]
  ds_read_b128 v[164:167], v15 offset:12288
  s_waitcnt lgkmcnt(2)
  v_mfma_f32_16x16x32_bf16 v[92:95], v[156:159], v[188:191], v[92:95]
  v_mfma_f32_16x16x32_bf16 v[96:99], v[156:159], v[192:195], v[96:99]
  v_mfma_f32_16x16x32_bf16 v[100:103], v[156:159], v[196:199], v[100:103]
  v_mfma_f32_16x16x32_bf16 v[104:107], v[156:159], v[200:203], v[104:107]
  ds_read_b128 v[168:171], v15 offset:14336
  s_waitcnt lgkmcnt(2)
  v_mfma_f32_16x16x32_bf16 v[108:111], v[160:163], v[188:191], v[108:111]
  v_mfma_f32_16x16x32_bf16 v[112:115], v[160:163], v[192:195], v[112:115]
  v_mfma_f32_16x16x32_bf16 v[116:119], v[160:163], v[196:199], v[116:119]
  v_mfma_f32_16x16x32_bf16 v[120:123], v[160:163], v[200:203], v[120:123]
  s_sub_u32 s33, s33, 1
  s_cmp_lg_u32 s33, 0
  s_cbranch_scc1 kvproj_kernel_loop3
  s_waitcnt vmcnt(0) lgkmcnt(0)
  s_barrier
  v_subrev_u32 v14, 0x8000, v14
  v_subrev_u32 v15, 0x8000, v15
  v_subrev_u32 v16, 0x8000, v16
  v_subrev_u32 v17, 0x8000, v17
  v_subrev_u32 v18, 0x8000, v18
  v_subrev_u32 v19, 0x8000, v19
  ds_read_b64_tr_b16 v[172:173], v16 offset:0
  ds_read_b64_tr_b16 v[174:175], v16 offset:2048
  ds_read_b128 v[156:159], v14 offset:0
  ds_read_b64_tr_b16 v[176:177], v17 offset:0
  ds_read_b64_tr_b16 v[178:179], v17 offset:2048
  ds_read_b64_tr_b16 v[180:181], v18 offset:0
  ds_read_b64_tr_b16 v[182:183], v18 offset:2048
  ds_read_b64_tr_b16 v[184:185], v19 offset:0
  ds_read_b64_tr_b16 v[186:187], v19 offset:2048
  v_mfma_f32_16x16x32_bf16 v[124:127], v[164:167], v[188:191], v[124:127]
  s_add_u32 m0, s21, 0x8000
  s_nop 0
  buffer_load_dwordx4 v5, s[4:7], s30 offen lds
  v_mfma_f32_16x16x32_bf16 v[128:131], v[164:167], v[192:195], v[128:131]
  s_add_u32 m0, s21, 0xa000
  s_nop 0
  buffer_load_dwordx4 v6, s[4:7], s30 offen lds
  v_mfma_f32_16x16x32_bf16 v[132:135], v[164:167], v[196:199], v[132:135]
  s_add_u32 m0, s21, 0xc000
  s_nop 0
  buffer_load_dwordx4 v7, s[4:7], s30 offen lds
  v_mfma_f32_16x16x32_bf16 v[136:139], v[164:167], v[200:203], v[136:139]
  s_add_u32 m0, s21, 0xe000
  s_nop 0
  buffer_load_dwordx4 v8, s[4:7], s30 offen lds
  s_add_u32 s30, s30, 128
  ds_read_b128 v[160:163], v14 offset:2048
  v_mfma_f32_16x16x32_bf16 v[140:143], v[168:171], v[188:191], v[140:143]
  s_add_u32 m0, s21, 0x18000
  s_nop 0
  buffer_load_dwordx4 v9, s[8:11], s31 offen lds
  v_mfma_f32_16x16x32_bf16 v[144:147], v[168:171], v[192:195], v[144:147]
  s_add_u32 m0, s21, 0x1a000
  s_nop 0
  buffer_load_dwordx4 v10, s[8:11], s31 offen lds
  v_mfma_f32_16x16x32_bf16 v[148:151], v[168:171], v[196:199], v[148:151]
  s_add_u32 m0, s21, 0x1c000
  s_nop 0
  buffer_load_dwordx4 v11, s[8:11], s31 offen lds
  v_mfma_f32_16x16x32_bf16 v[152:155], v[168:171], v[200:203], v[152:155]
  s_add_u32 m0, s21, 0x1e000
  s_nop 0
  buffer_load_dwordx4 v12, s[8:11], s31 offen lds
  s_add_u32 s31, s31, 0x80000
  ds_read_b128 v[164:167], v14 offset:4096
  s_waitcnt lgkmcnt(8)
  v_mfma_f32_16x16x32_bf16 v[28:31], v[156:159], v[172:175], v[28:31]
  ds_read_b64_tr_b16 v[188:189], v16 offset:16384
  ds_read_b64_tr_b16 v[190:191], v16 offset:18432
  s_waitcnt lgkmcnt(8)
  v_mfma_f32_16x16x32_bf16 v[32:35], v[156:159], v[176:179], v[32:35]
  s_waitcnt lgkmcnt(6)
  v_mfma_f32_16x16x32_bf16 v[36:39], v[156:159], v[180:183], v[36:39]
  s_waitcnt lgkmcnt(4)
  v_mfma_f32_16x16x32_bf16 v[40:43], v[156:159], v[184:187], v[40:43]
  ds_read_b128 v[168:171], v14 offset:6144
  s_waitcnt lgkmcnt(4)
  v_mfma_f32_16x16x32_bf16 v[44:47], v[160:163], v[172:175], v[44:47]
  v_mfma_f32_16x16x32_bf16 v[48:51], v[160:163], v[176:179], v[48:51]
  v_mfma_f32_16x16x32_bf16 v[52:55], v[160:163], v[180:183], v[52:55]
  v_mfma_f32_16x16x32_bf16 v[56:59], v[160:163], v[184:187], v[56:59]
  ds_read_b128 v[156:159], v14 offset:8192
  ds_read_b64_tr_b16 v[192:193], v17 offset:16384
  ds_read_b64_tr_b16 v[194:195], v17 offset:18432
  s_waitcnt lgkmcnt(6)
  v_mfma_f32_16x16x32_bf16 v[60:63], v[164:167], v[172:175], v[60:63]
  v_mfma_f32_16x16x32_bf16 v[64:67], v[164:167], v[176:179], v[64:67]
  v_mfma_f32_16x16x32_bf16 v[68:71], v[164:167], v[180:183], v[68:71]
  v_mfma_f32_16x16x32_bf16 v[72:75], v[164:167], v[184:187], v[72:75]
  ds_read_b128 v[160:163], v14 offset:10240
  s_waitcnt lgkmcnt(4)
  v_mfma_f32_16x16x32_bf16 v[76:79], v[168:171], v[172:175], v[76:79]
  v_mfma_f32_16x16x32_bf16 v[80:83], v[168:171], v[176:179], v[80:83]
  v_mfma_f32_16x16x32_bf16 v[84:87], v[168:171], v[180:183], v[84:87]
  ds_read_b64_tr_b16 v[196:197], v18 offset:16384
  ds_read_b64_tr_b16 v[198:199], v18 offset:18432
  v_mfma_f32_16x16x32_bf16 v[88:91], v[168:171], v[184:187], v[88:91]
  ds_read_b128 v[164:167], v14 offset:12288
  s_waitcnt lgkmcnt(6)
  v_mfma_f32_16x16x32_bf16 v[92:95], v[156:159], v[172:175], v[92:95]
  v_mfma_f32_16x16x32_bf16 v[96:99], v[156:159], v[176:179], v[96:99]
  v_mfma_f32_16x16x32_bf16 v[100:103], v[156:159], v[180:183], v[100:103]
  v_mfma_f32_16x16x32_bf16 v[104:107], v[156:159], v[184:187], v[104:107]
  ds_read_b128 v[168:171], v14 offset:14336
  s_waitcnt lgkmcnt(4)
  v_mfma_f32_16x16x32_bf16 v[108:111], v[160:163], v[172:175], v[108:111]
  v_mfma_f32_16x16x32_bf16 v[112:115], v[160:163], v[176:179], v[112:115]
  ds_read_b64_tr_b16 v[200:201], v19 offset:16384
  ds_read_b64_tr_b16 v[202:203], v19 offset:18432
  v_mfma_f32_16x16x32_bf16 v[116:119], v[160:163], v[180:183], v[116:119]
  v_mfma_f32_16x16x32_bf16 v[120:123], v[160:163], v[184:187], v[120:123]
  ds_read_b128 v[156:159], v15 offset:0
  s_waitcnt lgkmcnt(4)
  v_mfma_f32_16x16x32_bf16 v[124:127], v[164:167], v[172:175], v[124:127]
  v_mfma_f32_16x16x32_bf16 v[128:131], v[164:167], v[176:179], v[128:131]
  v_mfma_f32_16x16x32_bf16 v[132:135], v[164:167], v[180:183], v[132:135]
  v_mfma_f32_16x16x32_bf16 v[136:139], v[164:167], v[184:187], v[136:139]
  ds_read_b128 v[160:163], v15 offset:2048
  s_waitcnt lgkmcnt(4)
  v_mfma_f32_16x16x32_bf16 v[140:143], v[168:171], v[172:175], v[140:143]
  v_mfma_f32_16x16x32_bf16 v[144:147], v[168:171], v[176:179], v[144:147]
  v_mfma_f32_16x16x32_bf16 v[148:151], v[168:171], v[180:183], v[148:151]
  v_mfma_f32_16x16x32_bf16 v[152:155], v[168:171], v[184:187], v[152:155]
  ds_read_b128 v[164:167], v15 offset:4096
  s_waitcnt lgkmcnt(2)
  v_mfma_f32_16x16x32_bf16 v[28:31], v[156:159], v[188:191], v[28:31]
  v_mfma_f32_16x16x32_bf16 v[32:35], v[156:159], v[192:195], v[32:35]
  v_mfma_f32_16x16x32_bf16 v[36:39], v[156:159], v[196:199], v[36:39]
  v_mfma_f32_16x16x32_bf16 v[40:43], v[156:159], v[200:203], v[40:43]
  ds_read_b128 v[168:171], v15 offset:6144
  s_waitcnt lgkmcnt(2)
  v_mfma_f32_16x16x32_bf16 v[44:47], v[160:163], v[188:191], v[44:47]
  v_mfma_f32_16x16x32_bf16 v[48:51], v[160:163], v[192:195], v[48:51]
  v_mfma_f32_16x16x32_bf16 v[52:55], v[160:163], v[196:199], v[52:55]
  v_mfma_f32_16x16x32_bf16 v[56:59], v[160:163], v[200:203], v[56:59]
  ds_read_b128 v[156:159], v15 offset:8192
  s_waitcnt lgkmcnt(2)
  v_mfma_f32_16x16x32_bf16 v[60:63], v[164:167], v[188:191], v[60:63]
  v_mfma_f32_16x16x32_bf16 v[64:67], v[164:167], v[192:195], v[64:67]
  v_mfma_f32_16x16x32_bf16 v[68:71], v[164:167], v[196:199], v[68:71]
  v_mfma_f32_16x16x32_bf16 v[72:75], v[164:167], v[200:203], v[72:75]
  ds_read_b128 v[160:163], v15 offset:10240
  s_waitcnt lgkmcnt(2)
  v_mfma_f32_16x16x32_bf16 v[76:79], v[168:171], v[188:191], v[76:79]
  v_mfma_f32_16x16x32_bf16 v[80:83], v[168:171], v[192:195], v[80:83]
  v_mfma_f32_16x16x32_bf16 v[84:87], v[168:171], v[196:199], v[84:87]
  v_mfma_f32_16x16x32_bf16 v[88:91], v[168:171], v[200:203], v[88:91]
  ds_read_b128 v[164:167], v15 offset:12288
  s_waitcnt lgkmcnt(2)
  v_mfma_f32_16x16x32_bf16 v[92:95], v[156:159], v[188:191], v[92:95]
  v_mfma_f32_16x16x32_bf16 v[96:99], v[156:159], v[192:195], v[96:99]
  v_mfma_f32_16x16x32_bf16 v[100:103], v[156:159], v[196:199], v[100:103]
  v_mfma_f32_16x16x32_bf16 v[104:107], v[156:159], v[200:203], v[104:107]
  ds_read_b128 v[168:171], v15 offset:14336
  s_waitcnt lgkmcnt(2)
  v_mfma_f32_16x16x32_bf16 v[108:111], v[160:163], v[188:191], v[108:111]
  v_mfma_f32_16x16x32_bf16 v[112:115], v[160:163], v[192:195], v[112:115]
  v_mfma_f32_16x16x32_bf16 v[116:119], v[160:163], v[196:199], v[116:119]
  v_mfma_f32_16x16x32_bf16 v[120:123], v[160:163], v[200:203], v[120:123]
  s_waitcnt vmcnt(0) lgkmcnt(0)
  s_barrier
  v_add_u32 v14, 0x8000, v14
  v_add_u32 v15, 0x8000, v15
  v_add_u32 v16, 0x8000, v16
  v_add_u32 v17, 0x8000, v17
  v_add_u32 v18, 0x8000, v18
  v_add_u32 v19, 0x8000, v19
  ds_read_b64_tr_b16 v[172:173], v16 offset:0
  ds_read_b64_tr_b16 v[174:175], v16 offset:2048
  ds_read_b128 v[156:159], v14 offset:0
  ds_read_b64_tr_b16 v[176:177], v17 offset:0
  ds_read_b64_tr_b16 v[178:179], v17 offset:2048
  ds_read_b64_tr_b16 v[180:181], v18 offset:0
  ds_read_b64_tr_b16 v[182:183], v18 offset:2048
  ds_read_b64_tr_b16 v[184:185], v19 offset:0
  ds_read_b64_tr_b16 v[186:187], v19 offset:2048
  v_mfma_f32_16x16x32_bf16 v[124:127], v[164:167], v[188:191], v[124:127]
  v_mfma_f32_16x16x32_bf16 v[128:131], v[164:167], v[192:195], v[128:131]
  v_mfma_f32_16x16x32_bf16 v[132:135], v[164:167], v[196:199], v[132:135]
  v_mfma_f32_16x16x32_bf16 v[136:139], v[164:167], v[200:203], v[136:139]
  ds_read_b128 v[160:163], v14 offset:2048
  v_mfma_f32_16x16x32_bf16 v[140:143], v[168:171], v[188:191], v[140:143]
  v_mfma_f32_16x16x32_bf16 v[144:147], v[168:171], v[192:195], v[144:147]
  v_mfma_f32_16x16x32_bf16 v[148:151], v[168:171], v[196:199], v[148:151]
  v_mfma_f32_16x16x32_bf16 v[152:155], v[168:171], v[200:203], v[152:155]
  ds_read_b128 v[164:167], v14 offset:4096
  s_waitcnt lgkmcnt(8)
  v_mfma_f32_16x16x32_bf16 v[28:31], v[156:159], v[172:175], v[28:31]
  ds_read_b64_tr_b16 v[188:189], v16 offset:16384
  ds_read_b64_tr_b16 v[190:191], v16 offset:18432
  s_waitcnt lgkmcnt(8)
  v_mfma_f32_16x16x32_bf16 v[32:35], v[156:159], v[176:179], v[32:35]
  s_waitcnt lgkmcnt(6)
  v_mfma_f32_16x16x32_bf16 v[36:39], v[156:159], v[180:183], v[36:39]
  s_waitcnt lgkmcnt(4)
  v_mfma_f32_16x16x32_bf16 v[40:43], v[156:159], v[184:187], v[40:43]
  ds_read_b128 v[168:171], v14 offset:6144
  s_waitcnt lgkmcnt(4)
  v_mfma_f32_16x16x32_bf16 v[44:47], v[160:163], v[172:175], v[44:47]
  v_mfma_f32_16x16x32_bf16 v[48:51], v[160:163], v[176:179], v[48:51]
  v_mfma_f32_16x16x32_bf16 v[52:55], v[160:163], v[180:183], v[52:55]
  v_mfma_f32_16x16x32_bf16 v[56:59], v[160:163], v[184:187], v[56:59]
  ds_read_b128 v[156:159], v14 offset:8192
  ds_read_b64_tr_b16 v[192:193], v17 offset:16384
  ds_read_b64_tr_b16 v[194:195], v17 offset:18432
  s_waitcnt lgkmcnt(6)
  v_mfma_f32_16x16x32_bf16 v[60:63], v[164:167], v[172:175], v[60:63]
  v_mfma_f32_16x16x32_bf16 v[64:67], v[164:167], v[176:179], v[64:67]
  v_mfma_f32_16x16x32_bf16 v[68:71], v[164:167], v[180:183], v[68:71]
  v_mfma_f32_16x16x32_bf16 v[72:75], v[164:167], v[184:187], v[72:75]
  ds_read_b128 v[160:163], v14 offset:10240
  s_waitcnt lgkmcnt(4)
  v_mfma_f32_16x16x32_bf16 v[76:79], v[168:171], v[172:175], v[76:79]
  v_mfma_f32_16x16x32_bf16 v[80:83], v[168:171], v[176:179], v[80:83]
  v_mfma_f32_16x16x32_bf16 v[84:87], v[168:171], v[180:183], v[84:87]
  ds_read_b64_tr_b16 v[196:197], v18 offset:16384
  ds_read_b64_tr_b16 v[198:199], v18 offset:18432
  v_mfma_f32_16x16x32_bf16 v[88:91], v[168:171], v[184:187], v[88:91]
  ds_read_b128 v[164:167], v14 offset:12288
  s_waitcnt lgkmcnt(6)
  v_mfma_f32_16x16x32_bf16 v[92:95], v[156:159], v[172:175], v[92:95]
  v_mfma_f32_16x16x32_bf16 v[96:99], v[156:159], v[176:179], v[96:99]
  v_mfma_f32_16x16x32_bf16 v[100:103], v[156:159], v[180:183], v[100:103]
  v_mfma_f32_16x16x32_bf16 v[104:107], v[156:159], v[184:187], v[104:107]
  ds_read_b128 v[168:171], v14 offset:14336
  s_waitcnt lgkmcnt(4)
  v_mfma_f32_16x16x32_bf16 v[108:111], v[160:163], v[172:175], v[108:111]
  v_mfma_f32_16x16x32_bf16 v[112:115], v[160:163], v[176:179], v[112:115]
  ds_read_b64_tr_b16 v[200:201], v19 offset:16384
  ds_read_b64_tr_b16 v[202:203], v19 offset:18432
  v_mfma_f32_16x16x32_bf16 v[116:119], v[160:163], v[180:183], v[116:119]
  v_mfma_f32_16x16x32_bf16 v[120:123], v[160:163], v[184:187], v[120:123]
  ds_read_b128 v[156:159], v15 offset:0
  s_waitcnt lgkmcnt(4)
  v_mfma_f32_16x16x32_bf16 v[124:127], v[164:167], v[172:175], v[124:127]
  v_mfma_f32_16x16x32_bf16 v[128:131], v[164:167], v[176:179], v[128:131]
  v_mfma_f32_16x16x32_bf16 v[132:135], v[164:167], v[180:183], v[132:135]
  v_mfma_f32_16x16x32_bf16 v[136:139], v[164:167], v[184:187], v[136:139]
  ds_read_b128 v[160:163], v15 offset:2048
  s_waitcnt lgkmcnt(4)
  v_mfma_f32_16x16x32_bf16 v[140:143], v[168:171], v[172:175], v[140:143]
  v_mfma_f32_16x16x32_bf16 v[144:147], v[168:171], v[176:179], v[144:147]
  v_mfma_f32_16x16x32_bf16 v[148:151], v[168:171], v[180:183], v[148:151]
  v_mfma_f32_16x16x32_bf16 v[152:155], v[168:171], v[184:187], v[152:155]
  ds_read_b128 v[164:167], v15 offset:4096
  s_waitcnt lgkmcnt(2)
  v_mfma_f32_16x16x32_bf16 v[28:31], v[156:159], v[188:191], v[28:31]
  v_mfma_f32_16x16x32_bf16 v[32:35], v[156:159], v[192:195], v[32:35]
  v_mfma_f32_16x16x32_bf16 v[36:39], v[156:159], v[196:199], v[36:39]
  v_mfma_f32_16x16x32_bf16 v[40:43], v[156:159], v[200:203], v[40:43]
  ds_read_b128 v[168:171], v15 offset:6144
  s_waitcnt lgkmcnt(2)
  v_mfma_f32_16x16x32_bf16 v[44:47], v[160:163], v[188:191], v[44:47]
  v_mfma_f32_16x16x32_bf16 v[48:51], v[160:163], v[192:195], v[48:51]
  v_mfma_f32_16x16x32_bf16 v[52:55], v[160:163], v[196:199], v[52:55]
  v_mfma_f32_16x16x32_bf16 v[56:59], v[160:163], v[200:203], v[56:59]
  ds_read_b128 v[156:159], v15 offset:8192
  s_waitcnt lgkmcnt(2)
  v_mfma_f32_16x16x32_bf16 v[60:63], v[164:167], v[188:191], v[60:63]
  v_mfma_f32_16x16x32_bf16 v[64:67], v[164:167], v[192:195], v[64:67]
  v_mfma_f32_16x16x32_bf16 v[68:71], v[164:167], v[196:199], v[68:71]
  v_mfma_f32_16x16x32_bf16 v[72:75], v[164:167], v[200:203], v[72:75]
  ds_read_b128 v[160:163], v15 offset:10240
  s_waitcnt lgkmcnt(2)
  v_mfma_f32_16x16x32_bf16 v[76:79], v[168:171], v[188:191], v[76:79]
  v_mfma_f32_16x16x32_bf16 v[80:83], v[168:171], v[192:195], v[80:83]
  v_mfma_f32_16x16x32_bf16 v[84:87], v[168:171], v[196:199], v[84:87]
  v_mfma_f32_16x16x32_bf16 v[88:91], v[168:171], v[200:203], v[88:91]
  ds_read_b128 v[164:167], v15 offset:12288
  s_waitcnt lgkmcnt(2)
  v_mfma_f32_16x16x32_bf16 v[92:95], v[156:159], v[188:191], v[92:95]
  v_mfma_f32_16x16x32_bf16 v[96:99], v[156:159], v[192:195], v[96:99]
  v_mfma_f32_16x16x32_bf16 v[100:103], v[156:159], v[196:199], v[100:103]
  v_mfma_f32_16x16x32_bf16 v[104:107], v[156:159], v[200:203], v[104:107]
  ds_read_b128 v[168:171], v15 offset:14336
  s_waitcnt lgkmcnt(2)
  v_mfma_f32_16x16x32_bf16 v[108:111], v[160:163], v[188:191], v[108:111]
  v_mfma_f32_16x16x32_bf16 v[112:115], v[160:163], v[192:195], v[112:115]
  v_mfma_f32_16x16x32_bf16 v[116:119], v[160:163], v[196:199], v[116:119]
  v_mfma_f32_16x16x32_bf16 v[120:123], v[160:163], v[200:203], v[120:123]
  s_waitcnt lgkmcnt(1)
  v_mfma_f32_16x16x32_bf16 v[124:127], v[164:167], v[188:191], v[124:127]
  v_mfma_f32_16x16x32_bf16 v[128:131], v[164:167], v[192:195], v[128:131]
  v_mfma_f32_16x16x32_bf16 v[132:135], v[164:167], v[196:199], v[132:135]
  v_mfma_f32_16x16x32_bf16 v[136:139], v[164:167], v[200:203], v[136:139]
  s_waitcnt lgkmcnt(0)
  v_mfma_f32_16x16x32_bf16 v[140:143], v[168:171], v[188:191], v[140:143]
  v_mfma_f32_16x16x32_bf16 v[144:147], v[168:171], v[192:195], v[144:147]
  v_mfma_f32_16x16x32_bf16 v[148:151], v[168:171], v[196:199], v[148:151]
  v_mfma_f32_16x16x32_bf16 v[152:155], v[168:171], v[200:203], v[152:155]
  s_nop 15
  v_and_b32 v2, 15, v1
  v_lshlrev_b32 v2, 12, v2
  v_lshl_add_u32 v2, v13, 4, v2
  s_mul_i32 s28, s22, 262144
  s_mul_i32 s29, s24, 256
  s_add_u32 s28, s28, s29
  v_add_u32 v2, s28, v2
  s_mov_b32 s28, 0x0
  v_cvt_pk_bf16_f32 v28, v28, v29
  v_cvt_pk_bf16_f32 v29, v30, v31
  v_cvt_pk_bf16_f32 v30, v44, v45
  v_cvt_pk_bf16_f32 v31, v46, v47
  buffer_store_dwordx4 v[28:31], v2, s[12:15], s28 offen offset:0 sc1
  v_cvt_pk_bf16_f32 v60, v60, v61
  v_cvt_pk_bf16_f32 v61, v62, v63
  v_cvt_pk_bf16_f32 v62, v76, v77
  v_cvt_pk_bf16_f32 v63, v78, v79
  buffer_store_dwordx4 v[60:63], v2, s[12:15], s28 offen offset:64 sc1
  v_cvt_pk_bf16_f32 v92, v92, v93
  v_cvt_pk_bf16_f32 v93, v94, v95
  v_cvt_pk_bf16_f32 v94, v108, v109
  v_cvt_pk_bf16_f32 v95, v110, v111
  buffer_store_dwordx4 v[92:95], v2, s[12:15], s28 offen offset:128 sc1
  v_cvt_pk_bf16_f32 v124, v124, v125
  v_cvt_pk_bf16_f32 v125, v126, v127
  v_cvt_pk_bf16_f32 v126, v140, v141
  v_cvt_pk_bf16_f32 v127, v142, v143
  buffer_store_dwordx4 v[124:127], v2, s[12:15], s28 offen offset:192 sc1
  s_mov_b32 s28, 0x10000
  v_cvt_pk_bf16_f32 v32, v32, v33
  v_cvt_pk_bf16_f32 v33, v34, v35
  v_cvt_pk_bf16_f32 v34, v48, v49
  v_cvt_pk_bf16_f32 v35, v50, v51
  buffer_store_dwordx4 v[32:35], v2, s[12:15], s28 offen offset:0 sc1
  v_cvt_pk_bf16_f32 v64, v64, v65
  v_cvt_pk_bf16_f32 v65, v66, v67
  v_cvt_pk_bf16_f32 v66, v80, v81
  v_cvt_pk_bf16_f32 v67, v82, v83
  buffer_store_dwordx4 v[64:67], v2, s[12:15], s28 offen offset:64 sc1
  v_cvt_pk_bf16_f32 v96, v96, v97
  v_cvt_pk_bf16_f32 v97, v98, v99
  v_cvt_pk_bf16_f32 v98, v112, v113
  v_cvt_pk_bf16_f32 v99, v114, v115
  buffer_store_dwordx4 v[96:99], v2, s[12:15], s28 offen offset:128 sc1
  v_cvt_pk_bf16_f32 v128, v128, v129
  v_cvt_pk_bf16_f32 v129, v130, v131
  v_cvt_pk_bf16_f32 v130, v144, v145
  v_cvt_pk_bf16_f32 v131, v146, v147
  buffer_store_dwordx4 v[128:131], v2, s[12:15], s28 offen offset:192 sc1
  s_mov_b32 s28, 0x20000
  v_cvt_pk_bf16_f32 v36, v36, v37
  v_cvt_pk_bf16_f32 v37, v38, v39
  v_cvt_pk_bf16_f32 v38, v52, v53
  v_cvt_pk_bf16_f32 v39, v54, v55
  buffer_store_dwordx4 v[36:39], v2, s[12:15], s28 offen offset:0 sc1
  v_cvt_pk_bf16_f32 v68, v68, v69
  v_cvt_pk_bf16_f32 v69, v70, v71
  v_cvt_pk_bf16_f32 v70, v84, v85
  v_cvt_pk_bf16_f32 v71, v86, v87
  buffer_store_dwordx4 v[68:71], v2, s[12:15], s28 offen offset:64 sc1
  v_cvt_pk_bf16_f32 v100, v100, v101
  v_cvt_pk_bf16_f32 v101, v102, v103
  v_cvt_pk_bf16_f32 v102, v116, v117
  v_cvt_pk_bf16_f32 v103, v118, v119
  buffer_store_dwordx4 v[100:103], v2, s[12:15], s28 offen offset:128 sc1
  v_cvt_pk_bf16_f32 v132, v132, v133
  v_cvt_pk_bf16_f32 v133, v134, v135
  v_cvt_pk_bf16_f32 v134, v148, v149
  v_cvt_pk_bf16_f32 v135, v150, v151
  buffer_store_dwordx4 v[132:135], v2, s[12:15], s28 offen offset:192 sc1
  s_mov_b32 s28, 0x30000
  v_cvt_pk_bf16_f32 v40, v40, v41
  v_cvt_pk_bf16_f32 v41, v42, v43
  v_cvt_pk_bf16_f32 v42, v56, v57
  v_cvt_pk_bf16_f32 v43, v58, v59
  buffer_store_dwordx4 v[40:43], v2, s[12:15], s28 offen offset:0 sc1
  v_cvt_pk_bf16_f32 v72, v72, v73
  v_cvt_pk_bf16_f32 v73, v74, v75
  v_cvt_pk_bf16_f32 v74, v88, v89
  v_cvt_pk_bf16_f32 v75, v90, v91
  buffer_store_dwordx4 v[72:75], v2, s[12:15], s28 offen offset:64 sc1
  v_cvt_pk_bf16_f32 v104, v104, v105
  v_cvt_pk_bf16_f32 v105, v106, v107
  v_cvt_pk_bf16_f32 v106, v120, v121
  v_cvt_pk_bf16_f32 v107, v122, v123
  buffer_store_dwordx4 v[104:107], v2, s[12:15], s28 offen offset:128 sc1
  v_cvt_pk_bf16_f32 v136, v136, v137
  v_cvt_pk_bf16_f32 v137, v138, v139
  v_cvt_pk_bf16_f32 v138, v152, v153
  v_cvt_pk_bf16_f32 v139, v154, v155
  buffer_store_dwordx4 v[136:139], v2, s[12:15], s28 offen offset:192 sc1
kvproj_kernel_end_d:
kvproj_kernel_end:
  s_endpgm
.globl attn_kernel
.p2align 8
.type attn_kernel,@function
attn_kernel:
  s_cmp_ge_u32 s2, 256
  s_cbranch_scc1 attn_kernel_end
  s_load_dwordx2 s[40:41], s[0:1], 104
  s_load_dwordx2 s[42:43], s[0:1], 16
  v_lshrrev_b32 v2, 6, v0
  v_and_b32 v1, 63, v0
  v_readfirstlane_b32 s20, v2
  s_and_b32 s44, s2, 7
  s_lshr_b32 s45, s2, 3
  s_and_b32 s46, s45, 3
  s_lshl_b32 s44, s44, 2
  s_add_u32 s44, s44, s46
  s_lshr_b32 s45, s45, 2
  s_lshl_b32 s21, s20, 10
  s_sub_u32 s46, 15, s45
  s_lshl_b32 s46, s46, 7
  s_lshl_b32 s47, s20, 5
  s_add_u32 s46, s46, s47
  s_lshl_b32 s47, s45, 7
  s_sub_u32 s48, 7, s20
  s_lshl_b32 s48, s48, 5
  s_add_u32 s47, s47, s48
  s_cmp_lt_u32 s20, 4
  s_cselect_b32 s22, s46, s47
  s_lshr_b32 s23, s22, 6
  s_lshl_b32 s24, s45, 1
  s_sub_u32 s24, 32, s24
  s_sub_u32 s28, s24, 3
  s_sub_u32 s29, s24, 4
  s_lshl_b32 s49, s44, 19
  s_lshl_b32 s44, s44, 8
  s_mov_b32 s31, 0x41f00000
  v_lshrrev_b32 v2, 4, v1
  s_lshl_b32 s46, s20, 2
  v_add_u32 v3, s46, v2
  v_xor_b32 v4, v3, v1
  v_and_b32 v4, 15, v4
  v_lshlrev_b32 v4, 4, v4
  v_lshl_add_u32 v17, v3, 13, v4
  v_add_u32 v18, 0x40000, v17
  v_lshlrev_b32 v4, 2, v2
  v_xor_b32 v4, v4, v1
  v_and_b32 v4, 15, v4
  v_lshlrev_b32 v4, 4, v4
  v_lshl_add_u32 v114, v3, 13, v4
  v_add_u32 v115, 0x40000, v114
  v_xor_b32 v4, v2, v1
  v_and_b32 v4, 7, v4
  v_lshlrev_b32 v4, 4, v4
  v_xor_b32 v25, 64, v4
  v_lshrrev_b32 v26, 3, v1
  v_mul_u32_u24 v28, 1152, v26
  v_add_u32 v112, v28, v4
  v_add_u32 v113, v28, v25
  s_and_b32 s46, s20, 1
  s_lshl_b32 s46, s46, 6
  v_xor_b32 v4, s46, v4
  s_lshl_b32 s46, s20, 3
  v_add_u32 v26, s46, v26
  v_lshl_add_u32 v19, v26, 12, v4
  v_add_u32 v20, 0x40000, v19
  s_waitcnt lgkmcnt(0)
  s_sub_u32 s47, 16777216, s44
  s_add_u32 s4, s40, 0x240000
  s_addc_u32 s5, s41, 0
  s_add_u32 s4, s4, s44
  s_addc_u32 s5, s5, 0
  s_mov_b32 s6, s47
  s_mov_b32 s7, 0x00020000
  s_sub_u32 s47, 16777216, s49
  s_add_u32 s8, s40, 0x1240000
  s_addc_u32 s9, s41, 0
  s_add_u32 s8, s8, s49
  s_addc_u32 s9, s9, 0
  s_mov_b32 s10, s47
  s_mov_b32 s11, 0x00020000
  s_sub_u32 s47, 4718592, s44
  s_mov_b32 s12, s42
  s_mov_b32 s13, s43
  s_add_u32 s12, s12, s44
  s_addc_u32 s13, s13, 0
  s_mov_b32 s14, s47
  s_mov_b32 s15, 0x00020000
  s_mul_i32 s46, s22, 1152
  s_mov_b32 s16, s40
  s_mov_b32 s17, s41
  s_add_u32 s16, s16, s46
  s_addc_u32 s17, s17, 0
  s_mov_b32 s18, 0x9000
  s_mov_b32 s19, 0x00020000
  s_lshl_b32 s33, s20, 12
  s_add_u32 m0, s33, 0x8000
  s_mov_b32 s46, 0x0
  buffer_load_dwordx4 v112, s[16:19], s46 offen lds
  s_add_u32 m0, s33, 0x8400
  s_mov_b32 s46, 0x2400
  buffer_load_dwordx4 v113, s[16:19], s46 offen lds
  s_add_u32 m0, s33, 0x8800
  s_mov_b32 s46, 0x4800
  buffer_load_dwordx4 v112, s[16:19], s46 offen lds
  s_add_u32 m0, s33, 0x8c00
  s_mov_b32 s46, 0x6c00
  buffer_load_dwordx4 v113, s[16:19], s46 offen lds
  s_mov_b32 s46, 0x0
  s_add_u32 m0, s21, 0x18000
  s_nop 0
  buffer_load_dwordx4 v114, s[12:15], s46 offen lds
  s_add_u32 m0, s21, 0x1a000
  s_nop 0
  buffer_load_dwordx4 v115, s[12:15], s46 offen lds
  s_add_u32 m0, s33, 0x20000
  s_mov_b32 s46, 0x80
  buffer_load_dwordx4 v112, s[16:19], s46 offen lds
  s_add_u32 m0, s33, 0x20400
  s_mov_b32 s46, 0x2480
  buffer_load_dwordx4 v113, s[16:19], s46 offen lds
  s_add_u32 m0, s33, 0x20800
  s_mov_b32 s46, 0x4880
  buffer_load_dwordx4 v112, s[16:19], s46 offen lds
  s_add_u32 m0, s33, 0x20c00
  s_mov_b32 s46, 0x6c80
  buffer_load_dwordx4 v113, s[16:19], s46 offen lds
  s_mov_b32 s46, 0x80000
  s_add_u32 m0, s21, 0x1c000
  s_nop 0
  buffer_load_dwordx4 v114, s[12:15], s46 offen lds
  s_add_u32 m0, s21, 0x1e000
  s_nop 0
  buffer_load_dwordx4 v115, s[12:15], s46 offen lds
  v_bfe_u32 v2, v1, 2, 2
  v_lshrrev_b32 v3, 5, v1
  v_bfe_u32 v4, v1, 4, 1
  v_lshlrev_b32 v4, 5, v4
  v_and_b32 v25, 3, v1
  v_lshl_add_u32 v4, v25, 3, v4
  v_lshl_add_u32 v25, v3, 3, v2
  v_lshl_add_u32 v25, v25, 8, v4
  v_xor_b32 v4, 0, v2
  v_lshl_add_u32 v28, v4, 6, v25
  v_add_u32 v96, 0x18000, v28
  v_xor_b32 v4, 1, v2
  v_lshl_add_u32 v28, v4, 6, v25
  v_add_u32 v97, 0x18000, v28
  v_xor_b32 v4, 2, v2
  v_lshl_add_u32 v28, v4, 6, v25
  v_add_u32 v98, 0x18000, v28
  v_xor_b32 v4, 3, v2
  v_lshl_add_u32 v28, v4, 6, v25
  v_add_u32 v99, 0x18000, v28
  v_and_b32 v25, 31, v1
  v_lshrrev_b32 v26, 1, v25
  v_xor_b32 v26, v26, v3
  v_and_b32 v26, 7, v26
  v_lshlrev_b32 v25, 7, v25
  v_xor_b32 v4, 0, v26
  v_lshl_add_u32 v28, v4, 4, v25
  v_add_u32 v13, 0x10000, v28
  v_add_u32 v28, s33, v28
  v_add_u32 v104, 0x8000, v28
  v_add_u32 v108, 0x20000, v28
  v_xor_b32 v4, 2, v26
  v_lshl_add_u32 v28, v4, 4, v25
  v_add_u32 v14, 0x10000, v28
  v_add_u32 v28, s33, v28
  v_add_u32 v105, 0x8000, v28
  v_add_u32 v109, 0x20000, v28
  v_xor_b32 v4, 4, v26
  v_lshl_add_u32 v28, v4, 4, v25
  v_add_u32 v15, 0x10000, v28
  v_add_u32 v28, s33, v28
  v_add_u32 v106, 0x8000, v28
  v_add_u32 v110, 0x20000, v28
  v_xor_b32 v4, 6, v26
  v_lshl_add_u32 v28, v4, 4, v25
  v_add_u32 v16, 0x10000, v28
  v_add_u32 v28, s33, v28
  v_add_u32 v107, 0x8000, v28
  v_add_u32 v111, 0x20000, v28
  s_waitcnt vmcnt(6)
  s_barrier
  ds_read_b128 v[144:147], v104
  ds_read_b64_tr_b16 v[128:129], v96 offset:0
  ds_read_b64_tr_b16 v[130:131], v96 offset:1024
  ds_read_b64_tr_b16 v[132:133], v97 offset:0
  ds_read_b64_tr_b16 v[134:135], v97 offset:1024
  ds_read_b64_tr_b16 v[136:137], v98 offset:0
  ds_read_b64_tr_b16 v[138:139], v98 offset:1024
  ds_read_b128 v[148:151], v105
  ds_read_b128 v[152:155], v106
  ds_read_b128 v[156:159], v107
  s_waitcnt lgkmcnt(7)
  v_mfma_f32_32x32x16_bf16 v[32:47], v[128:131], v[144:147], 0
  ds_read_b64_tr_b16 v[140:141], v99 offset:0
  ds_read_b64_tr_b16 v[142:143], v99 offset:1024
  s_waitcnt lgkmcnt(7)
  v_mfma_f32_32x32x16_bf16 v[48:63], v[132:135], v[144:147], 0
  ds_read_b64_tr_b16 v[128:129], v96 offset:4096
  ds_read_b64_tr_b16 v[130:131], v96 offset:5120
  s_waitcnt lgkmcnt(7)
  v_mfma_f32_32x32x16_bf16 v[64:79], v[136:139], v[144:147], 0
  ds_read_b64_tr_b16 v[132:133], v97 offset:4096
  ds_read_b64_tr_b16 v[134:135], v97 offset:5120
  s_waitcnt lgkmcnt(4)
  v_mfma_f32_32x32x16_bf16 v[80:95], v[140:143], v[144:147], 0
  ds_read_b64_tr_b16 v[136:137], v98 offset:4096
  ds_read_b64_tr_b16 v[138:139], v98 offset:5120
  s_waitcnt lgkmcnt(4)
  v_mfma_f32_32x32x16_bf16 v[32:47], v[128:131], v[148:151], v[32:47]
  ds_read_b64_tr_b16 v[140:141], v99 offset:4096
  ds_read_b64_tr_b16 v[142:143], v99 offset:5120
  s_waitcnt lgkmcnt(4)
  v_mfma_f32_32x32x16_bf16 v[48:63], v[132:135], v[148:151], v[48:63]
  ds_read_b64_tr_b16 v[128:129], v96 offset:8192
  ds_read_b64_tr_b16 v[130:131], v96 offset:9216
  s_waitcnt lgkmcnt(4)
  v_mfma_f32_32x32x16_bf16 v[64:79], v[136:139], v[148:151], v[64:79]
  ds_read_b64_tr_b16 v[132:133], v97 offset:8192
  ds_read_b64_tr_b16 v[134:135], v97 offset:9216
  s_waitcnt lgkmcnt(4)
  v_mfma_f32_32x32x16_bf16 v[80:95], v[140:143], v[148:151], v[80:95]
  ds_read_b64_tr_b16 v[136:137], v98 offset:8192
  ds_read_b64_tr_b16 v[138:139], v98 offset:9216
  s_waitcnt lgkmcnt(4)
  v_mfma_f32_32x32x16_bf16 v[32:47], v[128:131], v[152:155], v[32:47]
  ds_read_b64_tr_b16 v[140:141], v99 offset:8192
  ds_read_b64_tr_b16 v[142:143], v99 offset:9216
  s_waitcnt lgkmcnt(4)
  v_mfma_f32_32x32x16_bf16 v[48:63], v[132:135], v[152:155], v[48:63]
  ds_read_b64_tr_b16 v[128:129], v96 offset:12288
  ds_read_b64_tr_b16 v[130:131], v96 offset:13312
  s_waitcnt lgkmcnt(4)
  v_mfma_f32_32x32x16_bf16 v[64:79], v[136:139], v[152:155], v[64:79]
  ds_read_b64_tr_b16 v[132:133], v97 offset:12288
  ds_read_b64_tr_b16 v[134:135], v97 offset:13312
  s_waitcnt lgkmcnt(4)
  v_mfma_f32_32x32x16_bf16 v[80:95], v[140:143], v[152:155], v[80:95]
  ds_read_b64_tr_b16 v[136:137], v98 offset:12288
  ds_read_b64_tr_b16 v[138:139], v98 offset:13312
  s_waitcnt lgkmcnt(4)
  v_mfma_f32_32x32x16_bf16 v[32:47], v[128:131], v[156:159], v[32:47]
  ds_read_b64_tr_b16 v[140:141], v99 offset:12288
  ds_read_b64_tr_b16 v[142:143], v99 offset:13312
  s_waitcnt vmcnt(0) lgkmcnt(0)
  s_barrier
  ds_read_b128 v[160:163], v108
  ds_read_b128 v[164:167], v109
  ds_read_b128 v[168:171], v110
  ds_read_b128 v[172:175], v111
  v_mfma_f32_32x32x16_bf16 v[48:63], v[132:135], v[156:159], v[48:63]
  ds_read_b64_tr_b16 v[128:129], v96 offset:16384
  ds_read_b64_tr_b16 v[130:131], v96 offset:17408
  s_add_u32 m0, s33, 0x8000
  s_mov_b32 s46, 0x100
  buffer_load_dwordx4 v112, s[16:19], s46 offen lds
  s_add_u32 m0, s33, 0x8400
  v_mfma_f32_32x32x16_bf16 v[64:79], v[136:139], v[156:159], v[64:79]
  ds_read_b64_tr_b16 v[132:133], v97 offset:16384
  ds_read_b64_tr_b16 v[134:135], v97 offset:17408
  s_mov_b32 s46, 0x2500
  buffer_load_dwordx4 v113, s[16:19], s46 offen lds
  s_add_u32 m0, s33, 0x8800
  s_mov_b32 s46, 0x4900
  v_mfma_f32_32x32x16_bf16 v[80:95], v[140:143], v[156:159], v[80:95]
  ds_read_b64_tr_b16 v[136:137], v98 offset:16384
  ds_read_b64_tr_b16 v[138:139], v98 offset:17408
  buffer_load_dwordx4 v112, s[16:19], s46 offen lds
  s_add_u32 m0, s33, 0x8c00
  s_mov_b32 s46, 0x6d00
  buffer_load_dwordx4 v113, s[16:19], s46 offen lds
  s_waitcnt lgkmcnt(4)
  v_mfma_f32_32x32x16_bf16 v[32:47], v[128:131], v[160:163], v[32:47]
  ds_read_b64_tr_b16 v[140:141], v99 offset:16384
  ds_read_b64_tr_b16 v[142:143], v99 offset:17408
  s_mov_b32 s46, 0x100000
  s_add_u32 m0, s21, 0x18000
  s_nop 0
  buffer_load_dwordx4 v114, s[12:15], s46 offen lds
  s_waitcnt lgkmcnt(4)
  v_mfma_f32_32x32x16_bf16 v[48:63], v[132:135], v[160:163], v[48:63]
  ds_read_b64_tr_b16 v[128:129], v96 offset:20480
  ds_read_b64_tr_b16 v[130:131], v96 offset:21504
  s_add_u32 m0, s21, 0x1a000
  s_nop 0
  buffer_load_dwordx4 v115, s[12:15], s46 offen lds
  s_waitcnt lgkmcnt(4)
  v_mfma_f32_32x32x16_bf16 v[64:79], v[136:139], v[160:163], v[64:79]
  ds_read_b64_tr_b16 v[132:133], v97 offset:20480
  ds_read_b64_tr_b16 v[134:135], v97 offset:21504
  s_waitcnt lgkmcnt(4)
  v_mfma_f32_32x32x16_bf16 v[80:95], v[140:143], v[160:163], v[80:95]
  ds_read_b64_tr_b16 v[136:137], v98 offset:20480
  ds_read_b64_tr_b16 v[138:139], v98 offset:21504
  s_waitcnt lgkmcnt(4)
  v_mfma_f32_32x32x16_bf16 v[32:47], v[128:131], v[164:167], v[32:47]
  ds_read_b64_tr_b16 v[140:141], v99 offset:20480
  ds_read_b64_tr_b16 v[142:143], v99 offset:21504
  s_waitcnt lgkmcnt(4)
  v_mfma_f32_32x32x16_bf16 v[48:63], v[132:135], v[164:167], v[48:63]
  ds_read_b64_tr_b16 v[128:129], v96 offset:24576
  ds_read_b64_tr_b16 v[130:131], v96 offset:25600
  s_waitcnt lgkmcnt(4)
  v_mfma_f32_32x32x16_bf16 v[64:79], v[136:139], v[164:167], v[64:79]
  ds_read_b64_tr_b16 v[132:133], v97 offset:24576
  ds_read_b64_tr_b16 v[134:135], v97 offset:25600
  s_waitcnt lgkmcnt(4)
  v_mfma_f32_32x32x16_bf16 v[80:95], v[140:143], v[164:167], v[80:95]
  ds_read_b64_tr_b16 v[136:137], v98 offset:24576
  ds_read_b64_tr_b16 v[138:139], v98 offset:25600
  s_waitcnt lgkmcnt(4)
  v_mfma_f32_32x32x16_bf16 v[32:47], v[128:131], v[168:171], v[32:47]
  ds_read_b64_tr_b16 v[140:141], v99 offset:24576
  ds_read_b64_tr_b16 v[142:143], v99 offset:25600
  s_waitcnt lgkmcnt(4)
  v_mfma_f32_32x32x16_bf16 v[48:63], v[132:135], v[168:171], v[48:63]
  ds_read_b64_tr_b16 v[128:129], v96 offset:28672
  ds_read_b64_tr_b16 v[130:131], v96 offset:29696
  s_waitcnt lgkmcnt(4)
  v_mfma_f32_32x32x16_bf16 v[64:79], v[136:139], v[168:171], v[64:79]
  ds_read_b64_tr_b16 v[132:133], v97 offset:28672
  ds_read_b64_tr_b16 v[134:135], v97 offset:29696
  s_waitcnt lgkmcnt(4)
  v_mfma_f32_32x32x16_bf16 v[80:95], v[140:143], v[168:171], v[80:95]
  ds_read_b64_tr_b16 v[136:137], v98 offset:28672
  ds_read_b64_tr_b16 v[138:139], v98 offset:29696
  s_waitcnt lgkmcnt(4)
  v_mfma_f32_32x32x16_bf16 v[32:47], v[128:131], v[172:175], v[32:47]
  ds_read_b64_tr_b16 v[140:141], v99 offset:28672
  ds_read_b64_tr_b16 v[142:143], v99 offset:29696
  s_waitcnt vmcnt(0) lgkmcnt(0)
  s_barrier
  ds_read_b128 v[144:147], v104
  ds_read_b128 v[148:151], v105
  ds_read_b128 v[152:155], v106
  ds_read_b128 v[156:159], v107
  v_mfma_f32_32x32x16_bf16 v[48:63], v[132:135], v[172:175], v[48:63]
  ds_read_b64_tr_b16 v[128:129], v96 offset:0
  ds_read_b64_tr_b16 v[130:131], v96 offset:1024
  s_add_u32 m0, s33, 0x20000
  s_mov_b32 s46, 0x180
  buffer_load_dwordx4 v112, s[16:19], s46 offen lds
  s_add_u32 m0, s33, 0x20400
  v_mfma_f32_32x32x16_bf16 v[64:79], v[136:139], v[172:175], v[64:79]
  ds_read_b64_tr_b16 v[132:133], v97 offset:0
  ds_read_b64_tr_b16 v[134:135], v97 offset:1024
  s_mov_b32 s46, 0x2580
  buffer_load_dwordx4 v113, s[16:19], s46 offen lds
  s_add_u32 m0, s33, 0x20800
  s_mov_b32 s46, 0x4980
  v_mfma_f32_32x32x16_bf16 v[80:95], v[140:143], v[172:175], v[80:95]
  ds_read_b64_tr_b16 v[136:137], v98 offset:0
  ds_read_b64_tr_b16 v[138:139], v98 offset:1024
  buffer_load_dwordx4 v112, s[16:19], s46 offen lds
  s_add_u32 m0, s33, 0x20c00
  s_mov_b32 s46, 0x6d80
  buffer_load_dwordx4 v113, s[16:19], s46 offen lds
  s_waitcnt lgkmcnt(4)
  v_mfma_f32_32x32x16_bf16 v[32:47], v[128:131], v[144:147], v[32:47]
  ds_read_b64_tr_b16 v[140:141], v99 offset:0
  ds_read_b64_tr_b16 v[142:143], v99 offset:1024
  s_mov_b32 s46, 0x180000
  s_add_u32 m0, s21, 0x1c000
  s_nop 0
  buffer_load_dwordx4 v114, s[12:15], s46 offen lds
  s_waitcnt lgkmcnt(4)
  v_mfma_f32_32x32x16_bf16 v[48:63], v[132:135], v[144:147], v[48:63]
  ds_read_b64_tr_b16 v[128:129], v96 offset:4096
  ds_read_b64_tr_b16 v[130:131], v96 offset:5120
  s_add_u32 m0, s21, 0x1e000
  s_nop 0
  buffer_load_dwordx4 v115, s[12:15], s46 offen lds
  s_waitcnt lgkmcnt(4)
  v_mfma_f32_32x32x16_bf16 v[64:79], v[136:139], v[144:147], v[64:79]
  ds_read_b64_tr_b16 v[132:133], v97 offset:4096
  ds_read_b64_tr_b16 v[134:135], v97 offset:5120
  s_waitcnt lgkmcnt(4)
  v_mfma_f32_32x32x16_bf16 v[80:95], v[140:143], v[144:147], v[80:95]
  ds_read_b64_tr_b16 v[136:137], v98 offset:4096
  ds_read_b64_tr_b16 v[138:139], v98 offset:5120
  s_waitcnt lgkmcnt(4)
  v_mfma_f32_32x32x16_bf16 v[32:47], v[128:131], v[148:151], v[32:47]
  ds_read_b64_tr_b16 v[140:141], v99 offset:4096
  ds_read_b64_tr_b16 v[142:143], v99 offset:5120
  s_waitcnt lgkmcnt(4)
  v_mfma_f32_32x32x16_bf16 v[48:63], v[132:135], v[148:151], v[48:63]
  ds_read_b64_tr_b16 v[128:129], v96 offset:8192
  ds_read_b64_tr_b16 v[130:131], v96 offset:9216
  s_waitcnt lgkmcnt(4)
  v_mfma_f32_32x32x16_bf16 v[64:79], v[136:139], v[148:151], v[64:79]
  ds_read_b64_tr_b16 v[132:133], v97 offset:8192
  ds_read_b64_tr_b16 v[134:135], v97 offset:9216
  s_waitcnt lgkmcnt(4)
  v_mfma_f32_32x32x16_bf16 v[80:95], v[140:143], v[148:151], v[80:95]
  ds_read_b64_tr_b16 v[136:137], v98 offset:8192
  ds_read_b64_tr_b16 v[138:139], v98 offset:9216
  s_waitcnt lgkmcnt(4)
  v_mfma_f32_32x32x16_bf16 v[32:47], v[128:131], v[152:155], v[32:47]
  ds_read_b64_tr_b16 v[140:141], v99 offset:8192
  ds_read_b64_tr_b16 v[142:143], v99 offset:9216
  s_waitcnt lgkmcnt(4)
  v_mfma_f32_32x32x16_bf16 v[48:63], v[132:135], v[152:155], v[48:63]
  ds_read_b64_tr_b16 v[128:129], v96 offset:12288
  ds_read_b64_tr_b16 v[130:131], v96 offset:13312
  s_waitcnt lgkmcnt(4)
  v_mfma_f32_32x32x16_bf16 v[64:79], v[136:139], v[152:155], v[64:79]
  ds_read_b64_tr_b16 v[132:133], v97 offset:12288
  ds_read_b64_tr_b16 v[134:135], v97 offset:13312
  s_waitcnt lgkmcnt(4)
  v_mfma_f32_32x32x16_bf16 v[80:95], v[140:143], v[152:155], v[80:95]
  ds_read_b64_tr_b16 v[136:137], v98 offset:12288
  ds_read_b64_tr_b16 v[138:139], v98 offset:13312
  s_waitcnt lgkmcnt(4)
  v_mfma_f32_32x32x16_bf16 v[32:47], v[128:131], v[156:159], v[32:47]
  ds_read_b64_tr_b16 v[140:141], v99 offset:12288
  ds_read_b64_tr_b16 v[142:143], v99 offset:13312
  s_waitcnt vmcnt(0) lgkmcnt(0)
  s_barrier
  ds_read_b128 v[160:163], v108
  ds_read_b128 v[164:167], v109
  ds_read_b128 v[168:171], v110
  ds_read_b128 v[172:175], v111
  v_mfma_f32_32x32x16_bf16 v[48:63], v[132:135], v[156:159], v[48:63]
  ds_read_b64_tr_b16 v[128:129], v96 offset:16384
  ds_read_b64_tr_b16 v[130:131], v96 offset:17408
  s_add_u32 m0, s33, 0x8000
  s_mov_b32 s46, 0x200
  buffer_load_dwordx4 v112, s[16:19], s46 offen lds
  s_add_u32 m0, s33, 0x8400
  v_mfma_f32_32x32x16_bf16 v[64:79], v[136:139], v[156:159], v[64:79]
  ds_read_b64_tr_b16 v[132:133], v97 offset:16384
  ds_read_b64_tr_b16 v[134:135], v97 offset:17408
  s_mov_b32 s46, 0x2600
  buffer_load_dwordx4 v113, s[16:19], s46 offen lds
  s_add_u32 m0, s33, 0x8800
  s_mov_b32 s46, 0x4a00
  v_mfma_f32_32x32x16_bf16 v[80:95], v[140:143], v[156:159], v[80:95]
  ds_read_b64_tr_b16 v[136:137], v98 offset:16384
  ds_read_b64_tr_b16 v[138:139], v98 offset:17408
  buffer_load_dwordx4 v112, s[16:19], s46 offen lds
  s_add_u32 m0, s33, 0x8c00
  s_mov_b32 s46, 0x6e00
  buffer_load_dwordx4 v113, s[16:19], s46 offen lds
  s_waitcnt lgkmcnt(4)
  v_mfma_f32_32x32x16_bf16 v[32:47], v[128:131], v[160:163], v[32:47]
  ds_read_b64_tr_b16 v[140:141], v99 offset:16384
  ds_read_b64_tr_b16 v[142:143], v99 offset:17408
  s_mov_b32 s46, 0x200000
  s_add_u32 m0, s21, 0x18000
  s_nop 0
  buffer_load_dwordx4 v114, s[12:15], s46 offen lds
  s_waitcnt lgkmcnt(4)
  v_mfma_f32_32x32x16_bf16 v[48:63], v[132:135], v[160:163], v[48:63]
  ds_read_b64_tr_b16 v[128:129], v96 offset:20480
  ds_read_b64_tr_b16 v[130:131], v96 offset:21504
  s_add_u32 m0, s21, 0x1a000
  s_nop 0
  buffer_load_dwordx4 v115, s[12:15], s46 offen lds
  s_waitcnt lgkmcnt(4)
  v_mfma_f32_32x32x16_bf16 v[64:79], v[136:139], v[160:163], v[64:79]
  ds_read_b64_tr_b16 v[132:133], v97 offset:20480
  ds_read_b64_tr_b16 v[134:135], v97 offset:21504
  s_waitcnt lgkmcnt(4)
  v_mfma_f32_32x32x16_bf16 v[80:95], v[140:143], v[160:163], v[80:95]
  ds_read_b64_tr_b16 v[136:137], v98 offset:20480
  ds_read_b64_tr_b16 v[138:139], v98 offset:21504
  s_waitcnt lgkmcnt(4)
  v_mfma_f32_32x32x16_bf16 v[32:47], v[128:131], v[164:167], v[32:47]
  ds_read_b64_tr_b16 v[140:141], v99 offset:20480
  ds_read_b64_tr_b16 v[142:143], v99 offset:21504
  s_waitcnt lgkmcnt(4)
  v_mfma_f32_32x32x16_bf16 v[48:63], v[132:135], v[164:167], v[48:63]
  ds_read_b64_tr_b16 v[128:129], v96 offset:24576
  ds_read_b64_tr_b16 v[130:131], v96 offset:25600
  s_waitcnt lgkmcnt(4)
  v_mfma_f32_32x32x16_bf16 v[64:79], v[136:139], v[164:167], v[64:79]
  ds_read_b64_tr_b16 v[132:133], v97 offset:24576
  ds_read_b64_tr_b16 v[134:135], v97 offset:25600
  s_waitcnt lgkmcnt(4)
  v_mfma_f32_32x32x16_bf16 v[80:95], v[140:143], v[164:167], v[80:95]
  ds_read_b64_tr_b16 v[136:137], v98 offset:24576
  ds_read_b64_tr_b16 v[138:139], v98 offset:25600
  s_waitcnt lgkmcnt(4)
  v_mfma_f32_32x32x16_bf16 v[32:47], v[128:131], v[168:171], v[32:47]
  ds_read_b64_tr_b16 v[140:141], v99 offset:24576
  ds_read_b64_tr_b16 v[142:143], v99 offset:25600
  s_waitcnt lgkmcnt(4)
  v_mfma_f32_32x32x16_bf16 v[48:63], v[132:135], v[168:171], v[48:63]
  ds_read_b64_tr_b16 v[128:129], v96 offset:28672
  ds_read_b64_tr_b16 v[130:131], v96 offset:29696
  s_waitcnt lgkmcnt(4)
  v_mfma_f32_32x32x16_bf16 v[64:79], v[136:139], v[168:171], v[64:79]
  ds_read_b64_tr_b16 v[132:133], v97 offset:28672
  ds_read_b64_tr_b16 v[134:135], v97 offset:29696
  s_waitcnt lgkmcnt(4)
  v_mfma_f32_32x32x16_bf16 v[80:95], v[140:143], v[168:171], v[80:95]
  ds_read_b64_tr_b16 v[136:137], v98 offset:28672
  ds_read_b64_tr_b16 v[138:139], v98 offset:29696
  s_waitcnt lgkmcnt(4)
  v_mfma_f32_32x32x16_bf16 v[32:47], v[128:131], v[172:175], v[32:47]
  ds_read_b64_tr_b16 v[140:141], v99 offset:28672
  ds_read_b64_tr_b16 v[142:143], v99 offset:29696
  s_waitcnt vmcnt(0) lgkmcnt(0)
  s_barrier
  ds_read_b128 v[144:147], v104
  ds_read_b128 v[148:151], v105
  ds_read_b128 v[152:155], v106
  ds_read_b128 v[156:159], v107
  v_mfma_f32_32x32x16_bf16 v[48:63], v[132:135], v[172:175], v[48:63]
  ds_read_b64_tr_b16 v[128:129], v96 offset:0
  ds_read_b64_tr_b16 v[130:131], v96 offset:1024
  s_add_u32 m0, s33, 0x20000
  s_mov_b32 s46, 0x280
  buffer_load_dwordx4 v112, s[16:19], s46 offen lds
  s_add_u32 m0, s33, 0x20400
  v_mfma_f32_32x32x16_bf16 v[64:79], v[136:139], v[172:175], v[64:79]
  ds_read_b64_tr_b16 v[132:133], v97 offset:0
  ds_read_b64_tr_b16 v[134:135], v97 offset:1024
  s_mov_b32 s46, 0x2680
  buffer_load_dwordx4 v113, s[16:19], s46 offen lds
  s_add_u32 m0, s33, 0x20800
  s_mov_b32 s46, 0x4a80
  v_mfma_f32_32x32x16_bf16 v[80:95], v[140:143], v[172:175], v[80:95]
  ds_read_b64_tr_b16 v[136:137], v98 offset:0
  ds_read_b64_tr_b16 v[138:139], v98 offset:1024
  buffer_load_dwordx4 v112, s[16:19], s46 offen lds
  s_add_u32 m0, s33, 0x20c00
  s_mov_b32 s46, 0x6e80
  buffer_load_dwordx4 v113, s[16:19], s46 offen lds
  s_waitcnt lgkmcnt(4)
  v_mfma_f32_32x32x16_bf16 v[32:47], v[128:131], v[144:147], v[32:47]
  ds_read_b64_tr_b16 v[140:141], v99 offset:0
  ds_read_b64_tr_b16 v[142:143], v99 offset:1024
  s_mov_b32 s46, 0x280000
  s_add_u32 m0, s21, 0x1c000
  s_nop 0
  buffer_load_dwordx4 v114, s[12:15], s46 offen lds
  s_waitcnt lgkmcnt(4)
  v_mfma_f32_32x32x16_bf16 v[48:63], v[132:135], v[144:147], v[48:63]
  ds_read_b64_tr_b16 v[128:129], v96 offset:4096
  ds_read_b64_tr_b16 v[130:131], v96 offset:5120
  s_add_u32 m0, s21, 0x1e000
  s_nop 0
  buffer_load_dwordx4 v115, s[12:15], s46 offen lds
  s_waitcnt lgkmcnt(4)
  v_mfma_f32_32x32x16_bf16 v[64:79], v[136:139], v[144:147], v[64:79]
  ds_read_b64_tr_b16 v[132:133], v97 offset:4096
  ds_read_b64_tr_b16 v[134:135], v97 offset:5120
  s_waitcnt lgkmcnt(4)
  v_mfma_f32_32x32x16_bf16 v[80:95], v[140:143], v[144:147], v[80:95]
  ds_read_b64_tr_b16 v[136:137], v98 offset:4096
  ds_read_b64_tr_b16 v[138:139], v98 offset:5120
  s_waitcnt lgkmcnt(4)
  v_mfma_f32_32x32x16_bf16 v[32:47], v[128:131], v[148:151], v[32:47]
  ds_read_b64_tr_b16 v[140:141], v99 offset:4096
  ds_read_b64_tr_b16 v[142:143], v99 offset:5120
  s_waitcnt lgkmcnt(4)
  v_mfma_f32_32x32x16_bf16 v[48:63], v[132:135], v[148:151], v[48:63]
  ds_read_b64_tr_b16 v[128:129], v96 offset:8192
  ds_read_b64_tr_b16 v[130:131], v96 offset:9216
  s_waitcnt lgkmcnt(4)
  v_mfma_f32_32x32x16_bf16 v[64:79], v[136:139], v[148:151], v[64:79]
  ds_read_b64_tr_b16 v[132:133], v97 offset:8192
  ds_read_b64_tr_b16 v[134:135], v97 offset:9216
  s_waitcnt lgkmcnt(4)
  v_mfma_f32_32x32x16_bf16 v[80:95], v[140:143], v[148:151], v[80:95]
  ds_read_b64_tr_b16 v[136:137], v98 offset:8192
  ds_read_b64_tr_b16 v[138:139], v98 offset:9216
  s_waitcnt lgkmcnt(4)
  v_mfma_f32_32x32x16_bf16 v[32:47], v[128:131], v[152:155], v[32:47]
  ds_read_b64_tr_b16 v[140:141], v99 offset:8192
  ds_read_b64_tr_b16 v[142:143], v99 offset:9216
  s_waitcnt lgkmcnt(4)
  v_mfma_f32_32x32x16_bf16 v[48:63], v[132:135], v[152:155], v[48:63]
  ds_read_b64_tr_b16 v[128:129], v96 offset:12288
  ds_read_b64_tr_b16 v[130:131], v96 offset:13312
  s_waitcnt lgkmcnt(4)
  v_mfma_f32_32x32x16_bf16 v[64:79], v[136:139], v[152:155], v[64:79]
  ds_read_b64_tr_b16 v[132:133], v97 offset:12288
  ds_read_b64_tr_b16 v[134:135], v97 offset:13312
  s_waitcnt lgkmcnt(4)
  v_mfma_f32_32x32x16_bf16 v[80:95], v[140:143], v[152:155], v[80:95]
  ds_read_b64_tr_b16 v[136:137], v98 offset:12288
  ds_read_b64_tr_b16 v[138:139], v98 offset:13312
  s_waitcnt lgkmcnt(4)
  v_mfma_f32_32x32x16_bf16 v[32:47], v[128:131], v[156:159], v[32:47]
  ds_read_b64_tr_b16 v[140:141], v99 offset:12288
  ds_read_b64_tr_b16 v[142:143], v99 offset:13312
  s_waitcnt vmcnt(0) lgkmcnt(0)
  s_barrier
  ds_read_b128 v[160:163], v108
  ds_read_b128 v[164:167], v109
  ds_read_b128 v[168:171], v110
  ds_read_b128 v[172:175], v111
  v_mfma_f32_32x32x16_bf16 v[48:63], v[132:135], v[156:159], v[48:63]
  ds_read_b64_tr_b16 v[128:129], v96 offset:16384
  ds_read_b64_tr_b16 v[130:131], v96 offset:17408
  s_add_u32 m0, s33, 0x8000
  s_mov_b32 s46, 0x300
  buffer_load_dwordx4 v112, s[16:19], s46 offen lds
  s_add_u32 m0, s33, 0x8400
  v_mfma_f32_32x32x16_bf16 v[64:79], v[136:139], v[156:159], v[64:79]
  ds_read_b64_tr_b16 v[132:133], v97 offset:16384
  ds_read_b64_tr_b16 v[134:135], v97 offset:17408
  s_mov_b32 s46, 0x2700
  buffer_load_dwordx4 v113, s[16:19], s46 offen lds
  s_add_u32 m0, s33, 0x8800
  s_mov_b32 s46, 0x4b00
  v_mfma_f32_32x32x16_bf16 v[80:95], v[140:143], v[156:159], v[80:95]
  ds_read_b64_tr_b16 v[136:137], v98 offset:16384
  ds_read_b64_tr_b16 v[138:139], v98 offset:17408
  buffer_load_dwordx4 v112, s[16:19], s46 offen lds
  s_add_u32 m0, s33, 0x8c00
  s_mov_b32 s46, 0x6f00
  buffer_load_dwordx4 v113, s[16:19], s46 offen lds
  s_waitcnt lgkmcnt(4)
  v_mfma_f32_32x32x16_bf16 v[32:47], v[128:131], v[160:163], v[32:47]
  ds_read_b64_tr_b16 v[140:141], v99 offset:16384
  ds_read_b64_tr_b16 v[142:143], v99 offset:17408
  s_mov_b32 s46, 0x300000
  s_add_u32 m0, s21, 0x18000
  s_nop 0
  buffer_load_dwordx4 v114, s[12:15], s46 offen lds
  s_waitcnt lgkmcnt(4)
  v_mfma_f32_32x32x16_bf16 v[48:63], v[132:135], v[160:163], v[48:63]
  ds_read_b64_tr_b16 v[128:129], v96 offset:20480
  ds_read_b64_tr_b16 v[130:131], v96 offset:21504
  s_add_u32 m0, s21, 0x1a000
  s_nop 0
  buffer_load_dwordx4 v115, s[12:15], s46 offen lds
  s_mov_b32 s46, 0x0
  s_waitcnt lgkmcnt(4)
  v_mfma_f32_32x32x16_bf16 v[64:79], v[136:139], v[160:163], v[64:79]
  ds_read_b64_tr_b16 v[132:133], v97 offset:20480
  ds_read_b64_tr_b16 v[134:135], v97 offset:21504
  s_add_u32 m0, s21, 0x0
  s_nop 0
  buffer_load_dwordx4 v17, s[4:7], s46 offen lds
  s_add_u32 m0, s21, 0x2000
  s_waitcnt lgkmcnt(4)
  v_mfma_f32_32x32x16_bf16 v[80:95], v[140:143], v[160:163], v[80:95]
  ds_read_b64_tr_b16 v[136:137], v98 offset:20480
  ds_read_b64_tr_b16 v[138:139], v98 offset:21504
  s_nop 0
  buffer_load_dwordx4 v18, s[4:7], s46 offen lds
  s_mov_b32 s46, 0x0
  s_add_u32 m0, s21, 0x10000
  s_waitcnt lgkmcnt(4)
  v_mfma_f32_32x32x16_bf16 v[32:47], v[128:131], v[164:167], v[32:47]
  ds_read_b64_tr_b16 v[140:141], v99 offset:20480
  ds_read_b64_tr_b16 v[142:143], v99 offset:21504
  s_nop 0
  buffer_load_dwordx4 v19, s[8:11], s46 offen lds
  s_add_u32 m0, s21, 0x12000
  s_nop 0
  s_waitcnt lgkmcnt(4)
  v_mfma_f32_32x32x16_bf16 v[48:63], v[132:135], v[164:167], v[48:63]
  ds_read_b64_tr_b16 v[128:129], v96 offset:24576
  ds_read_b64_tr_b16 v[130:131], v96 offset:25600
  buffer_load_dwordx4 v20, s[8:11], s46 offen lds
  s_waitcnt lgkmcnt(4)
  v_mfma_f32_32x32x16_bf16 v[64:79], v[136:139], v[164:167], v[64:79]
  ds_read_b64_tr_b16 v[132:133], v97 offset:24576
  ds_read_b64_tr_b16 v[134:135], v97 offset:25600
  s_waitcnt lgkmcnt(4)
  v_mfma_f32_32x32x16_bf16 v[80:95], v[140:143], v[164:167], v[80:95]
  ds_read_b64_tr_b16 v[136:137], v98 offset:24576
  ds_read_b64_tr_b16 v[138:139], v98 offset:25600
  s_waitcnt lgkmcnt(4)
  v_mfma_f32_32x32x16_bf16 v[32:47], v[128:131], v[168:171], v[32:47]
  ds_read_b64_tr_b16 v[140:141], v99 offset:24576
  ds_read_b64_tr_b16 v[142:143], v99 offset:25600
  s_waitcnt lgkmcnt(4)
  v_mfma_f32_32x32x16_bf16 v[48:63], v[132:135], v[168:171], v[48:63]
  ds_read_b64_tr_b16 v[128:129], v96 offset:28672
  ds_read_b64_tr_b16 v[130:131], v96 offset:29696
  s_waitcnt lgkmcnt(4)
  v_mfma_f32_32x32x16_bf16 v[64:79], v[136:139], v[168:171], v[64:79]
  ds_read_b64_tr_b16 v[132:133], v97 offset:28672
  ds_read_b64_tr_b16 v[134:135], v97 offset:29696
  s_waitcnt lgkmcnt(4)
  v_mfma_f32_32x32x16_bf16 v[80:95], v[140:143], v[168:171], v[80:95]
  ds_read_b64_tr_b16 v[136:137], v98 offset:28672
  ds_read_b64_tr_b16 v[138:139], v98 offset:29696
  s_waitcnt lgkmcnt(4)
  v_mfma_f32_32x32x16_bf16 v[32:47], v[128:131], v[172:175], v[32:47]
  ds_read_b64_tr_b16 v[140:141], v99 offset:28672
  ds_read_b64_tr_b16 v[142:143], v99 offset:29696
  s_waitcnt vmcnt(4) lgkmcnt(0)
  s_barrier
  ds_read_b128 v[144:147], v104
  ds_read_b128 v[148:151], v105
  ds_read_b128 v[152:155], v106
  ds_read_b128 v[156:159], v107
  v_mfma_f32_32x32x16_bf16 v[48:63], v[132:135], v[172:175], v[48:63]
  ds_read_b64_tr_b16 v[128:129], v96 offset:0
  ds_read_b64_tr_b16 v[130:131], v96 offset:1024
  s_add_u32 m0, s33, 0x20000
  s_mov_b32 s46, 0x380
  buffer_load_dwordx4 v112, s[16:19], s46 offen lds
  s_add_u32 m0, s33, 0x20400
  v_mfma_f32_32x32x16_bf16 v[64:79], v[136:139], v[172:175], v[64:79]
  ds_read_b64_tr_b16 v[132:133], v97 offset:0
  ds_read_b64_tr_b16 v[134:135], v97 offset:1024
  s_mov_b32 s46, 0x2780
  buffer_load_dwordx4 v113, s[16:19], s46 offen lds
  s_add_u32 m0, s33, 0x20800
  s_mov_b32 s46, 0x4b80
  v_mfma_f32_32x32x16_bf16 v[80:95], v[140:143], v[172:175], v[80:95]
  ds_read_b64_tr_b16 v[136:137], v98 offset:0
  ds_read_b64_tr_b16 v[138:139], v98 offset:1024
  buffer_load_dwordx4 v112, s[16:19], s46 offen lds
  s_add_u32 m0, s33, 0x20c00
  s_mov_b32 s46, 0x6f80
  buffer_load_dwordx4 v113, s[16:19], s46 offen lds
  s_waitcnt lgkmcnt(4)
  v_mfma_f32_32x32x16_bf16 v[32:47], v[128:131], v[144:147], v[32:47]
  ds_read_b64_tr_b16 v[140:141], v99 offset:0
  ds_read_b64_tr_b16 v[142:143], v99 offset:1024
  s_mov_b32 s46, 0x380000
  s_add_u32 m0, s21, 0x1c000
  s_nop 0
  buffer_load_dwordx4 v114, s[12:15], s46 offen lds
  s_waitcnt lgkmcnt(4)
  v_mfma_f32_32x32x16_bf16 v[48:63], v[132:135], v[144:147], v[48:63]
  ds_read_b64_tr_b16 v[128:129], v96 offset:4096
  ds_read_b64_tr_b16 v[130:131], v96 offset:5120
  s_add_u32 m0, s21, 0x1e000
  s_nop 0
  buffer_load_dwordx4 v115, s[12:15], s46 offen lds
  s_waitcnt lgkmcnt(4)
  v_mfma_f32_32x32x16_bf16 v[64:79], v[136:139], v[144:147], v[64:79]
  ds_read_b64_tr_b16 v[132:133], v97 offset:4096
  ds_read_b64_tr_b16 v[134:135], v97 offset:5120
  s_waitcnt lgkmcnt(4)
  v_mfma_f32_32x32x16_bf16 v[80:95], v[140:143], v[144:147], v[80:95]
  ds_read_b64_tr_b16 v[136:137], v98 offset:4096
  ds_read_b64_tr_b16 v[138:139], v98 offset:5120
  s_waitcnt lgkmcnt(4)
  v_mfma_f32_32x32x16_bf16 v[32:47], v[128:131], v[148:151], v[32:47]
  ds_read_b64_tr_b16 v[140:141], v99 offset:4096
  ds_read_b64_tr_b16 v[142:143], v99 offset:5120
  s_waitcnt lgkmcnt(4)
  v_mfma_f32_32x32x16_bf16 v[48:63], v[132:135], v[148:151], v[48:63]
  ds_read_b64_tr_b16 v[128:129], v96 offset:8192
  ds_read_b64_tr_b16 v[130:131], v96 offset:9216
  s_waitcnt lgkmcnt(4)
  v_mfma_f32_32x32x16_bf16 v[64:79], v[136:139], v[148:151], v[64:79]
  ds_read_b64_tr_b16 v[132:133], v97 offset:8192
  ds_read_b64_tr_b16 v[134:135], v97 offset:9216
  s_waitcnt lgkmcnt(4)
  v_mfma_f32_32x32x16_bf16 v[80:95], v[140:143], v[148:151], v[80:95]
  ds_read_b64_tr_b16 v[136:137], v98 offset:8192
  ds_read_b64_tr_b16 v[138:139], v98 offset:9216
  s_waitcnt lgkmcnt(4)
  v_mfma_f32_32x32x16_bf16 v[32:47], v[128:131], v[152:155], v[32:47]
  ds_read_b64_tr_b16 v[140:141], v99 offset:8192
  ds_read_b64_tr_b16 v[142:143], v99 offset:9216
  s_waitcnt lgkmcnt(4)
  v_mfma_f32_32x32x16_bf16 v[48:63], v[132:135], v[152:155], v[48:63]
  ds_read_b64_tr_b16 v[128:129], v96 offset:12288
  ds_read_b64_tr_b16 v[130:131], v96 offset:13312
  s_waitcnt lgkmcnt(4)
  v_mfma_f32_32x32x16_bf16 v[64:79], v[136:139], v[152:155], v[64:79]
  ds_read_b64_tr_b16 v[132:133], v97 offset:12288
  ds_read_b64_tr_b16 v[134:135], v97 offset:13312
  s_waitcnt lgkmcnt(4)
  v_mfma_f32_32x32x16_bf16 v[80:95], v[140:143], v[152:155], v[80:95]
  ds_read_b64_tr_b16 v[136:137], v98 offset:12288
  ds_read_b64_tr_b16 v[138:139], v98 offset:13312
  s_waitcnt lgkmcnt(4)
  v_mfma_f32_32x32x16_bf16 v[32:47], v[128:131], v[156:159], v[32:47]
  ds_read_b64_tr_b16 v[140:141], v99 offset:12288
  ds_read_b64_tr_b16 v[142:143], v99 offset:13312
  s_waitcnt vmcnt(0) lgkmcnt(0)
  s_barrier
  ds_read_b128 v[160:163], v108
  ds_read_b128 v[164:167], v109
  ds_read_b128 v[168:171], v110
  ds_read_b128 v[172:175], v111
  v_mfma_f32_32x32x16_bf16 v[48:63], v[132:135], v[156:159], v[48:63]
  ds_read_b64_tr_b16 v[128:129], v96 offset:16384
  ds_read_b64_tr_b16 v[130:131], v96 offset:17408
  s_add_u32 m0, s33, 0x8000
  s_mov_b32 s46, 0x400
  buffer_load_dwordx4 v112, s[16:19], s46 offen lds
  s_add_u32 m0, s33, 0x8400
  v_mfma_f32_32x32x16_bf16 v[64:79], v[136:139], v[156:159], v[64:79]
  ds_read_b64_tr_b16 v[132:133], v97 offset:16384
  ds_read_b64_tr_b16 v[134:135], v97 offset:17408
  s_mov_b32 s46, 0x2800
  buffer_load_dwordx4 v113, s[16:19], s46 offen lds
  s_add_u32 m0, s33, 0x8800
  s_mov_b32 s46, 0x4c00
  v_mfma_f32_32x32x16_bf16 v[80:95], v[140:143], v[156:159], v[80:95]
  ds_read_b64_tr_b16 v[136:137], v98 offset:16384
  ds_read_b64_tr_b16 v[138:139], v98 offset:17408
  buffer_load_dwordx4 v112, s[16:19], s46 offen lds
  s_add_u32 m0, s33, 0x8c00
  s_mov_b32 s46, 0x7000
  buffer_load_dwordx4 v113, s[16:19], s46 offen lds
  s_waitcnt lgkmcnt(4)
  v_mfma_f32_32x32x16_bf16 v[32:47], v[128:131], v[160:163], v[32:47]
  ds_read_b64_tr_b16 v[140:141], v99 offset:16384
  ds_read_b64_tr_b16 v[142:143], v99 offset:17408
  s_mov_b32 s46, 0x400000
  s_add_u32 m0, s21, 0x18000
  s_nop 0
  buffer_load_dwordx4 v114, s[12:15], s46 offen lds
  s_waitcnt lgkmcnt(4)
  v_mfma_f32_32x32x16_bf16 v[48:63], v[132:135], v[160:163], v[48:63]
  ds_read_b64_tr_b16 v[128:129], v96 offset:20480
  ds_read_b64_tr_b16 v[130:131], v96 offset:21504
  s_add_u32 m0, s21, 0x1a000
  s_nop 0
  buffer_load_dwordx4 v115, s[12:15], s46 offen lds
  s_mov_b32 s46, 0x80000
  s_waitcnt lgkmcnt(4)
  v_mfma_f32_32x32x16_bf16 v[64:79], v[136:139], v[160:163], v[64:79]
  ds_read_b64_tr_b16 v[132:133], v97 offset:20480
  ds_read_b64_tr_b16 v[134:135], v97 offset:21504
  s_add_u32 m0, s21, 0x4000
  s_nop 0
  buffer_load_dwordx4 v17, s[4:7], s46 offen lds
  s_add_u32 m0, s21, 0x6000
  s_waitcnt lgkmcnt(4)
  v_mfma_f32_32x32x16_bf16 v[80:95], v[140:143], v[160:163], v[80:95]
  ds_read_b64_tr_b16 v[136:137], v98 offset:20480
  ds_read_b64_tr_b16 v[138:139], v98 offset:21504
  s_nop 0
  buffer_load_dwordx4 v18, s[4:7], s46 offen lds
  s_mov_b32 s46, 0x80
  s_add_u32 m0, s21, 0x14000
  s_waitcnt lgkmcnt(4)
  v_mfma_f32_32x32x16_bf16 v[32:47], v[128:131], v[164:167], v[32:47]
  ds_read_b64_tr_b16 v[140:141], v99 offset:20480
  ds_read_b64_tr_b16 v[142:143], v99 offset:21504
  s_nop 0
  buffer_load_dwordx4 v19, s[8:11], s46 offen lds
  s_add_u32 m0, s21, 0x16000
  s_nop 0
  s_waitcnt lgkmcnt(4)
  v_mfma_f32_32x32x16_bf16 v[48:63], v[132:135], v[164:167], v[48:63]
  ds_read_b64_tr_b16 v[128:129], v96 offset:24576
  ds_read_b64_tr_b16 v[130:131], v96 offset:25600
  buffer_load_dwordx4 v20, s[8:11], s46 offen lds
  s_waitcnt lgkmcnt(4)
  v_mfma_f32_32x32x16_bf16 v[64:79], v[136:139], v[164:167], v[64:79]
  ds_read_b64_tr_b16 v[132:133], v97 offset:24576
  ds_read_b64_tr_b16 v[134:135], v97 offset:25600
  s_waitcnt lgkmcnt(4)
  v_mfma_f32_32x32x16_bf16 v[80:95], v[140:143], v[164:167], v[80:95]
  ds_read_b64_tr_b16 v[136:137], v98 offset:24576
  ds_read_b64_tr_b16 v[138:139], v98 offset:25600
  s_waitcnt lgkmcnt(4)
  v_mfma_f32_32x32x16_bf16 v[32:47], v[128:131], v[168:171], v[32:47]
  ds_read_b64_tr_b16 v[140:141], v99 offset:24576
  ds_read_b64_tr_b16 v[142:143], v99 offset:25600
  s_waitcnt lgkmcnt(4)
  v_mfma_f32_32x32x16_bf16 v[48:63], v[132:135], v[168:171], v[48:63]
  ds_read_b64_tr_b16 v[128:129], v96 offset:28672
  ds_read_b64_tr_b16 v[130:131], v96 offset:29696
  s_waitcnt lgkmcnt(4)
  v_mfma_f32_32x32x16_bf16 v[64:79], v[136:139], v[168:171], v[64:79]
  ds_read_b64_tr_b16 v[132:133], v97 offset:28672
  ds_read_b64_tr_b16 v[134:135], v97 offset:29696
  s_waitcnt lgkmcnt(4)
  v_mfma_f32_32x32x16_bf16 v[80:95], v[140:143], v[168:171], v[80:95]
  ds_read_b64_tr_b16 v[136:137], v98 offset:28672
  ds_read_b64_tr_b16 v[138:139], v98 offset:29696
  s_waitcnt lgkmcnt(4)
  v_mfma_f32_32x32x16_bf16 v[32:47], v[128:131], v[172:175], v[32:47]
  ds_read_b64_tr_b16 v[140:141], v99 offset:28672
  ds_read_b64_tr_b16 v[142:143], v99 offset:29696
  s_waitcnt vmcnt(4) lgkmcnt(0)
  s_barrier
  ds_read_b128 v[144:147], v104
  ds_read_b128 v[148:151], v105
  ds_read_b128 v[152:155], v106
  ds_read_b128 v[156:159], v107
  v_mfma_f32_32x32x16_bf16 v[48:63], v[132:135], v[172:175], v[48:63]
  ds_read_b64_tr_b16 v[128:129], v96 offset:0
  ds_read_b64_tr_b16 v[130:131], v96 offset:1024
  v_mfma_f32_32x32x16_bf16 v[64:79], v[136:139], v[172:175], v[64:79]
  ds_read_b64_tr_b16 v[132:133], v97 offset:0
  ds_read_b64_tr_b16 v[134:135], v97 offset:1024
  v_mfma_f32_32x32x16_bf16 v[80:95], v[140:143], v[172:175], v[80:95]
  ds_read_b64_tr_b16 v[136:137], v98 offset:0
  ds_read_b64_tr_b16 v[138:139], v98 offset:1024
  s_waitcnt lgkmcnt(4)
  v_mfma_f32_32x32x16_bf16 v[32:47], v[128:131], v[144:147], v[32:47]
  ds_read_b64_tr_b16 v[140:141], v99 offset:0
  ds_read_b64_tr_b16 v[142:143], v99 offset:1024
  s_waitcnt lgkmcnt(4)
  v_mfma_f32_32x32x16_bf16 v[48:63], v[132:135], v[144:147], v[48:63]
  ds_read_b64_tr_b16 v[128:129], v96 offset:4096
  ds_read_b64_tr_b16 v[130:131], v96 offset:5120
  s_waitcnt lgkmcnt(4)
  v_mfma_f32_32x32x16_bf16 v[64:79], v[136:139], v[144:147], v[64:79]
  ds_read_b64_tr_b16 v[132:133], v97 offset:4096
  ds_read_b64_tr_b16 v[134:135], v97 offset:5120
  s_waitcnt lgkmcnt(4)
  v_mfma_f32_32x32x16_bf16 v[80:95], v[140:143], v[144:147], v[80:95]
  ds_read_b64_tr_b16 v[136:137], v98 offset:4096
  ds_read_b64_tr_b16 v[138:139], v98 offset:5120
  s_waitcnt lgkmcnt(4)
  v_mfma_f32_32x32x16_bf16 v[32:47], v[128:131], v[148:151], v[32:47]
  ds_read_b64_tr_b16 v[140:141], v99 offset:4096
  ds_read_b64_tr_b16 v[142:143], v99 offset:5120
  s_waitcnt lgkmcnt(4)
  v_mfma_f32_32x32x16_bf16 v[48:63], v[132:135], v[148:151], v[48:63]
  ds_read_b64_tr_b16 v[128:129], v96 offset:8192
  ds_read_b64_tr_b16 v[130:131], v96 offset:9216
  s_waitcnt lgkmcnt(4)
  v_mfma_f32_32x32x16_bf16 v[64:79], v[136:139], v[148:151], v[64:79]
  ds_read_b64_tr_b16 v[132:133], v97 offset:8192
  ds_read_b64_tr_b16 v[134:135], v97 offset:9216
  s_waitcnt lgkmcnt(4)
  v_mfma_f32_32x32x16_bf16 v[80:95], v[140:143], v[148:151], v[80:95]
  ds_read_b64_tr_b16 v[136:137], v98 offset:8192
  ds_read_b64_tr_b16 v[138:139], v98 offset:9216
  s_waitcnt lgkmcnt(4)
  v_mfma_f32_32x32x16_bf16 v[32:47], v[128:131], v[152:155], v[32:47]
  ds_read_b64_tr_b16 v[140:141], v99 offset:8192
  ds_read_b64_tr_b16 v[142:143], v99 offset:9216
  s_waitcnt lgkmcnt(4)
  v_mfma_f32_32x32x16_bf16 v[48:63], v[132:135], v[152:155], v[48:63]
  ds_read_b64_tr_b16 v[128:129], v96 offset:12288
  ds_read_b64_tr_b16 v[130:131], v96 offset:13312
  s_waitcnt lgkmcnt(4)
  v_mfma_f32_32x32x16_bf16 v[64:79], v[136:139], v[152:155], v[64:79]
  ds_read_b64_tr_b16 v[132:133], v97 offset:12288
  ds_read_b64_tr_b16 v[134:135], v97 offset:13312
  s_waitcnt lgkmcnt(4)
  v_mfma_f32_32x32x16_bf16 v[80:95], v[140:143], v[152:155], v[80:95]
  ds_read_b64_tr_b16 v[136:137], v98 offset:12288
  ds_read_b64_tr_b16 v[138:139], v98 offset:13312
  s_waitcnt lgkmcnt(4)
  v_mfma_f32_32x32x16_bf16 v[32:47], v[128:131], v[156:159], v[32:47]
  ds_read_b64_tr_b16 v[140:141], v99 offset:12288
  ds_read_b64_tr_b16 v[142:143], v99 offset:13312
  s_waitcnt lgkmcnt(4)
  v_mfma_f32_32x32x16_bf16 v[48:63], v[132:135], v[156:159], v[48:63]
  s_waitcnt lgkmcnt(2)
  v_mfma_f32_32x32x16_bf16 v[64:79], v[136:139], v[156:159], v[64:79]
  s_waitcnt lgkmcnt(0)
  v_mfma_f32_32x32x16_bf16 v[80:95], v[140:143], v[156:159], v[80:95]
  s_waitcnt vmcnt(18) lgkmcnt(0)
  s_barrier
  s_mov_b32 s46, 0x100000
  s_add_u32 m0, s21, 0x8000
  s_nop 0
  buffer_load_dwordx4 v17, s[4:7], s46 offen lds
  s_add_u32 m0, s21, 0xa000
  s_nop 0
  buffer_load_dwordx4 v18, s[4:7], s46 offen lds
  s_mov_b32 s46, 0x100
  s_add_u32 m0, s21, 0x18000
  s_nop 0
  buffer_load_dwordx4 v19, s[8:11], s46 offen lds
  s_add_u32 m0, s21, 0x1a000
  s_nop 0
  buffer_load_dwordx4 v20, s[8:11], s46 offen lds
  s_mov_b32 s46, 0x180000
  s_add_u32 m0, s21, 0xc000
  s_nop 0
  buffer_load_dwordx4 v17, s[4:7], s46 offen lds
  s_add_u32 m0, s21, 0xe000
  s_nop 0
  buffer_load_dwordx4 v18, s[4:7], s46 offen lds
  v_and_b32 v2, 31, v1
  v_lshlrev_b32 v2, 8, v2
  v_lshrrev_b32 v3, 5, v1
  v_xor_b32 v3, v3, v1
  v_and_b32 v3, 15, v3
  v_xor_b32 v4, 0, v3
  v_lshl_add_u32 v5, v4, 4, v2
  v_xor_b32 v4, 2, v3
  v_lshl_add_u32 v6, v4, 4, v2
  v_xor_b32 v4, 4, v3
  v_lshl_add_u32 v7, v4, 4, v2
  v_xor_b32 v4, 6, v3
  v_lshl_add_u32 v8, v4, 4, v2
  v_xor_b32 v4, 8, v3
  v_lshl_add_u32 v9, v4, 4, v2
  v_xor_b32 v4, 10, v3
  v_lshl_add_u32 v10, v4, 4, v2
  v_xor_b32 v4, 12, v3
  v_lshl_add_u32 v11, v4, 4, v2
  v_xor_b32 v4, 14, v3
  v_lshl_add_u32 v12, v4, 4, v2
  ds_read_b128 v[192:195], v5 offset:0
  ds_read_b128 v[196:199], v6 offset:0
  ds_read_b128 v[200:203], v7 offset:0
  ds_read_b128 v[204:207], v8 offset:0
  ds_read_b128 v[208:211], v9 offset:0
  ds_read_b128 v[212:215], v10 offset:0
  ds_read_b128 v[216:219], v11 offset:0
  ds_read_b128 v[220:223], v12 offset:0
  v_and_b32 v23, 31, v1
  s_and_b32 s46, s22, 32
  v_add_u32 v23, s46, v23
  v_lshrrev_b32 v3, 5, v1
  v_lshlrev_b32 v3, 2, v3
  v_sub_u32 v23, v23, v3
  v_mov_b32 v24, 0xff800000
  s_mov_b32 s46, 0x3e0293ee
  v_mul_f32 v32, s46, v32
  v_mul_f32 v33, s46, v33
  v_mul_f32 v34, s46, v34
  v_mul_f32 v35, s46, v35
  v_mul_f32 v36, s46, v36
  v_mul_f32 v37, s46, v37
  v_mul_f32 v38, s46, v38
  v_mul_f32 v39, s46, v39
  v_mul_f32 v40, s46, v40
  v_mul_f32 v41, s46, v41
  v_mul_f32 v42, s46, v42
  v_mul_f32 v43, s46, v43
  v_mul_f32 v44, s46, v44
  v_mul_f32 v45, s46, v45
  v_mul_f32 v46, s46, v46
  v_mul_f32 v47, s46, v47
  v_cvt_pk_bf16_f32 v160, v32, v33
  v_cvt_pk_bf16_f32 v161, v34, v35
  v_cvt_pk_bf16_f32 v162, v40, v41
  v_cvt_pk_bf16_f32 v163, v42, v43
  v_cvt_pk_bf16_f32 v164, v36, v37
  v_cvt_pk_bf16_f32 v165, v38, v39
  v_cvt_pk_bf16_f32 v166, v44, v45
  v_cvt_pk_bf16_f32 v167, v46, v47
  v_mul_f32 v48, s46, v48
  v_mul_f32 v49, s46, v49
  v_mul_f32 v50, s46, v50
  v_mul_f32 v51, s46, v51
  v_mul_f32 v52, s46, v52
  v_mul_f32 v53, s46, v53
  v_mul_f32 v54, s46, v54
  v_mul_f32 v55, s46, v55
  v_mul_f32 v56, s46, v56
  v_mul_f32 v57, s46, v57
  v_mul_f32 v58, s46, v58
  v_mul_f32 v59, s46, v59
  v_mul_f32 v60, s46, v60
  v_mul_f32 v61, s46, v61
  v_mul_f32 v62, s46, v62
  v_mul_f32 v63, s46, v63
  v_cvt_pk_bf16_f32 v168, v48, v49
  v_cvt_pk_bf16_f32 v169, v50, v51
  v_cvt_pk_bf16_f32 v170, v56, v57
  v_cvt_pk_bf16_f32 v171, v58, v59
  v_cvt_pk_bf16_f32 v172, v52, v53
  v_cvt_pk_bf16_f32 v173, v54, v55
  v_cvt_pk_bf16_f32 v174, v60, v61
  v_cvt_pk_bf16_f32 v175, v62, v63
  v_mul_f32 v64, s46, v64
  v_mul_f32 v65, s46, v65
  v_mul_f32 v66, s46, v66
  v_mul_f32 v67, s46, v67
  v_mul_f32 v68, s46, v68
  v_mul_f32 v69, s46, v69
  v_mul_f32 v70, s46, v70
  v_mul_f32 v71, s46, v71
  v_mul_f32 v72, s46, v72
  v_mul_f32 v73, s46, v73
  v_mul_f32 v74, s46, v74
  v_mul_f32 v75, s46, v75
  v_mul_f32 v76, s46, v76
  v_mul_f32 v77, s46, v77
  v_mul_f32 v78, s46, v78
  v_mul_f32 v79, s46, v79
  v_cvt_pk_bf16_f32 v176, v64, v65
  v_cvt_pk_bf16_f32 v177, v66, v67
  v_cvt_pk_bf16_f32 v178, v72, v73
  v_cvt_pk_bf16_f32 v179, v74, v75
  v_cvt_pk_bf16_f32 v180, v68, v69
  v_cvt_pk_bf16_f32 v181, v70, v71
  v_cvt_pk_bf16_f32 v182, v76, v77
  v_cvt_pk_bf16_f32 v183, v78, v79
  v_mul_f32 v80, s46, v80
  v_mul_f32 v81, s46, v81
  v_mul_f32 v82, s46, v82
  v_mul_f32 v83, s46, v83
  v_mul_f32 v84, s46, v84
  v_mul_f32 v85, s46, v85
  v_mul_f32 v86, s46, v86
  v_mul_f32 v87, s46, v87
  v_mul_f32 v88, s46, v88
  v_mul_f32 v89, s46, v89
  v_mul_f32 v90, s46, v90
  v_mul_f32 v91, s46, v91
  v_mul_f32 v92, s46, v92
  v_mul_f32 v93, s46, v93
  v_mul_f32 v94, s46, v94
  v_mul_f32 v95, s46, v95
  v_cvt_pk_bf16_f32 v184, v80, v81
  v_cvt_pk_bf16_f32 v185, v82, v83
  v_cvt_pk_bf16_f32 v186, v88, v89
  v_cvt_pk_bf16_f32 v187, v90, v91
  v_cvt_pk_bf16_f32 v188, v84, v85
  v_cvt_pk_bf16_f32 v189, v86, v87
  v_cvt_pk_bf16_f32 v190, v92, v93
  v_cvt_pk_bf16_f32 v191, v94, v95
  v_mov_b32 v22, 0
  s_waitcnt lgkmcnt(7)
  v_mfma_f32_32x32x16_bf16 v[96:111], v[192:195], v[160:163], 0
  ds_read_b128 v[192:195], v5 offset:8192
  v_mov_b32 v32, 0
  v_mov_b32 v33, 0
  v_mov_b32 v34, 0
  v_mov_b32 v35, 0
  s_waitcnt lgkmcnt(7)
  v_mfma_f32_32x32x16_bf16 v[96:111], v[196:199], v[164:167], v[96:111]
  ds_read_b128 v[196:199], v6 offset:8192
  v_mov_b32 v36, 0
  v_mov_b32 v37, 0
  v_mov_b32 v38, 0
  v_mov_b32 v39, 0
  s_waitcnt lgkmcnt(7)
  v_mfma_f32_32x32x16_bf16 v[96:111], v[200:203], v[168:171], v[96:111]
  ds_read_b128 v[200:203], v7 offset:8192
  v_mov_b32 v40, 0
  v_mov_b32 v41, 0
  v_mov_b32 v42, 0
  v_mov_b32 v43, 0
  s_waitcnt lgkmcnt(7)
  v_mfma_f32_32x32x16_bf16 v[96:111], v[204:207], v[172:175], v[96:111]
  ds_read_b128 v[204:207], v8 offset:8192
  v_mov_b32 v44, 0
  v_mov_b32 v45, 0
  v_mov_b32 v46, 0
  v_mov_b32 v47, 0
  s_waitcnt lgkmcnt(7)
  v_mfma_f32_32x32x16_bf16 v[96:111], v[208:211], v[176:179], v[96:111]
  ds_read_b128 v[208:211], v9 offset:8192
  v_mov_b32 v48, 0
  v_mov_b32 v49, 0
  v_mov_b32 v50, 0
  v_mov_b32 v51, 0
  s_waitcnt lgkmcnt(7)
  v_mfma_f32_32x32x16_bf16 v[96:111], v[212:215], v[180:183], v[96:111]
  ds_read_b128 v[212:215], v10 offset:8192
  v_mov_b32 v52, 0
  v_mov_b32 v53, 0
  v_mov_b32 v54, 0
  v_mov_b32 v55, 0
  s_waitcnt lgkmcnt(7)
  v_mfma_f32_32x32x16_bf16 v[96:111], v[216:219], v[184:187], v[96:111]
  ds_read_b128 v[216:219], v11 offset:8192
  v_mov_b32 v56, 0
  v_mov_b32 v57, 0
  v_mov_b32 v58, 0
  v_mov_b32 v59, 0
  s_waitcnt lgkmcnt(7)
  v_mfma_f32_32x32x16_bf16 v[96:111], v[220:223], v[188:191], v[96:111]
  ds_read_b128 v[220:223], v12 offset:8192
  v_mov_b32 v60, 0
  v_mov_b32 v61, 0
  v_mov_b32 v62, 0
  v_mov_b32 v63, 0
  s_waitcnt lgkmcnt(7)
  v_mfma_f32_32x32x16_bf16 v[112:127], v[192:195], v[160:163], 0
  v_mov_b32 v64, 0
  v_mov_b32 v65, 0
  v_mov_b32 v66, 0
  v_mov_b32 v67, 0
  s_waitcnt lgkmcnt(6)
  v_mfma_f32_32x32x16_bf16 v[112:127], v[196:199], v[164:167], v[112:127]
  v_mov_b32 v68, 0
  v_mov_b32 v69, 0
  v_mov_b32 v70, 0
  v_mov_b32 v71, 0
  s_waitcnt lgkmcnt(5)
  v_mfma_f32_32x32x16_bf16 v[112:127], v[200:203], v[168:171], v[112:127]
  v_mov_b32 v72, 0
  v_mov_b32 v73, 0
  v_mov_b32 v74, 0
  v_mov_b32 v75, 0
  s_waitcnt lgkmcnt(4)
  v_mfma_f32_32x32x16_bf16 v[112:127], v[204:207], v[172:175], v[112:127]
  v_mov_b32 v76, 0
  v_mov_b32 v77, 0
  v_mov_b32 v78, 0
  v_mov_b32 v79, 0
  s_waitcnt lgkmcnt(3)
  v_mfma_f32_32x32x16_bf16 v[112:127], v[208:211], v[176:179], v[112:127]
  v_mov_b32 v80, 0
  v_mov_b32 v81, 0
  v_mov_b32 v82, 0
  v_mov_b32 v83, 0
  s_waitcnt lgkmcnt(2)
  v_mfma_f32_32x32x16_bf16 v[112:127], v[212:215], v[180:183], v[112:127]
  v_mov_b32 v84, 0
  v_mov_b32 v85, 0
  v_mov_b32 v86, 0
  v_mov_b32 v87, 0
  s_waitcnt lgkmcnt(1)
  v_mfma_f32_32x32x16_bf16 v[112:127], v[216:219], v[184:187], v[112:127]
  v_mov_b32 v88, 0
  v_mov_b32 v89, 0
  v_mov_b32 v90, 0
  v_mov_b32 v91, 0
  s_waitcnt lgkmcnt(0)
  v_mfma_f32_32x32x16_bf16 v[112:127], v[220:223], v[188:191], v[112:127]
  v_mov_b32 v92, 0
  v_mov_b32 v93, 0
  v_mov_b32 v94, 0
  v_mov_b32 v95, 0
  s_cmp_eq_u32 s23, 0
  s_cbranch_scc0 6f
  s_nop 7
  s_nop 3
  v_cmp_gt_i32 s[34:35], 0, v23
  v_cmp_gt_i32 s[36:37], 1, v23
  v_cmp_gt_i32 s[38:39], 2, v23
  v_cndmask_b32 v96, v96, v24, s[34:35]
  v_cmp_gt_i32 s[34:35], 3, v23
  v_cndmask_b32 v97, v97, v24, s[36:37]
  v_cmp_gt_i32 s[36:37], 8, v23
  v_cndmask_b32 v98, v98, v24, s[38:39]
  v_cmp_gt_i32 s[38:39], 9, v23
  v_cndmask_b32 v99, v99, v24, s[34:35]
  v_cmp_gt_i32 s[34:35], 10, v23
  v_cndmask_b32 v100, v100, v24, s[36:37]
  v_cmp_gt_i32 s[36:37], 11, v23
  v_cndmask_b32 v101, v101, v24, s[38:39]
  v_cmp_gt_i32 s[38:39], 16, v23
  v_cndmask_b32 v102, v102, v24, s[34:35]
  v_cmp_gt_i32 s[34:35], 17, v23
  v_cndmask_b32 v103, v103, v24, s[36:37]
  v_cmp_gt_i32 s[36:37], 18, v23
  v_cndmask_b32 v104, v104, v24, s[38:39]
  v_cmp_gt_i32 s[38:39], 19, v23
  v_cndmask_b32 v105, v105, v24, s[34:35]
  v_cmp_gt_i32 s[34:35], 24, v23
  v_cndmask_b32 v106, v106, v24, s[36:37]
  v_cmp_gt_i32 s[36:37], 25, v23
  v_cndmask_b32 v107, v107, v24, s[38:39]
  v_cmp_gt_i32 s[38:39], 26, v23
  v_cndmask_b32 v108, v108, v24, s[34:35]
  v_cmp_gt_i32 s[34:35], 27, v23
  v_cndmask_b32 v109, v109, v24, s[36:37]
  v_cmp_gt_i32 s[36:37], 32, v23
  v_cndmask_b32 v110, v110, v24, s[38:39]
  v_cmp_gt_i32 s[38:39], 33, v23
  v_cndmask_b32 v111, v111, v24, s[34:35]
  v_cmp_gt_i32 s[34:35], 34, v23
  v_cndmask_b32 v112, v112, v24, s[36:37]
  v_cmp_gt_i32 s[36:37], 35, v23
  v_cndmask_b32 v113, v113, v24, s[38:39]
  v_cmp_gt_i32 s[38:39], 40, v23
  v_cndmask_b32 v114, v114, v24, s[34:35]
  v_cmp_gt_i32 s[34:35], 41, v23
  v_cndmask_b32 v115, v115, v24, s[36:37]
  v_cmp_gt_i32 s[36:37], 42, v23
  v_cndmask_b32 v116, v116, v24, s[38:39]
  v_cmp_gt_i32 s[38:39], 43, v23
  v_cndmask_b32 v117, v117, v24, s[34:35]
  v_cmp_gt_i32 s[34:35], 48, v23
  v_cndmask_b32 v118, v118, v24, s[36:37]
  v_cmp_gt_i32 s[36:37], 49, v23
  v_cndmask_b32 v119, v119, v24, s[38:39]
  v_cmp_gt_i32 s[38:39], 50, v23
  v_cndmask_b32 v120, v120, v24, s[34:35]
  v_cmp_gt_i32 s[34:35], 51, v23
  v_cndmask_b32 v121, v121, v24, s[36:37]
  v_cmp_gt_i32 s[36:37], 56, v23
  v_cndmask_b32 v122, v122, v24, s[38:39]
  v_cmp_gt_i32 s[38:39], 57, v23
  v_cndmask_b32 v123, v123, v24, s[34:35]
  v_cmp_gt_i32 s[34:35], 58, v23
  v_cndmask_b32 v124, v124, v24, s[36:37]
  v_cmp_gt_i32 s[36:37], 59, v23
  v_cndmask_b32 v125, v125, v24, s[38:39]
  s_nop 0
  v_cndmask_b32 v126, v126, v24, s[34:35]
  s_nop 0
  v_cndmask_b32 v127, v127, v24, s[36:37]
6:
  s_nop 7
  s_nop 3
  v_max3_f32 v25, v96, v97, v98
  v_max3_f32 v25, v25, v99, v100
  v_max3_f32 v25, v25, v101, v102
  v_max3_f32 v25, v25, v103, v104
  v_max3_f32 v25, v25, v105, v106
  v_max3_f32 v25, v25, v107, v108
  v_max3_f32 v25, v25, v109, v110
  v_max3_f32 v26, v112, v113, v114
  v_max3_f32 v26, v26, v115, v116
  v_max3_f32 v26, v26, v117, v118
  v_max3_f32 v26, v26, v119, v120
  v_max3_f32 v26, v26, v121, v122
  v_max3_f32 v26, v26, v123, v124
  v_max3_f32 v26, v26, v125, v126
  v_max3_f32 v25, v25, v111, v127
  v_max_f32 v25, v25, v26
  v_cmp_lt_f32 vcc, s31, v25
  v_mov_b32 v26, v25
  s_nop 1
  v_permlane32_swap_b32 v25, v26
  s_nop 1
  v_max_f32 v25, v25, v26
  v_sub_f32 v96, v96, v25
  v_sub_f32 v97, v97, v25
  v_sub_f32 v98, v98, v25
  v_sub_f32 v99, v99, v25
  v_sub_f32 v100, v100, v25
  v_sub_f32 v101, v101, v25
  v_sub_f32 v102, v102, v25
  v_sub_f32 v103, v103, v25
  v_sub_f32 v104, v104, v25
  v_sub_f32 v105, v105, v25
  v_sub_f32 v106, v106, v25
  v_sub_f32 v107, v107, v25
  v_sub_f32 v108, v108, v25
  v_sub_f32 v109, v109, v25
  v_sub_f32 v110, v110, v25
  v_sub_f32 v111, v111, v25
  v_sub_f32 v112, v112, v25
  v_sub_f32 v113, v113, v25
  v_sub_f32 v114, v114, v25
  v_sub_f32 v115, v115, v25
  v_sub_f32 v116, v116, v25
  v_sub_f32 v117, v117, v25
  v_sub_f32 v118, v118, v25
  v_sub_f32 v119, v119, v25
  v_sub_f32 v120, v120, v25
  v_sub_f32 v121, v121, v25
  v_sub_f32 v122, v122, v25
  v_sub_f32 v123, v123, v25
  v_sub_f32 v124, v124, v25
  v_sub_f32 v125, v125, v25
  v_sub_f32 v126, v126, v25
  v_sub_f32 v127, v127, v25
  v_sub_f32 v232, 0, v25
  v_sub_f32 v233, 0, v25
  v_sub_f32 v234, 0, v25
  v_sub_f32 v235, 0, v25
  v_sub_f32 v236, 0, v25
  v_sub_f32 v237, 0, v25
  v_sub_f32 v238, 0, v25
  v_sub_f32 v239, 0, v25
  v_sub_f32 v240, 0, v25
  v_sub_f32 v241, 0, v25
  v_sub_f32 v242, 0, v25
  v_sub_f32 v243, 0, v25
  v_sub_f32 v244, 0, v25
  v_sub_f32 v245, 0, v25
  v_sub_f32 v246, 0, v25
  v_sub_f32 v247, 0, v25
  s_mov_b32 s25, 0
  s_mov_b32 s26, 0x200000
  s_mov_b32 s27, 0x180
  s_waitcnt vmcnt(8) lgkmcnt(0)
  s_barrier
  ds_read_b128 v[192:195], v5 offset:16384
  ds_read_b128 v[196:199], v6 offset:16384
  ds_read_b128 v[200:203], v7 offset:16384
  ds_read_b128 v[204:207], v8 offset:16384
  ds_read_b128 v[208:211], v9 offset:16384
  ds_read_b128 v[212:215], v10 offset:16384
  ds_read_b128 v[216:219], v11 offset:16384
  ds_read_b128 v[220:223], v12 offset:16384
  s_cmp_eq_u32 s23, 0
  s_cbranch_scc1 attn_kernel_fin0
attn_kernel_body0:
  s_waitcnt lgkmcnt(6)
  v_mfma_f32_32x32x16_bf16 v[128:143], v[192:195], v[160:163], v[232:247]
  ds_read_b128 v[192:195], v5 offset:24576
  v_exp_f32 v96, v96
  v_exp_f32 v97, v97
  v_exp_f32 v98, v98
  s_add_u32 m0, s21, 0x0
  v_mfma_f32_32x32x16_bf16 v[128:143], v[196:199], v[164:167], v[128:143]
  ds_read_b128 v[196:199], v6 offset:24576
  buffer_load_dwordx4 v17, s[4:7], s26 offen lds
  v_exp_f32 v99, v99
  v_add_f32 v22, v22, v96
  s_waitcnt lgkmcnt(6)
  v_mfma_f32_32x32x16_bf16 v[128:143], v[200:203], v[168:171], v[128:143]
  ds_read_b128 v[200:203], v7 offset:24576
  v_add_f32 v22, v22, v97
  v_cvt_pk_bf16_f32 v96, v96, v97
  v_exp_f32 v104, v104
  v_exp_f32 v105, v105
  v_mfma_f32_32x32x16_bf16 v[128:143], v[204:207], v[172:175], v[128:143]
  ds_read_b128 v[204:207], v8 offset:24576
  v_add_f32 v22, v22, v98
  v_add_f32 v22, v22, v99
  v_cvt_pk_bf16_f32 v97, v98, v99
  s_waitcnt lgkmcnt(4)
  v_mfma_f32_32x32x16_bf16 v[128:143], v[208:211], v[176:179], v[128:143]
  ds_read_b128 v[208:211], v9 offset:24576
  v_exp_f32 v106, v106
  v_exp_f32 v107, v107
  s_add_u32 m0, s21, 0x2000
  v_mfma_f32_32x32x16_bf16 v[128:143], v[212:215], v[180:183], v[128:143]
  ds_read_b128 v[212:215], v10 offset:24576
  buffer_load_dwordx4 v18, s[4:7], s26 offen lds
  v_add_f32 v22, v22, v104
  v_add_f32 v22, v22, v105
  v_cvt_pk_bf16_f32 v98, v104, v105
  v_exp_f32 v100, v100
  v_mfma_f32_32x32x16_bf16 v[128:143], v[216:219], v[184:187], v[128:143]
  ds_read_b128 v[216:219], v11 offset:24576
  v_exp_f32 v101, v101
  v_add_f32 v22, v22, v106
  v_add_f32 v22, v22, v107
  v_mfma_f32_32x32x16_bf16 v[128:143], v[220:223], v[188:191], v[128:143]
  ds_read_b128 v[220:223], v12 offset:24576
  v_cvt_pk_bf16_f32 v99, v106, v107
  v_exp_f32 v102, v102
  v_exp_f32 v103, v103
  s_waitcnt lgkmcnt(4)
  v_mfma_f32_32x32x16_bf16 v[144:159], v[192:195], v[160:163], v[232:247]
  ds_read_b128 v[192:195], v13 offset:0
  v_add_f32 v22, v22, v100
  v_add_f32 v22, v22, v101
  v_cvt_pk_bf16_f32 v100, v100, v101
  v_exp_f32 v108, v108
  s_add_u32 m0, s21, 0x1c000
  v_mfma_f32_32x32x16_bf16 v[144:159], v[196:199], v[164:167], v[144:159]
  ds_read_b128 v[196:199], v13 offset:4096
  buffer_load_dwordx4 v19, s[8:11], s27 offen lds
  v_exp_f32 v109, v109
  v_add_f32 v22, v22, v102
  v_mfma_f32_32x32x16_bf16 v[144:159], v[200:203], v[168:171], v[144:159]
  ds_read_b128 v[200:203], v13 offset:8192
  v_add_f32 v22, v22, v103
  v_cvt_pk_bf16_f32 v101, v102, v103
  v_exp_f32 v110, v110
  v_exp_f32 v111, v111
  v_mfma_f32_32x32x16_bf16 v[144:159], v[204:207], v[172:175], v[144:159]
  ds_read_b128 v[204:207], v13 offset:12288
  v_add_f32 v22, v22, v108
  v_add_f32 v22, v22, v109
  v_cvt_pk_bf16_f32 v102, v108, v109
  s_waitcnt lgkmcnt(4)
  v_mfma_f32_32x32x16_bf16 v[144:159], v[208:211], v[176:179], v[144:159]
  ds_read_b128 v[208:211], v14 offset:0
  v_exp_f32 v112, v112
  v_exp_f32 v113, v113
  v_add_f32 v22, v22, v110
  s_add_u32 m0, s21, 0x1e000
  v_mfma_f32_32x32x16_bf16 v[144:159], v[212:215], v[180:183], v[144:159]
  ds_read_b128 v[212:215], v14 offset:4096
  buffer_load_dwordx4 v20, s[8:11], s27 offen lds
  s_add_u32 s26, s26, 0x80000
  s_add_u32 s27, s27, 128
  v_add_f32 v22, v22, v111
  v_cvt_pk_bf16_f32 v103, v110, v111
  v_exp_f32 v114, v114
  v_mfma_f32_32x32x16_bf16 v[144:159], v[216:219], v[184:187], v[144:159]
  ds_read_b128 v[216:219], v14 offset:8192
  v_exp_f32 v115, v115
  v_add_f32 v22, v22, v112
  v_add_f32 v22, v22, v113
  v_mfma_f32_32x32x16_bf16 v[144:159], v[220:223], v[188:191], v[144:159]
  ds_read_b128 v[220:223], v14 offset:12288
  v_cvt_pk_bf16_f32 v112, v112, v113
  v_exp_f32 v120, v120
  v_exp_f32 v121, v121
  s_waitcnt lgkmcnt(4)
  v_mfma_f32_32x32x16_bf16 v[32:47], v[192:195], v[96:99], v[32:47]
  ds_read_b128 v[192:195], v15 offset:0
  v_add_f32 v22, v22, v114
  v_add_f32 v22, v22, v115
  v_cvt_pk_bf16_f32 v113, v114, v115
  v_exp_f32 v122, v122
  v_mfma_f32_32x32x16_bf16 v[48:63], v[196:199], v[96:99], v[48:63]
  ds_read_b128 v[196:199], v15 offset:4096
  s_add_u32 s25, s25, 1
  s_cmp_eq_u32 s25, s23
  s_cbranch_scc0 6f
  s_nop 7
  s_nop 3
  v_cmp_gt_i32 s[34:35], 0, v23
  v_cmp_gt_i32 s[36:37], 1, v23
  v_cmp_gt_i32 s[38:39], 2, v23
  v_cndmask_b32 v128, v128, v24, s[34:35]
  v_cmp_gt_i32 s[34:35], 3, v23
  v_cndmask_b32 v129, v129, v24, s[36:37]
  v_cmp_gt_i32 s[36:37], 8, v23
  v_cndmask_b32 v130, v130, v24, s[38:39]
  v_cmp_gt_i32 s[38:39], 9, v23
  v_cndmask_b32 v131, v131, v24, s[34:35]
  v_cmp_gt_i32 s[34:35], 10, v23
  v_cndmask_b32 v132, v132, v24, s[36:37]
  v_cmp_gt_i32 s[36:37], 11, v23
  v_cndmask_b32 v133, v133, v24, s[38:39]
  v_cmp_gt_i32 s[38:39], 16, v23
  v_cndmask_b32 v134, v134, v24, s[34:35]
  v_cmp_gt_i32 s[34:35], 17, v23
  v_cndmask_b32 v135, v135, v24, s[36:37]
  v_cmp_gt_i32 s[36:37], 18, v23
  v_cndmask_b32 v136, v136, v24, s[38:39]
  v_cmp_gt_i32 s[38:39], 19, v23
  v_cndmask_b32 v137, v137, v24, s[34:35]
  v_cmp_gt_i32 s[34:35], 24, v23
  v_cndmask_b32 v138, v138, v24, s[36:37]
  v_cmp_gt_i32 s[36:37], 25, v23
  v_cndmask_b32 v139, v139, v24, s[38:39]
  v_cmp_gt_i32 s[38:39], 26, v23
  v_cndmask_b32 v140, v140, v24, s[34:35]
  v_cmp_gt_i32 s[34:35], 27, v23
  v_cndmask_b32 v141, v141, v24, s[36:37]
  v_cmp_gt_i32 s[36:37], 32, v23
  v_cndmask_b32 v142, v142, v24, s[38:39]
  v_cmp_gt_i32 s[38:39], 33, v23
  v_cndmask_b32 v143, v143, v24, s[34:35]
  v_cmp_gt_i32 s[34:35], 34, v23
  v_cndmask_b32 v144, v144, v24, s[36:37]
  v_cmp_gt_i32 s[36:37], 35, v23
  v_cndmask_b32 v145, v145, v24, s[38:39]
  v_cmp_gt_i32 s[38:39], 40, v23
  v_cndmask_b32 v146, v146, v24, s[34:35]
  v_cmp_gt_i32 s[34:35], 41, v23
  v_cndmask_b32 v147, v147, v24, s[36:37]
  v_cmp_gt_i32 s[36:37], 42, v23
  v_cndmask_b32 v148, v148, v24, s[38:39]
  v_cmp_gt_i32 s[38:39], 43, v23
  v_cndmask_b32 v149, v149, v24, s[34:35]
  v_cmp_gt_i32 s[34:35], 48, v23
  v_cndmask_b32 v150, v150, v24, s[36:37]
  v_cmp_gt_i32 s[36:37], 49, v23
  v_cndmask_b32 v151, v151, v24, s[38:39]
  v_cmp_gt_i32 s[38:39], 50, v23
  v_cndmask_b32 v152, v152, v24, s[34:35]
  v_cmp_gt_i32 s[34:35], 51, v23
  v_cndmask_b32 v153, v153, v24, s[36:37]
  v_cmp_gt_i32 s[36:37], 56, v23
  v_cndmask_b32 v154, v154, v24, s[38:39]
  v_cmp_gt_i32 s[38:39], 57, v23
  v_cndmask_b32 v155, v155, v24, s[34:35]
  v_cmp_gt_i32 s[34:35], 58, v23
  v_cndmask_b32 v156, v156, v24, s[36:37]
  v_cmp_gt_i32 s[36:37], 59, v23
  v_cndmask_b32 v157, v157, v24, s[38:39]
  s_nop 0
  v_cndmask_b32 v158, v158, v24, s[34:35]
  s_nop 0
  v_cndmask_b32 v159, v159, v24, s[36:37]
6:
  v_exp_f32 v123, v123
  v_add_f32 v22, v22, v120
  v_add_f32 v22, v22, v121
  v_mfma_f32_32x32x16_bf16 v[64:79], v[200:203], v[96:99], v[64:79]
  ds_read_b128 v[200:203], v15 offset:8192
  v_cvt_pk_bf16_f32 v114, v120, v121
  v_exp_f32 v116, v116
  v_exp_f32 v117, v117
  v_mfma_f32_32x32x16_bf16 v[80:95], v[204:207], v[96:99], v[80:95]
  ds_read_b128 v[204:207], v15 offset:12288
  v_add_f32 v22, v22, v122
  v_add_f32 v22, v22, v123
  v_cvt_pk_bf16_f32 v115, v122, v123
  s_waitcnt lgkmcnt(4)
  v_mfma_f32_32x32x16_bf16 v[32:47], v[208:211], v[100:103], v[32:47]
  ds_read_b128 v[208:211], v16 offset:0
  v_exp_f32 v118, v118
  v_exp_f32 v119, v119
  v_add_f32 v22, v22, v116
  v_mfma_f32_32x32x16_bf16 v[48:63], v[212:215], v[100:103], v[48:63]
  ds_read_b128 v[212:215], v16 offset:4096
  v_add_f32 v22, v22, v117
  v_cvt_pk_bf16_f32 v116, v116, v117
  v_exp_f32 v124, v124
  v_mfma_f32_32x32x16_bf16 v[64:79], v[216:219], v[100:103], v[64:79]
  ds_read_b128 v[216:219], v16 offset:8192
  v_exp_f32 v125, v125
  v_add_f32 v22, v22, v118
  v_add_f32 v22, v22, v119
  v_cvt_pk_bf16_f32 v117, v118, v119
  v_mfma_f32_32x32x16_bf16 v[80:95], v[220:223], v[100:103], v[80:95]
  ds_read_b128 v[220:223], v16 offset:12288
  v_exp_f32 v126, v126
  v_exp_f32 v127, v127
  s_waitcnt lgkmcnt(4)
  v_mfma_f32_32x32x16_bf16 v[32:47], v[192:195], v[112:115], v[32:47]
  v_add_f32 v22, v22, v124
  v_add_f32 v22, v22, v125
  v_cvt_pk_bf16_f32 v118, v124, v125
  s_nop 0
  v_add_f32 v22, v22, v126
  v_mfma_f32_32x32x16_bf16 v[48:63], v[196:199], v[112:115], v[48:63]
  v_add_f32 v22, v22, v127
  v_cvt_pk_bf16_f32 v119, v126, v127
  v_max3_f32 v25, v128, v129, v130
  v_max3_f32 v25, v25, v131, v132
  v_mfma_f32_32x32x16_bf16 v[64:79], v[200:203], v[112:115], v[64:79]
  s_waitcnt vmcnt(8) lgkmcnt(0)
  s_barrier
  ds_read_b128 v[192:195], v5 offset:32768
  ds_read_b128 v[196:199], v6 offset:32768
  ds_read_b128 v[200:203], v7 offset:32768
  v_max3_f32 v25, v25, v133, v134
  v_max3_f32 v25, v25, v135, v136
  v_max3_f32 v25, v25, v137, v138
  v_max3_f32 v25, v25, v139, v140
  v_mfma_f32_32x32x16_bf16 v[80:95], v[204:207], v[112:115], v[80:95]
  ds_read_b128 v[204:207], v8 offset:32768
  v_max3_f32 v25, v25, v141, v142
  v_max3_f32 v26, v144, v145, v146
  v_max3_f32 v26, v26, v147, v148
  v_max3_f32 v26, v26, v149, v150
  v_max3_f32 v26, v26, v151, v152
  v_mfma_f32_32x32x16_bf16 v[32:47], v[208:211], v[116:119], v[32:47]
  ds_read_b128 v[208:211], v9 offset:32768
  v_max3_f32 v26, v26, v153, v154
  v_max3_f32 v26, v26, v155, v156
  v_max3_f32 v26, v26, v157, v158
  v_max3_f32 v25, v25, v143, v159
  v_mfma_f32_32x32x16_bf16 v[48:63], v[212:215], v[116:119], v[48:63]
  ds_read_b128 v[212:215], v10 offset:32768
  v_max_f32 v25, v25, v26
  v_cmp_lt_f32 vcc, s31, v25
  v_mfma_f32_32x32x16_bf16 v[64:79], v[216:219], v[116:119], v[64:79]
  ds_read_b128 v[216:219], v11 offset:32768
  v_mfma_f32_32x32x16_bf16 v[80:95], v[220:223], v[116:119], v[80:95]
  ds_read_b128 v[220:223], v12 offset:32768
  s_cbranch_vccz 2f
  s_nop 7
  s_nop 3
  v_mov_b32 v26, v25
  s_nop 1
  v_permlane32_swap_b32 v25, v26
  s_nop 1
  v_max_f32 v25, v25, v26
  v_max_f32 v25, 0, v25
  v_sub_f32 v28, 0, v25
  v_exp_f32 v28, v28
  v_sub_f32 v128, v128, v25
  v_sub_f32 v129, v129, v25
  v_sub_f32 v130, v130, v25
  v_sub_f32 v131, v131, v25
  v_sub_f32 v132, v132, v25
  v_sub_f32 v133, v133, v25
  v_sub_f32 v134, v134, v25
  v_sub_f32 v135, v135, v25
  v_sub_f32 v136, v136, v25
  v_sub_f32 v137, v137, v25
  v_sub_f32 v138, v138, v25
  v_sub_f32 v139, v139, v25
  v_sub_f32 v140, v140, v25
  v_sub_f32 v141, v141, v25
  v_sub_f32 v142, v142, v25
  v_sub_f32 v143, v143, v25
  v_sub_f32 v144, v144, v25
  v_sub_f32 v145, v145, v25
  v_sub_f32 v146, v146, v25
  v_sub_f32 v147, v147, v25
  v_sub_f32 v148, v148, v25
  v_sub_f32 v149, v149, v25
  v_sub_f32 v150, v150, v25
  v_sub_f32 v151, v151, v25
  v_sub_f32 v152, v152, v25
  v_sub_f32 v153, v153, v25
  v_sub_f32 v154, v154, v25
  v_sub_f32 v155, v155, v25
  v_sub_f32 v156, v156, v25
  v_sub_f32 v157, v157, v25
  v_sub_f32 v158, v158, v25
  v_sub_f32 v159, v159, v25
  v_sub_f32 v232, v232, v25
  v_sub_f32 v233, v233, v25
  v_sub_f32 v234, v234, v25
  v_sub_f32 v235, v235, v25
  v_sub_f32 v236, v236, v25
  v_sub_f32 v237, v237, v25
  v_sub_f32 v238, v238, v25
  v_sub_f32 v239, v239, v25
  v_sub_f32 v240, v240, v25
  v_sub_f32 v241, v241, v25
  v_sub_f32 v242, v242, v25
  v_sub_f32 v243, v243, v25
  v_sub_f32 v244, v244, v25
  v_sub_f32 v245, v245, v25
  v_sub_f32 v246, v246, v25
  v_sub_f32 v247, v247, v25
  v_mul_f32 v32, v32, v28
  v_mul_f32 v33, v33, v28
  v_mul_f32 v34, v34, v28
  v_mul_f32 v35, v35, v28
  v_mul_f32 v36, v36, v28
  v_mul_f32 v37, v37, v28
  v_mul_f32 v38, v38, v28
  v_mul_f32 v39, v39, v28
  v_mul_f32 v40, v40, v28
  v_mul_f32 v41, v41, v28
  v_mul_f32 v42, v42, v28
  v_mul_f32 v43, v43, v28
  v_mul_f32 v44, v44, v28
  v_mul_f32 v45, v45, v28
  v_mul_f32 v46, v46, v28
  v_mul_f32 v47, v47, v28
  v_mul_f32 v48, v48, v28
  v_mul_f32 v49, v49, v28
  v_mul_f32 v50, v50, v28
  v_mul_f32 v51, v51, v28
  v_mul_f32 v52, v52, v28
  v_mul_f32 v53, v53, v28
  v_mul_f32 v54, v54, v28
  v_mul_f32 v55, v55, v28
  v_mul_f32 v56, v56, v28
  v_mul_f32 v57, v57, v28
  v_mul_f32 v58, v58, v28
  v_mul_f32 v59, v59, v28
  v_mul_f32 v60, v60, v28
  v_mul_f32 v61, v61, v28
  v_mul_f32 v62, v62, v28
  v_mul_f32 v63, v63, v28
  v_mul_f32 v64, v64, v28
  v_mul_f32 v65, v65, v28
  v_mul_f32 v66, v66, v28
  v_mul_f32 v67, v67, v28
  v_mul_f32 v68, v68, v28
  v_mul_f32 v69, v69, v28
  v_mul_f32 v70, v70, v28
  v_mul_f32 v71, v71, v28
  v_mul_f32 v72, v72, v28
  v_mul_f32 v73, v73, v28
  v_mul_f32 v74, v74, v28
  v_mul_f32 v75, v75, v28
  v_mul_f32 v76, v76, v28
  v_mul_f32 v77, v77, v28
  v_mul_f32 v78, v78, v28
  v_mul_f32 v79, v79, v28
  v_mul_f32 v80, v80, v28
  v_mul_f32 v81, v81, v28
  v_mul_f32 v82, v82, v28
  v_mul_f32 v83, v83, v28
  v_mul_f32 v84, v84, v28
  v_mul_f32 v85, v85, v28
  v_mul_f32 v86, v86, v28
  v_mul_f32 v87, v87, v28
  v_mul_f32 v88, v88, v28
  v_mul_f32 v89, v89, v28
  v_mul_f32 v90, v90, v28
  v_mul_f32 v91, v91, v28
  v_mul_f32 v92, v92, v28
  v_mul_f32 v93, v93, v28
  v_mul_f32 v94, v94, v28
  v_mul_f32 v95, v95, v28
  v_mul_f32 v22, v22, v28
  s_nop 1
2:
  s_cmp_eq_u32 s25, s23
  s_cbranch_scc1 attn_kernel_fin1
attn_kernel_body1:
  s_waitcnt lgkmcnt(6)
  v_mfma_f32_32x32x16_bf16 v[96:111], v[192:195], v[160:163], v[232:247]
  ds_read_b128 v[192:195], v5 offset:40960
  v_exp_f32 v128, v128
  v_exp_f32 v129, v129
  v_exp_f32 v130, v130
  s_add_u32 m0, s21, 0x4000
  v_mfma_f32_32x32x16_bf16 v[96:111], v[196:199], v[164:167], v[96:111]
  ds_read_b128 v[196:199], v6 offset:40960
  buffer_load_dwordx4 v17, s[4:7], s26 offen lds
  v_exp_f32 v131, v131
  v_add_f32 v22, v22, v128
  s_waitcnt lgkmcnt(6)
  v_mfma_f32_32x32x16_bf16 v[96:111], v[200:203], v[168:171], v[96:111]
  ds_read_b128 v[200:203], v7 offset:40960
  v_add_f32 v22, v22, v129
  v_cvt_pk_bf16_f32 v128, v128, v129
  v_exp_f32 v136, v136
  v_exp_f32 v137, v137
  v_mfma_f32_32x32x16_bf16 v[96:111], v[204:207], v[172:175], v[96:111]
  ds_read_b128 v[204:207], v8 offset:40960
  v_add_f32 v22, v22, v130
  v_add_f32 v22, v22, v131
  v_cvt_pk_bf16_f32 v129, v130, v131
  s_waitcnt lgkmcnt(4)
  v_mfma_f32_32x32x16_bf16 v[96:111], v[208:211], v[176:179], v[96:111]
  ds_read_b128 v[208:211], v9 offset:40960
  v_exp_f32 v138, v138
  v_exp_f32 v139, v139
  s_add_u32 m0, s21, 0x6000
  v_mfma_f32_32x32x16_bf16 v[96:111], v[212:215], v[180:183], v[96:111]
  ds_read_b128 v[212:215], v10 offset:40960
  buffer_load_dwordx4 v18, s[4:7], s26 offen lds
  v_add_f32 v22, v22, v136
  v_add_f32 v22, v22, v137
  v_cvt_pk_bf16_f32 v130, v136, v137
  v_exp_f32 v132, v132
  v_mfma_f32_32x32x16_bf16 v[96:111], v[216:219], v[184:187], v[96:111]
  ds_read_b128 v[216:219], v11 offset:40960
  v_exp_f32 v133, v133
  v_add_f32 v22, v22, v138
  v_add_f32 v22, v22, v139
  v_mfma_f32_32x32x16_bf16 v[96:111], v[220:223], v[188:191], v[96:111]
  ds_read_b128 v[220:223], v12 offset:40960
  v_cvt_pk_bf16_f32 v131, v138, v139
  v_exp_f32 v134, v134
  v_exp_f32 v135, v135
  s_waitcnt lgkmcnt(4)
  v_mfma_f32_32x32x16_bf16 v[112:127], v[192:195], v[160:163], v[232:247]
  ds_read_b128 v[192:195], v13 offset:16384
  v_add_f32 v22, v22, v132
  v_add_f32 v22, v22, v133
  v_cvt_pk_bf16_f32 v132, v132, v133
  v_exp_f32 v140, v140
  s_add_u32 m0, s21, 0x10000
  v_mfma_f32_32x32x16_bf16 v[112:127], v[196:199], v[164:167], v[112:127]
  ds_read_b128 v[196:199], v13 offset:20480
  buffer_load_dwordx4 v19, s[8:11], s27 offen lds
  v_exp_f32 v141, v141
  v_add_f32 v22, v22, v134
  v_mfma_f32_32x32x16_bf16 v[112:127], v[200:203], v[168:171], v[112:127]
  ds_read_b128 v[200:203], v13 offset:24576
  v_add_f32 v22, v22, v135
  v_cvt_pk_bf16_f32 v133, v134, v135
  v_exp_f32 v142, v142
  v_exp_f32 v143, v143
  v_mfma_f32_32x32x16_bf16 v[112:127], v[204:207], v[172:175], v[112:127]
  ds_read_b128 v[204:207], v13 offset:28672
  v_add_f32 v22, v22, v140
  v_add_f32 v22, v22, v141
  v_cvt_pk_bf16_f32 v134, v140, v141
  s_waitcnt lgkmcnt(4)
  v_mfma_f32_32x32x16_bf16 v[112:127], v[208:211], v[176:179], v[112:127]
  ds_read_b128 v[208:211], v14 offset:16384
  v_exp_f32 v144, v144
  v_exp_f32 v145, v145
  v_add_f32 v22, v22, v142
  s_add_u32 m0, s21, 0x12000
  v_mfma_f32_32x32x16_bf16 v[112:127], v[212:215], v[180:183], v[112:127]
  ds_read_b128 v[212:215], v14 offset:20480
  buffer_load_dwordx4 v20, s[8:11], s27 offen lds
  s_add_u32 s26, s26, 0x80000
  s_add_u32 s27, s27, 128
  v_add_f32 v22, v22, v143
  v_cvt_pk_bf16_f32 v135, v142, v143
  v_exp_f32 v146, v146
  v_mfma_f32_32x32x16_bf16 v[112:127], v[216:219], v[184:187], v[112:127]
  ds_read_b128 v[216:219], v14 offset:24576
  v_exp_f32 v147, v147
  v_add_f32 v22, v22, v144
  v_add_f32 v22, v22, v145
  v_mfma_f32_32x32x16_bf16 v[112:127], v[220:223], v[188:191], v[112:127]
  ds_read_b128 v[220:223], v14 offset:28672
  v_cvt_pk_bf16_f32 v144, v144, v145
  v_exp_f32 v152, v152
  v_exp_f32 v153, v153
  s_waitcnt lgkmcnt(4)
  v_mfma_f32_32x32x16_bf16 v[32:47], v[192:195], v[128:131], v[32:47]
  ds_read_b128 v[192:195], v15 offset:16384
  v_add_f32 v22, v22, v146
  v_add_f32 v22, v22, v147
  v_cvt_pk_bf16_f32 v145, v146, v147
  v_exp_f32 v154, v154
  v_mfma_f32_32x32x16_bf16 v[48:63], v[196:199], v[128:131], v[48:63]
  ds_read_b128 v[196:199], v15 offset:20480
  s_add_u32 s25, s25, 1
  s_cmp_eq_u32 s25, s23
  s_cbranch_scc0 6f
  s_nop 7
  s_nop 3
  v_cmp_gt_i32 s[34:35], 0, v23
  v_cmp_gt_i32 s[36:37], 1, v23
  v_cmp_gt_i32 s[38:39], 2, v23
  v_cndmask_b32 v96, v96, v24, s[34:35]
  v_cmp_gt_i32 s[34:35], 3, v23
  v_cndmask_b32 v97, v97, v24, s[36:37]
  v_cmp_gt_i32 s[36:37], 8, v23
  v_cndmask_b32 v98, v98, v24, s[38:39]
  v_cmp_gt_i32 s[38:39], 9, v23
  v_cndmask_b32 v99, v99, v24, s[34:35]
  v_cmp_gt_i32 s[34:35], 10, v23
  v_cndmask_b32 v100, v100, v24, s[36:37]
  v_cmp_gt_i32 s[36:37], 11, v23
  v_cndmask_b32 v101, v101, v24, s[38:39]
  v_cmp_gt_i32 s[38:39], 16, v23
  v_cndmask_b32 v102, v102, v24, s[34:35]
  v_cmp_gt_i32 s[34:35], 17, v23
  v_cndmask_b32 v103, v103, v24, s[36:37]
  v_cmp_gt_i32 s[36:37], 18, v23
  v_cndmask_b32 v104, v104, v24, s[38:39]
  v_cmp_gt_i32 s[38:39], 19, v23
  v_cndmask_b32 v105, v105, v24, s[34:35]
  v_cmp_gt_i32 s[34:35], 24, v23
  v_cndmask_b32 v106, v106, v24, s[36:37]
  v_cmp_gt_i32 s[36:37], 25, v23
  v_cndmask_b32 v107, v107, v24, s[38:39]
  v_cmp_gt_i32 s[38:39], 26, v23
  v_cndmask_b32 v108, v108, v24, s[34:35]
  v_cmp_gt_i32 s[34:35], 27, v23
  v_cndmask_b32 v109, v109, v24, s[36:37]
  v_cmp_gt_i32 s[36:37], 32, v23
  v_cndmask_b32 v110, v110, v24, s[38:39]
  v_cmp_gt_i32 s[38:39], 33, v23
  v_cndmask_b32 v111, v111, v24, s[34:35]
  v_cmp_gt_i32 s[34:35], 34, v23
  v_cndmask_b32 v112, v112, v24, s[36:37]
  v_cmp_gt_i32 s[36:37], 35, v23
  v_cndmask_b32 v113, v113, v24, s[38:39]
  v_cmp_gt_i32 s[38:39], 40, v23
  v_cndmask_b32 v114, v114, v24, s[34:35]
  v_cmp_gt_i32 s[34:35], 41, v23
  v_cndmask_b32 v115, v115, v24, s[36:37]
  v_cmp_gt_i32 s[36:37], 42, v23
  v_cndmask_b32 v116, v116, v24, s[38:39]
  v_cmp_gt_i32 s[38:39], 43, v23
  v_cndmask_b32 v117, v117, v24, s[34:35]
  v_cmp_gt_i32 s[34:35], 48, v23
  v_cndmask_b32 v118, v118, v24, s[36:37]
  v_cmp_gt_i32 s[36:37], 49, v23
  v_cndmask_b32 v119, v119, v24, s[38:39]
  v_cmp_gt_i32 s[38:39], 50, v23
  v_cndmask_b32 v120, v120, v24, s[34:35]
  v_cmp_gt_i32 s[34:35], 51, v23
  v_cndmask_b32 v121, v121, v24, s[36:37]
  v_cmp_gt_i32 s[36:37], 56, v23
  v_cndmask_b32 v122, v122, v24, s[38:39]
  v_cmp_gt_i32 s[38:39], 57, v23
  v_cndmask_b32 v123, v123, v24, s[34:35]
  v_cmp_gt_i32 s[34:35], 58, v23
  v_cndmask_b32 v124, v124, v24, s[36:37]
  v_cmp_gt_i32 s[36:37], 59, v23
  v_cndmask_b32 v125, v125, v24, s[38:39]
  s_nop 0
  v_cndmask_b32 v126, v126, v24, s[34:35]
  s_nop 0
  v_cndmask_b32 v127, v127, v24, s[36:37]
6:
  v_exp_f32 v155, v155
  v_add_f32 v22, v22, v152
  v_add_f32 v22, v22, v153
  v_mfma_f32_32x32x16_bf16 v[64:79], v[200:203], v[128:131], v[64:79]
  ds_read_b128 v[200:203], v15 offset:24576
  v_cvt_pk_bf16_f32 v146, v152, v153
  v_exp_f32 v148, v148
  v_exp_f32 v149, v149
  v_mfma_f32_32x32x16_bf16 v[80:95], v[204:207], v[128:131], v[80:95]
  ds_read_b128 v[204:207], v15 offset:28672
  v_add_f32 v22, v22, v154
  v_add_f32 v22, v22, v155
  v_cvt_pk_bf16_f32 v147, v154, v155
  s_waitcnt lgkmcnt(4)
  v_mfma_f32_32x32x16_bf16 v[32:47], v[208:211], v[132:135], v[32:47]
  ds_read_b128 v[208:211], v16 offset:16384
  v_exp_f32 v150, v150
  v_exp_f32 v151, v151
  v_add_f32 v22, v22, v148
  v_mfma_f32_32x32x16_bf16 v[48:63], v[212:215], v[132:135], v[48:63]
  ds_read_b128 v[212:215], v16 offset:20480
  v_add_f32 v22, v22, v149
  v_cvt_pk_bf16_f32 v148, v148, v149
  v_exp_f32 v156, v156
  v_mfma_f32_32x32x16_bf16 v[64:79], v[216:219], v[132:135], v[64:79]
  ds_read_b128 v[216:219], v16 offset:24576
  v_exp_f32 v157, v157
  v_add_f32 v22, v22, v150
  v_add_f32 v22, v22, v151
  v_cvt_pk_bf16_f32 v149, v150, v151
  v_mfma_f32_32x32x16_bf16 v[80:95], v[220:223], v[132:135], v[80:95]
  ds_read_b128 v[220:223], v16 offset:28672
  v_exp_f32 v158, v158
  v_exp_f32 v159, v159
  s_waitcnt lgkmcnt(4)
  v_mfma_f32_32x32x16_bf16 v[32:47], v[192:195], v[144:147], v[32:47]
  v_add_f32 v22, v22, v156
  v_add_f32 v22, v22, v157
  v_cvt_pk_bf16_f32 v150, v156, v157
  s_nop 0
  v_add_f32 v22, v22, v158
  v_mfma_f32_32x32x16_bf16 v[48:63], v[196:199], v[144:147], v[48:63]
  v_add_f32 v22, v22, v159
  v_cvt_pk_bf16_f32 v151, v158, v159
  v_max3_f32 v25, v96, v97, v98
  v_max3_f32 v25, v25, v99, v100
  v_mfma_f32_32x32x16_bf16 v[64:79], v[200:203], v[144:147], v[64:79]
  s_waitcnt vmcnt(8) lgkmcnt(0)
  s_barrier
  ds_read_b128 v[192:195], v5 offset:49152
  ds_read_b128 v[196:199], v6 offset:49152
  ds_read_b128 v[200:203], v7 offset:49152
  v_max3_f32 v25, v25, v101, v102
  v_max3_f32 v25, v25, v103, v104
  v_max3_f32 v25, v25, v105, v106
  v_max3_f32 v25, v25, v107, v108
  v_mfma_f32_32x32x16_bf16 v[80:95], v[204:207], v[144:147], v[80:95]
  ds_read_b128 v[204:207], v8 offset:49152
  v_max3_f32 v25, v25, v109, v110
  v_max3_f32 v26, v112, v113, v114
  v_max3_f32 v26, v26, v115, v116
  v_max3_f32 v26, v26, v117, v118
  v_max3_f32 v26, v26, v119, v120
  v_mfma_f32_32x32x16_bf16 v[32:47], v[208:211], v[148:151], v[32:47]
  ds_read_b128 v[208:211], v9 offset:49152
  v_max3_f32 v26, v26, v121, v122
  v_max3_f32 v26, v26, v123, v124
  v_max3_f32 v26, v26, v125, v126
  v_max3_f32 v25, v25, v111, v127
  v_mfma_f32_32x32x16_bf16 v[48:63], v[212:215], v[148:151], v[48:63]
  ds_read_b128 v[212:215], v10 offset:49152
  v_max_f32 v25, v25, v26
  v_cmp_lt_f32 vcc, s31, v25
  v_mfma_f32_32x32x16_bf16 v[64:79], v[216:219], v[148:151], v[64:79]
  ds_read_b128 v[216:219], v11 offset:49152
  v_mfma_f32_32x32x16_bf16 v[80:95], v[220:223], v[148:151], v[80:95]
  ds_read_b128 v[220:223], v12 offset:49152
  s_cbranch_vccz 2f
  s_nop 7
  s_nop 3
  v_mov_b32 v26, v25
  s_nop 1
  v_permlane32_swap_b32 v25, v26
  s_nop 1
  v_max_f32 v25, v25, v26
  v_max_f32 v25, 0, v25
  v_sub_f32 v28, 0, v25
  v_exp_f32 v28, v28
  v_sub_f32 v96, v96, v25
  v_sub_f32 v97, v97, v25
  v_sub_f32 v98, v98, v25
  v_sub_f32 v99, v99, v25
  v_sub_f32 v100, v100, v25
  v_sub_f32 v101, v101, v25
  v_sub_f32 v102, v102, v25
  v_sub_f32 v103, v103, v25
  v_sub_f32 v104, v104, v25
  v_sub_f32 v105, v105, v25
  v_sub_f32 v106, v106, v25
  v_sub_f32 v107, v107, v25
  v_sub_f32 v108, v108, v25
  v_sub_f32 v109, v109, v25
  v_sub_f32 v110, v110, v25
  v_sub_f32 v111, v111, v25
  v_sub_f32 v112, v112, v25
  v_sub_f32 v113, v113, v25
  v_sub_f32 v114, v114, v25
  v_sub_f32 v115, v115, v25
  v_sub_f32 v116, v116, v25
  v_sub_f32 v117, v117, v25
  v_sub_f32 v118, v118, v25
  v_sub_f32 v119, v119, v25
  v_sub_f32 v120, v120, v25
  v_sub_f32 v121, v121, v25
  v_sub_f32 v122, v122, v25
  v_sub_f32 v123, v123, v25
  v_sub_f32 v124, v124, v25
  v_sub_f32 v125, v125, v25
  v_sub_f32 v126, v126, v25
  v_sub_f32 v127, v127, v25
  v_sub_f32 v232, v232, v25
  v_sub_f32 v233, v233, v25
  v_sub_f32 v234, v234, v25
  v_sub_f32 v235, v235, v25
  v_sub_f32 v236, v236, v25
  v_sub_f32 v237, v237, v25
  v_sub_f32 v238, v238, v25
  v_sub_f32 v239, v239, v25
  v_sub_f32 v240, v240, v25
  v_sub_f32 v241, v241, v25
  v_sub_f32 v242, v242, v25
  v_sub_f32 v243, v243, v25
  v_sub_f32 v244, v244, v25
  v_sub_f32 v245, v245, v25
  v_sub_f32 v246, v246, v25
  v_sub_f32 v247, v247, v25
  v_mul_f32 v32, v32, v28
  v_mul_f32 v33, v33, v28
  v_mul_f32 v34, v34, v28
  v_mul_f32 v35, v35, v28
  v_mul_f32 v36, v36, v28
  v_mul_f32 v37, v37, v28
  v_mul_f32 v38, v38, v28
  v_mul_f32 v39, v39, v28
  v_mul_f32 v40, v40, v28
  v_mul_f32 v41, v41, v28
  v_mul_f32 v42, v42, v28
  v_mul_f32 v43, v43, v28
  v_mul_f32 v44, v44, v28
  v_mul_f32 v45, v45, v28
  v_mul_f32 v46, v46, v28
  v_mul_f32 v47, v47, v28
  v_mul_f32 v48, v48, v28
  v_mul_f32 v49, v49, v28
  v_mul_f32 v50, v50, v28
  v_mul_f32 v51, v51, v28
  v_mul_f32 v52, v52, v28
  v_mul_f32 v53, v53, v28
  v_mul_f32 v54, v54, v28
  v_mul_f32 v55, v55, v28
  v_mul_f32 v56, v56, v28
  v_mul_f32 v57, v57, v28
  v_mul_f32 v58, v58, v28
  v_mul_f32 v59, v59, v28
  v_mul_f32 v60, v60, v28
  v_mul_f32 v61, v61, v28
  v_mul_f32 v62, v62, v28
  v_mul_f32 v63, v63, v28
  v_mul_f32 v64, v64, v28
  v_mul_f32 v65, v65, v28
  v_mul_f32 v66, v66, v28
  v_mul_f32 v67, v67, v28
  v_mul_f32 v68, v68, v28
  v_mul_f32 v69, v69, v28
  v_mul_f32 v70, v70, v28
  v_mul_f32 v71, v71, v28
  v_mul_f32 v72, v72, v28
  v_mul_f32 v73, v73, v28
  v_mul_f32 v74, v74, v28
  v_mul_f32 v75, v75, v28
  v_mul_f32 v76, v76, v28
  v_mul_f32 v77, v77, v28
  v_mul_f32 v78, v78, v28
  v_mul_f32 v79, v79, v28
  v_mul_f32 v80, v80, v28
  v_mul_f32 v81, v81, v28
  v_mul_f32 v82, v82, v28
  v_mul_f32 v83, v83, v28
  v_mul_f32 v84, v84, v28
  v_mul_f32 v85, v85, v28
  v_mul_f32 v86, v86, v28
  v_mul_f32 v87, v87, v28
  v_mul_f32 v88, v88, v28
  v_mul_f32 v89, v89, v28
  v_mul_f32 v90, v90, v28
  v_mul_f32 v91, v91, v28
  v_mul_f32 v92, v92, v28
  v_mul_f32 v93, v93, v28
  v_mul_f32 v94, v94, v28
  v_mul_f32 v95, v95, v28
  v_mul_f32 v22, v22, v28
  s_nop 1
2:
  s_cmp_eq_u32 s25, s23
  s_cbranch_scc1 attn_kernel_fin2
attn_kernel_body2:
  s_waitcnt lgkmcnt(6)
  v_mfma_f32_32x32x16_bf16 v[128:143], v[192:195], v[160:163], v[232:247]
  ds_read_b128 v[192:195], v5 offset:57344
  v_exp_f32 v96, v96
  v_exp_f32 v97, v97
  v_exp_f32 v98, v98
  s_add_u32 m0, s21, 0x8000
  v_mfma_f32_32x32x16_bf16 v[128:143], v[196:199], v[164:167], v[128:143]
  ds_read_b128 v[196:199], v6 offset:57344
  buffer_load_dwordx4 v17, s[4:7], s26 offen lds
  v_exp_f32 v99, v99
  v_add_f32 v22, v22, v96
  s_waitcnt lgkmcnt(6)
  v_mfma_f32_32x32x16_bf16 v[128:143], v[200:203], v[168:171], v[128:143]
  ds_read_b128 v[200:203], v7 offset:57344
  v_add_f32 v22, v22, v97
  v_cvt_pk_bf16_f32 v96, v96, v97
  v_exp_f32 v104, v104
  v_exp_f32 v105, v105
  v_mfma_f32_32x32x16_bf16 v[128:143], v[204:207], v[172:175], v[128:143]
  ds_read_b128 v[204:207], v8 offset:57344
  v_add_f32 v22, v22, v98
  v_add_f32 v22, v22, v99
  v_cvt_pk_bf16_f32 v97, v98, v99
  s_waitcnt lgkmcnt(4)
  v_mfma_f32_32x32x16_bf16 v[128:143], v[208:211], v[176:179], v[128:143]
  ds_read_b128 v[208:211], v9 offset:57344
  v_exp_f32 v106, v106
  v_exp_f32 v107, v107
  s_add_u32 m0, s21, 0xa000
  v_mfma_f32_32x32x16_bf16 v[128:143], v[212:215], v[180:183], v[128:143]
  ds_read_b128 v[212:215], v10 offset:57344
  buffer_load_dwordx4 v18, s[4:7], s26 offen lds
  v_add_f32 v22, v22, v104
  v_add_f32 v22, v22, v105
  v_cvt_pk_bf16_f32 v98, v104, v105
  v_exp_f32 v100, v100
  v_mfma_f32_32x32x16_bf16 v[128:143], v[216:219], v[184:187], v[128:143]
  ds_read_b128 v[216:219], v11 offset:57344
  v_exp_f32 v101, v101
  v_add_f32 v22, v22, v106
  v_add_f32 v22, v22, v107
  v_mfma_f32_32x32x16_bf16 v[128:143], v[220:223], v[188:191], v[128:143]
  ds_read_b128 v[220:223], v12 offset:57344
  v_cvt_pk_bf16_f32 v99, v106, v107
  v_exp_f32 v102, v102
  v_exp_f32 v103, v103
  s_waitcnt lgkmcnt(4)
  v_mfma_f32_32x32x16_bf16 v[144:159], v[192:195], v[160:163], v[232:247]
  ds_read_b128 v[192:195], v13 offset:32768
  v_add_f32 v22, v22, v100
  v_add_f32 v22, v22, v101
  v_cvt_pk_bf16_f32 v100, v100, v101
  v_exp_f32 v108, v108
  s_add_u32 m0, s21, 0x14000
  v_mfma_f32_32x32x16_bf16 v[144:159], v[196:199], v[164:167], v[144:159]
  ds_read_b128 v[196:199], v13 offset:36864
  buffer_load_dwordx4 v19, s[8:11], s27 offen lds
  v_exp_f32 v109, v109
  v_add_f32 v22, v22, v102
  v_mfma_f32_32x32x16_bf16 v[144:159], v[200:203], v[168:171], v[144:159]
  ds_read_b128 v[200:203], v13 offset:40960
  v_add_f32 v22, v22, v103
  v_cvt_pk_bf16_f32 v101, v102, v103
  v_exp_f32 v110, v110
  v_exp_f32 v111, v111
  v_mfma_f32_32x32x16_bf16 v[144:159], v[204:207], v[172:175], v[144:159]
  ds_read_b128 v[204:207], v13 offset:45056
  v_add_f32 v22, v22, v108
  v_add_f32 v22, v22, v109
  v_cvt_pk_bf16_f32 v102, v108, v109
  s_waitcnt lgkmcnt(4)
  v_mfma_f32_32x32x16_bf16 v[144:159], v[208:211], v[176:179], v[144:159]
  ds_read_b128 v[208:211], v14 offset:32768
  v_exp_f32 v112, v112
  v_exp_f32 v113, v113
  v_add_f32 v22, v22, v110
  s_add_u32 m0, s21, 0x16000
  v_mfma_f32_32x32x16_bf16 v[144:159], v[212:215], v[180:183], v[144:159]
  ds_read_b128 v[212:215], v14 offset:36864
  buffer_load_dwordx4 v20, s[8:11], s27 offen lds
  s_add_u32 s26, s26, 0x80000
  s_add_u32 s27, s27, 128
  v_add_f32 v22, v22, v111
  v_cvt_pk_bf16_f32 v103, v110, v111
  v_exp_f32 v114, v114
  v_mfma_f32_32x32x16_bf16 v[144:159], v[216:219], v[184:187], v[144:159]
  ds_read_b128 v[216:219], v14 offset:40960
  v_exp_f32 v115, v115
  v_add_f32 v22, v22, v112
  v_add_f32 v22, v22, v113
  v_mfma_f32_32x32x16_bf16 v[144:159], v[220:223], v[188:191], v[144:159]
  ds_read_b128 v[220:223], v14 offset:45056
  v_cvt_pk_bf16_f32 v112, v112, v113
  v_exp_f32 v120, v120
  v_exp_f32 v121, v121
  s_waitcnt lgkmcnt(4)
  v_mfma_f32_32x32x16_bf16 v[32:47], v[192:195], v[96:99], v[32:47]
  ds_read_b128 v[192:195], v15 offset:32768
  v_add_f32 v22, v22, v114
  v_add_f32 v22, v22, v115
  v_cvt_pk_bf16_f32 v113, v114, v115
  v_exp_f32 v122, v122
  v_mfma_f32_32x32x16_bf16 v[48:63], v[196:199], v[96:99], v[48:63]
  ds_read_b128 v[196:199], v15 offset:36864
  s_add_u32 s25, s25, 1
  s_cmp_eq_u32 s25, s23
  s_cbranch_scc0 6f
  s_nop 7
  s_nop 3
  v_cmp_gt_i32 s[34:35], 0, v23
  v_cmp_gt_i32 s[36:37], 1, v23
  v_cmp_gt_i32 s[38:39], 2, v23
  v_cndmask_b32 v128, v128, v24, s[34:35]
  v_cmp_gt_i32 s[34:35], 3, v23
  v_cndmask_b32 v129, v129, v24, s[36:37]
  v_cmp_gt_i32 s[36:37], 8, v23
  v_cndmask_b32 v130, v130, v24, s[38:39]
  v_cmp_gt_i32 s[38:39], 9, v23
  v_cndmask_b32 v131, v131, v24, s[34:35]
  v_cmp_gt_i32 s[34:35], 10, v23
  v_cndmask_b32 v132, v132, v24, s[36:37]
  v_cmp_gt_i32 s[36:37], 11, v23
  v_cndmask_b32 v133, v133, v24, s[38:39]
  v_cmp_gt_i32 s[38:39], 16, v23
  v_cndmask_b32 v134, v134, v24, s[34:35]
  v_cmp_gt_i32 s[34:35], 17, v23
  v_cndmask_b32 v135, v135, v24, s[36:37]
  v_cmp_gt_i32 s[36:37], 18, v23
  v_cndmask_b32 v136, v136, v24, s[38:39]
  v_cmp_gt_i32 s[38:39], 19, v23
  v_cndmask_b32 v137, v137, v24, s[34:35]
  v_cmp_gt_i32 s[34:35], 24, v23
  v_cndmask_b32 v138, v138, v24, s[36:37]
  v_cmp_gt_i32 s[36:37], 25, v23
  v_cndmask_b32 v139, v139, v24, s[38:39]
  v_cmp_gt_i32 s[38:39], 26, v23
  v_cndmask_b32 v140, v140, v24, s[34:35]
  v_cmp_gt_i32 s[34:35], 27, v23
  v_cndmask_b32 v141, v141, v24, s[36:37]
  v_cmp_gt_i32 s[36:37], 32, v23
  v_cndmask_b32 v142, v142, v24, s[38:39]
  v_cmp_gt_i32 s[38:39], 33, v23
  v_cndmask_b32 v143, v143, v24, s[34:35]
  v_cmp_gt_i32 s[34:35], 34, v23
  v_cndmask_b32 v144, v144, v24, s[36:37]
  v_cmp_gt_i32 s[36:37], 35, v23
  v_cndmask_b32 v145, v145, v24, s[38:39]
  v_cmp_gt_i32 s[38:39], 40, v23
  v_cndmask_b32 v146, v146, v24, s[34:35]
  v_cmp_gt_i32 s[34:35], 41, v23
  v_cndmask_b32 v147, v147, v24, s[36:37]
  v_cmp_gt_i32 s[36:37], 42, v23
  v_cndmask_b32 v148, v148, v24, s[38:39]
  v_cmp_gt_i32 s[38:39], 43, v23
  v_cndmask_b32 v149, v149, v24, s[34:35]
  v_cmp_gt_i32 s[34:35], 48, v23
  v_cndmask_b32 v150, v150, v24, s[36:37]
  v_cmp_gt_i32 s[36:37], 49, v23
  v_cndmask_b32 v151, v151, v24, s[38:39]
  v_cmp_gt_i32 s[38:39], 50, v23
  v_cndmask_b32 v152, v152, v24, s[34:35]
  v_cmp_gt_i32 s[34:35], 51, v23
  v_cndmask_b32 v153, v153, v24, s[36:37]
  v_cmp_gt_i32 s[36:37], 56, v23
  v_cndmask_b32 v154, v154, v24, s[38:39]
  v_cmp_gt_i32 s[38:39], 57, v23
  v_cndmask_b32 v155, v155, v24, s[34:35]
  v_cmp_gt_i32 s[34:35], 58, v23
  v_cndmask_b32 v156, v156, v24, s[36:37]
  v_cmp_gt_i32 s[36:37], 59, v23
  v_cndmask_b32 v157, v157, v24, s[38:39]
  s_nop 0
  v_cndmask_b32 v158, v158, v24, s[34:35]
  s_nop 0
  v_cndmask_b32 v159, v159, v24, s[36:37]
6:
  v_exp_f32 v123, v123
  v_add_f32 v22, v22, v120
  v_add_f32 v22, v22, v121
  v_mfma_f32_32x32x16_bf16 v[64:79], v[200:203], v[96:99], v[64:79]
  ds_read_b128 v[200:203], v15 offset:40960
  v_cvt_pk_bf16_f32 v114, v120, v121
  v_exp_f32 v116, v116
  v_exp_f32 v117, v117
  v_mfma_f32_32x32x16_bf16 v[80:95], v[204:207], v[96:99], v[80:95]
  ds_read_b128 v[204:207], v15 offset:45056
  v_add_f32 v22, v22, v122
  v_add_f32 v22, v22, v123
  v_cvt_pk_bf16_f32 v115, v122, v123
  s_waitcnt lgkmcnt(4)
  v_mfma_f32_32x32x16_bf16 v[32:47], v[208:211], v[100:103], v[32:47]
  ds_read_b128 v[208:211], v16 offset:32768
  v_exp_f32 v118, v118
  v_exp_f32 v119, v119
  v_add_f32 v22, v22, v116
  v_mfma_f32_32x32x16_bf16 v[48:63], v[212:215], v[100:103], v[48:63]
  ds_read_b128 v[212:215], v16 offset:36864
  v_add_f32 v22, v22, v117
  v_cvt_pk_bf16_f32 v116, v116, v117
  v_exp_f32 v124, v124
  v_mfma_f32_32x32x16_bf16 v[64:79], v[216:219], v[100:103], v[64:79]
  ds_read_b128 v[216:219], v16 offset:40960
  v_exp_f32 v125, v125
  v_add_f32 v22, v22, v118
  v_add_f32 v22, v22, v119
  v_cvt_pk_bf16_f32 v117, v118, v119
  v_mfma_f32_32x32x16_bf16 v[80:95], v[220:223], v[100:103], v[80:95]
  ds_read_b128 v[220:223], v16 offset:45056
  v_exp_f32 v126, v126
  v_exp_f32 v127, v127
  s_waitcnt lgkmcnt(4)
  v_mfma_f32_32x32x16_bf16 v[32:47], v[192:195], v[112:115], v[32:47]
  v_add_f32 v22, v22, v124
  v_add_f32 v22, v22, v125
  v_cvt_pk_bf16_f32 v118, v124, v125
  s_nop 0
  v_add_f32 v22, v22, v126
  v_mfma_f32_32x32x16_bf16 v[48:63], v[196:199], v[112:115], v[48:63]
  v_add_f32 v22, v22, v127
  v_cvt_pk_bf16_f32 v119, v126, v127
  v_max3_f32 v25, v128, v129, v130
  v_max3_f32 v25, v25, v131, v132
  v_mfma_f32_32x32x16_bf16 v[64:79], v[200:203], v[112:115], v[64:79]
  s_waitcnt vmcnt(8) lgkmcnt(0)
  s_barrier
  ds_read_b128 v[192:195], v5 offset:0
  ds_read_b128 v[196:199], v6 offset:0
  ds_read_b128 v[200:203], v7 offset:0
  v_max3_f32 v25, v25, v133, v134
  v_max3_f32 v25, v25, v135, v136
  v_max3_f32 v25, v25, v137, v138
  v_max3_f32 v25, v25, v139, v140
  v_mfma_f32_32x32x16_bf16 v[80:95], v[204:207], v[112:115], v[80:95]
  ds_read_b128 v[204:207], v8 offset:0
  v_max3_f32 v25, v25, v141, v142
  v_max3_f32 v26, v144, v145, v146
  v_max3_f32 v26, v26, v147, v148
  v_max3_f32 v26, v26, v149, v150
  v_max3_f32 v26, v26, v151, v152
  v_mfma_f32_32x32x16_bf16 v[32:47], v[208:211], v[116:119], v[32:47]
  ds_read_b128 v[208:211], v9 offset:0
  v_max3_f32 v26, v26, v153, v154
  v_max3_f32 v26, v26, v155, v156
  v_max3_f32 v26, v26, v157, v158
  v_max3_f32 v25, v25, v143, v159
  v_mfma_f32_32x32x16_bf16 v[48:63], v[212:215], v[116:119], v[48:63]
  ds_read_b128 v[212:215], v10 offset:0
  v_max_f32 v25, v25, v26
  v_cmp_lt_f32 vcc, s31, v25
  v_mfma_f32_32x32x16_bf16 v[64:79], v[216:219], v[116:119], v[64:79]
  ds_read_b128 v[216:219], v11 offset:0
  v_mfma_f32_32x32x16_bf16 v[80:95], v[220:223], v[116:119], v[80:95]
  ds_read_b128 v[220:223], v12 offset:0
  s_cbranch_vccz 2f
  s_nop 7
  s_nop 3
  v_mov_b32 v26, v25
  s_nop 1
  v_permlane32_swap_b32 v25, v26
  s_nop 1
  v_max_f32 v25, v25, v26
  v_max_f32 v25, 0, v25
  v_sub_f32 v28, 0, v25
  v_exp_f32 v28, v28
  v_sub_f32 v128, v128, v25
  v_sub_f32 v129, v129, v25
  v_sub_f32 v130, v130, v25
  v_sub_f32 v131, v131, v25
  v_sub_f32 v132, v132, v25
  v_sub_f32 v133, v133, v25
  v_sub_f32 v134, v134, v25
  v_sub_f32 v135, v135, v25
  v_sub_f32 v136, v136, v25
  v_sub_f32 v137, v137, v25
  v_sub_f32 v138, v138, v25
  v_sub_f32 v139, v139, v25
  v_sub_f32 v140, v140, v25
  v_sub_f32 v141, v141, v25
  v_sub_f32 v142, v142, v25
  v_sub_f32 v143, v143, v25
  v_sub_f32 v144, v144, v25
  v_sub_f32 v145, v145, v25
  v_sub_f32 v146, v146, v25
  v_sub_f32 v147, v147, v25
  v_sub_f32 v148, v148, v25
  v_sub_f32 v149, v149, v25
  v_sub_f32 v150, v150, v25
  v_sub_f32 v151, v151, v25
  v_sub_f32 v152, v152, v25
  v_sub_f32 v153, v153, v25
  v_sub_f32 v154, v154, v25
  v_sub_f32 v155, v155, v25
  v_sub_f32 v156, v156, v25
  v_sub_f32 v157, v157, v25
  v_sub_f32 v158, v158, v25
  v_sub_f32 v159, v159, v25
  v_sub_f32 v232, v232, v25
  v_sub_f32 v233, v233, v25
  v_sub_f32 v234, v234, v25
  v_sub_f32 v235, v235, v25
  v_sub_f32 v236, v236, v25
  v_sub_f32 v237, v237, v25
  v_sub_f32 v238, v238, v25
  v_sub_f32 v239, v239, v25
  v_sub_f32 v240, v240, v25
  v_sub_f32 v241, v241, v25
  v_sub_f32 v242, v242, v25
  v_sub_f32 v243, v243, v25
  v_sub_f32 v244, v244, v25
  v_sub_f32 v245, v245, v25
  v_sub_f32 v246, v246, v25
  v_sub_f32 v247, v247, v25
  v_mul_f32 v32, v32, v28
  v_mul_f32 v33, v33, v28
  v_mul_f32 v34, v34, v28
  v_mul_f32 v35, v35, v28
  v_mul_f32 v36, v36, v28
  v_mul_f32 v37, v37, v28
  v_mul_f32 v38, v38, v28
  v_mul_f32 v39, v39, v28
  v_mul_f32 v40, v40, v28
  v_mul_f32 v41, v41, v28
  v_mul_f32 v42, v42, v28
  v_mul_f32 v43, v43, v28
  v_mul_f32 v44, v44, v28
  v_mul_f32 v45, v45, v28
  v_mul_f32 v46, v46, v28
  v_mul_f32 v47, v47, v28
  v_mul_f32 v48, v48, v28
  v_mul_f32 v49, v49, v28
  v_mul_f32 v50, v50, v28
  v_mul_f32 v51, v51, v28
  v_mul_f32 v52, v52, v28
  v_mul_f32 v53, v53, v28
  v_mul_f32 v54, v54, v28
  v_mul_f32 v55, v55, v28
  v_mul_f32 v56, v56, v28
  v_mul_f32 v57, v57, v28
  v_mul_f32 v58, v58, v28
  v_mul_f32 v59, v59, v28
  v_mul_f32 v60, v60, v28
  v_mul_f32 v61, v61, v28
  v_mul_f32 v62, v62, v28
  v_mul_f32 v63, v63, v28
  v_mul_f32 v64, v64, v28
  v_mul_f32 v65, v65, v28
  v_mul_f32 v66, v66, v28
  v_mul_f32 v67, v67, v28
  v_mul_f32 v68, v68, v28
  v_mul_f32 v69, v69, v28
  v_mul_f32 v70, v70, v28
  v_mul_f32 v71, v71, v28
  v_mul_f32 v72, v72, v28
  v_mul_f32 v73, v73, v28
  v_mul_f32 v74, v74, v28
  v_mul_f32 v75, v75, v28
  v_mul_f32 v76, v76, v28
  v_mul_f32 v77, v77, v28
  v_mul_f32 v78, v78, v28
  v_mul_f32 v79, v79, v28
  v_mul_f32 v80, v80, v28
  v_mul_f32 v81, v81, v28
  v_mul_f32 v82, v82, v28
  v_mul_f32 v83, v83, v28
  v_mul_f32 v84, v84, v28
  v_mul_f32 v85, v85, v28
  v_mul_f32 v86, v86, v28
  v_mul_f32 v87, v87, v28
  v_mul_f32 v88, v88, v28
  v_mul_f32 v89, v89, v28
  v_mul_f32 v90, v90, v28
  v_mul_f32 v91, v91, v28
  v_mul_f32 v92, v92, v28
  v_mul_f32 v93, v93, v28
  v_mul_f32 v94, v94, v28
  v_mul_f32 v95, v95, v28
  v_mul_f32 v22, v22, v28
  s_nop 1
2:
  s_cmp_eq_u32 s25, s23
  s_cbranch_scc1 attn_kernel_fin3
attn_kernel_body3:
  s_waitcnt lgkmcnt(6)
  v_mfma_f32_32x32x16_bf16 v[96:111], v[192:195], v[160:163], v[232:247]
  ds_read_b128 v[192:195], v5 offset:8192
  v_exp_f32 v128, v128
  v_exp_f32 v129, v129
  v_exp_f32 v130, v130
  s_add_u32 m0, s21, 0xc000
  v_mfma_f32_32x32x16_bf16 v[96:111], v[196:199], v[164:167], v[96:111]
  ds_read_b128 v[196:199], v6 offset:8192
  buffer_load_dwordx4 v17, s[4:7], s26 offen lds
  v_exp_f32 v131, v131
  v_add_f32 v22, v22, v128
  s_waitcnt lgkmcnt(6)
  v_mfma_f32_32x32x16_bf16 v[96:111], v[200:203], v[168:171], v[96:111]
  ds_read_b128 v[200:203], v7 offset:8192
  v_add_f32 v22, v22, v129
  v_cvt_pk_bf16_f32 v128, v128, v129
  v_exp_f32 v136, v136
  v_exp_f32 v137, v137
  v_mfma_f32_32x32x16_bf16 v[96:111], v[204:207], v[172:175], v[96:111]
  ds_read_b128 v[204:207], v8 offset:8192
  v_add_f32 v22, v22, v130
  v_add_f32 v22, v22, v131
  v_cvt_pk_bf16_f32 v129, v130, v131
  s_waitcnt lgkmcnt(4)
  v_mfma_f32_32x32x16_bf16 v[96:111], v[208:211], v[176:179], v[96:111]
  ds_read_b128 v[208:211], v9 offset:8192
  v_exp_f32 v138, v138
  v_exp_f32 v139, v139
  s_add_u32 m0, s21, 0xe000
  v_mfma_f32_32x32x16_bf16 v[96:111], v[212:215], v[180:183], v[96:111]
  ds_read_b128 v[212:215], v10 offset:8192
  buffer_load_dwordx4 v18, s[4:7], s26 offen lds
  v_add_f32 v22, v22, v136
  v_add_f32 v22, v22, v137
  v_cvt_pk_bf16_f32 v130, v136, v137
  v_exp_f32 v132, v132
  v_mfma_f32_32x32x16_bf16 v[96:111], v[216:219], v[184:187], v[96:111]
  ds_read_b128 v[216:219], v11 offset:8192
  v_exp_f32 v133, v133
  v_add_f32 v22, v22, v138
  v_add_f32 v22, v22, v139
  v_mfma_f32_32x32x16_bf16 v[96:111], v[220:223], v[188:191], v[96:111]
  ds_read_b128 v[220:223], v12 offset:8192
  v_cvt_pk_bf16_f32 v131, v138, v139
  v_exp_f32 v134, v134
  v_exp_f32 v135, v135
  s_waitcnt lgkmcnt(4)
  v_mfma_f32_32x32x16_bf16 v[112:127], v[192:195], v[160:163], v[232:247]
  ds_read_b128 v[192:195], v13 offset:49152
  v_add_f32 v22, v22, v132
  v_add_f32 v22, v22, v133
  v_cvt_pk_bf16_f32 v132, v132, v133
  v_exp_f32 v140, v140
  s_add_u32 m0, s21, 0x18000
  v_mfma_f32_32x32x16_bf16 v[112:127], v[196:199], v[164:167], v[112:127]
  ds_read_b128 v[196:199], v13 offset:53248
  buffer_load_dwordx4 v19, s[8:11], s27 offen lds
  v_exp_f32 v141, v141
  v_add_f32 v22, v22, v134
  v_mfma_f32_32x32x16_bf16 v[112:127], v[200:203], v[168:171], v[112:127]
  ds_read_b128 v[200:203], v13 offset:57344
  v_add_f32 v22, v22, v135
  v_cvt_pk_bf16_f32 v133, v134, v135
  v_exp_f32 v142, v142
  v_exp_f32 v143, v143
  v_mfma_f32_32x32x16_bf16 v[112:127], v[204:207], v[172:175], v[112:127]
  ds_read_b128 v[204:207], v13 offset:61440
  v_add_f32 v22, v22, v140
  v_add_f32 v22, v22, v141
  v_cvt_pk_bf16_f32 v134, v140, v141
  s_waitcnt lgkmcnt(4)
  v_mfma_f32_32x32x16_bf16 v[112:127], v[208:211], v[176:179], v[112:127]
  ds_read_b128 v[208:211], v14 offset:49152
  v_exp_f32 v144, v144
  v_exp_f32 v145, v145
  v_add_f32 v22, v22, v142
  s_add_u32 m0, s21, 0x1a000
  v_mfma_f32_32x32x16_bf16 v[112:127], v[212:215], v[180:183], v[112:127]
  ds_read_b128 v[212:215], v14 offset:53248
  buffer_load_dwordx4 v20, s[8:11], s27 offen lds
  s_add_u32 s26, s26, 0x80000
  s_add_u32 s27, s27, 128
  v_add_f32 v22, v22, v143
  v_cvt_pk_bf16_f32 v135, v142, v143
  v_exp_f32 v146, v146
  v_mfma_f32_32x32x16_bf16 v[112:127], v[216:219], v[184:187], v[112:127]
  ds_read_b128 v[216:219], v14 offset:57344
  v_exp_f32 v147, v147
  v_add_f32 v22, v22, v144
  v_add_f32 v22, v22, v145
  v_mfma_f32_32x32x16_bf16 v[112:127], v[220:223], v[188:191], v[112:127]
  ds_read_b128 v[220:223], v14 offset:61440
  v_cvt_pk_bf16_f32 v144, v144, v145
  v_exp_f32 v152, v152
  v_exp_f32 v153, v153
  s_waitcnt lgkmcnt(4)
  v_mfma_f32_32x32x16_bf16 v[32:47], v[192:195], v[128:131], v[32:47]
  ds_read_b128 v[192:195], v15 offset:49152
  v_add_f32 v22, v22, v146
  v_add_f32 v22, v22, v147
  v_cvt_pk_bf16_f32 v145, v146, v147
  v_exp_f32 v154, v154
  v_mfma_f32_32x32x16_bf16 v[48:63], v[196:199], v[128:131], v[48:63]
  ds_read_b128 v[196:199], v15 offset:53248
  s_add_u32 s25, s25, 1
  s_cmp_eq_u32 s25, s23
  s_cbranch_scc0 6f
  s_nop 7
  s_nop 3
  v_cmp_gt_i32 s[34:35], 0, v23
  v_cmp_gt_i32 s[36:37], 1, v23
  v_cmp_gt_i32 s[38:39], 2, v23
  v_cndmask_b32 v96, v96, v24, s[34:35]
  v_cmp_gt_i32 s[34:35], 3, v23
  v_cndmask_b32 v97, v97, v24, s[36:37]
  v_cmp_gt_i32 s[36:37], 8, v23
  v_cndmask_b32 v98, v98, v24, s[38:39]
  v_cmp_gt_i32 s[38:39], 9, v23
  v_cndmask_b32 v99, v99, v24, s[34:35]
  v_cmp_gt_i32 s[34:35], 10, v23
  v_cndmask_b32 v100, v100, v24, s[36:37]
  v_cmp_gt_i32 s[36:37], 11, v23
  v_cndmask_b32 v101, v101, v24, s[38:39]
  v_cmp_gt_i32 s[38:39], 16, v23
  v_cndmask_b32 v102, v102, v24, s[34:35]
  v_cmp_gt_i32 s[34:35], 17, v23
  v_cndmask_b32 v103, v103, v24, s[36:37]
  v_cmp_gt_i32 s[36:37], 18, v23
  v_cndmask_b32 v104, v104, v24, s[38:39]
  v_cmp_gt_i32 s[38:39], 19, v23
  v_cndmask_b32 v105, v105, v24, s[34:35]
  v_cmp_gt_i32 s[34:35], 24, v23
  v_cndmask_b32 v106, v106, v24, s[36:37]
  v_cmp_gt_i32 s[36:37], 25, v23
  v_cndmask_b32 v107, v107, v24, s[38:39]
  v_cmp_gt_i32 s[38:39], 26, v23
  v_cndmask_b32 v108, v108, v24, s[34:35]
  v_cmp_gt_i32 s[34:35], 27, v23
  v_cndmask_b32 v109, v109, v24, s[36:37]
  v_cmp_gt_i32 s[36:37], 32, v23
  v_cndmask_b32 v110, v110, v24, s[38:39]
  v_cmp_gt_i32 s[38:39], 33, v23
  v_cndmask_b32 v111, v111, v24, s[34:35]
  v_cmp_gt_i32 s[34:35], 34, v23
  v_cndmask_b32 v112, v112, v24, s[36:37]
  v_cmp_gt_i32 s[36:37], 35, v23
  v_cndmask_b32 v113, v113, v24, s[38:39]
  v_cmp_gt_i32 s[38:39], 40, v23
  v_cndmask_b32 v114, v114, v24, s[34:35]
  v_cmp_gt_i32 s[34:35], 41, v23
  v_cndmask_b32 v115, v115, v24, s[36:37]
  v_cmp_gt_i32 s[36:37], 42, v23
  v_cndmask_b32 v116, v116, v24, s[38:39]
  v_cmp_gt_i32 s[38:39], 43, v23
  v_cndmask_b32 v117, v117, v24, s[34:35]
  v_cmp_gt_i32 s[34:35], 48, v23
  v_cndmask_b32 v118, v118, v24, s[36:37]
  v_cmp_gt_i32 s[36:37], 49, v23
  v_cndmask_b32 v119, v119, v24, s[38:39]
  v_cmp_gt_i32 s[38:39], 50, v23
  v_cndmask_b32 v120, v120, v24, s[34:35]
  v_cmp_gt_i32 s[34:35], 51, v23
  v_cndmask_b32 v121, v121, v24, s[36:37]
  v_cmp_gt_i32 s[36:37], 56, v23
  v_cndmask_b32 v122, v122, v24, s[38:39]
  v_cmp_gt_i32 s[38:39], 57, v23
  v_cndmask_b32 v123, v123, v24, s[34:35]
  v_cmp_gt_i32 s[34:35], 58, v23
  v_cndmask_b32 v124, v124, v24, s[36:37]
  v_cmp_gt_i32 s[36:37], 59, v23
  v_cndmask_b32 v125, v125, v24, s[38:39]
  s_nop 0
  v_cndmask_b32 v126, v126, v24, s[34:35]
  s_nop 0
  v_cndmask_b32 v127, v127, v24, s[36:37]
6:
  v_exp_f32 v155, v155
  v_add_f32 v22, v22, v152
  v_add_f32 v22, v22, v153
  v_mfma_f32_32x32x16_bf16 v[64:79], v[200:203], v[128:131], v[64:79]
  ds_read_b128 v[200:203], v15 offset:57344
  v_cvt_pk_bf16_f32 v146, v152, v153
  v_exp_f32 v148, v148
  v_exp_f32 v149, v149
  v_mfma_f32_32x32x16_bf16 v[80:95], v[204:207], v[128:131], v[80:95]
  ds_read_b128 v[204:207], v15 offset:61440
  v_add_f32 v22, v22, v154
  v_add_f32 v22, v22, v155
  v_cvt_pk_bf16_f32 v147, v154, v155
  s_waitcnt lgkmcnt(4)
  v_mfma_f32_32x32x16_bf16 v[32:47], v[208:211], v[132:135], v[32:47]
  ds_read_b128 v[208:211], v16 offset:49152
  v_exp_f32 v150, v150
  v_exp_f32 v151, v151
  v_add_f32 v22, v22, v148
  v_mfma_f32_32x32x16_bf16 v[48:63], v[212:215], v[132:135], v[48:63]
  ds_read_b128 v[212:215], v16 offset:53248
  v_add_f32 v22, v22, v149
  v_cvt_pk_bf16_f32 v148, v148, v149
  v_exp_f32 v156, v156
  v_mfma_f32_32x32x16_bf16 v[64:79], v[216:219], v[132:135], v[64:79]
  ds_read_b128 v[216:219], v16 offset:57344
  v_exp_f32 v157, v157
  v_add_f32 v22, v22, v150
  v_add_f32 v22, v22, v151
  v_cvt_pk_bf16_f32 v149, v150, v151
  v_mfma_f32_32x32x16_bf16 v[80:95], v[220:223], v[132:135], v[80:95]
  ds_read_b128 v[220:223], v16 offset:61440
  v_exp_f32 v158, v158
  v_exp_f32 v159, v159
  s_waitcnt lgkmcnt(4)
  v_mfma_f32_32x32x16_bf16 v[32:47], v[192:195], v[144:147], v[32:47]
  v_add_f32 v22, v22, v156
  v_add_f32 v22, v22, v157
  v_cvt_pk_bf16_f32 v150, v156, v157
  s_nop 0
  v_add_f32 v22, v22, v158
  v_mfma_f32_32x32x16_bf16 v[48:63], v[196:199], v[144:147], v[48:63]
  v_add_f32 v22, v22, v159
  v_cvt_pk_bf16_f32 v151, v158, v159
  v_max3_f32 v25, v96, v97, v98
  v_max3_f32 v25, v25, v99, v100
  v_mfma_f32_32x32x16_bf16 v[64:79], v[200:203], v[144:147], v[64:79]
  s_waitcnt vmcnt(8) lgkmcnt(0)
  s_barrier
  ds_read_b128 v[192:195], v5 offset:16384
  ds_read_b128 v[196:199], v6 offset:16384
  ds_read_b128 v[200:203], v7 offset:16384
  v_max3_f32 v25, v25, v101, v102
  v_max3_f32 v25, v25, v103, v104
  v_max3_f32 v25, v25, v105, v106
  v_max3_f32 v25, v25, v107, v108
  v_mfma_f32_32x32x16_bf16 v[80:95], v[204:207], v[144:147], v[80:95]
  ds_read_b128 v[204:207], v8 offset:16384
  v_max3_f32 v25, v25, v109, v110
  v_max3_f32 v26, v112, v113, v114
  v_max3_f32 v26, v26, v115, v116
  v_max3_f32 v26, v26, v117, v118
  v_max3_f32 v26, v26, v119, v120
  v_mfma_f32_32x32x16_bf16 v[32:47], v[208:211], v[148:151], v[32:47]
  ds_read_b128 v[208:211], v9 offset:16384
  v_max3_f32 v26, v26, v121, v122
  v_max3_f32 v26, v26, v123, v124
  v_max3_f32 v26, v26, v125, v126
  v_max3_f32 v25, v25, v111, v127
  v_mfma_f32_32x32x16_bf16 v[48:63], v[212:215], v[148:151], v[48:63]
  ds_read_b128 v[212:215], v10 offset:16384
  v_max_f32 v25, v25, v26
  v_cmp_lt_f32 vcc, s31, v25
  v_mfma_f32_32x32x16_bf16 v[64:79], v[216:219], v[148:151], v[64:79]
  ds_read_b128 v[216:219], v11 offset:16384
  v_mfma_f32_32x32x16_bf16 v[80:95], v[220:223], v[148:151], v[80:95]
  ds_read_b128 v[220:223], v12 offset:16384
  s_cbranch_vccz 2f
  s_nop 7
  s_nop 3
  v_mov_b32 v26, v25
  s_nop 1
  v_permlane32_swap_b32 v25, v26
  s_nop 1
  v_max_f32 v25, v25, v26
  v_max_f32 v25, 0, v25
  v_sub_f32 v28, 0, v25
  v_exp_f32 v28, v28
  v_sub_f32 v96, v96, v25
  v_sub_f32 v97, v97, v25
  v_sub_f32 v98, v98, v25
  v_sub_f32 v99, v99, v25
  v_sub_f32 v100, v100, v25
  v_sub_f32 v101, v101, v25
  v_sub_f32 v102, v102, v25
  v_sub_f32 v103, v103, v25
  v_sub_f32 v104, v104, v25
  v_sub_f32 v105, v105, v25
  v_sub_f32 v106, v106, v25
  v_sub_f32 v107, v107, v25
  v_sub_f32 v108, v108, v25
  v_sub_f32 v109, v109, v25
  v_sub_f32 v110, v110, v25
  v_sub_f32 v111, v111, v25
  v_sub_f32 v112, v112, v25
  v_sub_f32 v113, v113, v25
  v_sub_f32 v114, v114, v25
  v_sub_f32 v115, v115, v25
  v_sub_f32 v116, v116, v25
  v_sub_f32 v117, v117, v25
  v_sub_f32 v118, v118, v25
  v_sub_f32 v119, v119, v25
  v_sub_f32 v120, v120, v25
  v_sub_f32 v121, v121, v25
  v_sub_f32 v122, v122, v25
  v_sub_f32 v123, v123, v25
  v_sub_f32 v124, v124, v25
  v_sub_f32 v125, v125, v25
  v_sub_f32 v126, v126, v25
  v_sub_f32 v127, v127, v25
  v_sub_f32 v232, v232, v25
  v_sub_f32 v233, v233, v25
  v_sub_f32 v234, v234, v25
  v_sub_f32 v235, v235, v25
  v_sub_f32 v236, v236, v25
  v_sub_f32 v237, v237, v25
  v_sub_f32 v238, v238, v25
  v_sub_f32 v239, v239, v25
  v_sub_f32 v240, v240, v25
  v_sub_f32 v241, v241, v25
  v_sub_f32 v242, v242, v25
  v_sub_f32 v243, v243, v25
  v_sub_f32 v244, v244, v25
  v_sub_f32 v245, v245, v25
  v_sub_f32 v246, v246, v25
  v_sub_f32 v247, v247, v25
  v_mul_f32 v32, v32, v28
  v_mul_f32 v33, v33, v28
  v_mul_f32 v34, v34, v28
  v_mul_f32 v35, v35, v28
  v_mul_f32 v36, v36, v28
  v_mul_f32 v37, v37, v28
  v_mul_f32 v38, v38, v28
  v_mul_f32 v39, v39, v28
  v_mul_f32 v40, v40, v28
  v_mul_f32 v41, v41, v28
  v_mul_f32 v42, v42, v28
  v_mul_f32 v43, v43, v28
  v_mul_f32 v44, v44, v28
  v_mul_f32 v45, v45, v28
  v_mul_f32 v46, v46, v28
  v_mul_f32 v47, v47, v28
  v_mul_f32 v48, v48, v28
  v_mul_f32 v49, v49, v28
  v_mul_f32 v50, v50, v28
  v_mul_f32 v51, v51, v28
  v_mul_f32 v52, v52, v28
  v_mul_f32 v53, v53, v28
  v_mul_f32 v54, v54, v28
  v_mul_f32 v55, v55, v28
  v_mul_f32 v56, v56, v28
  v_mul_f32 v57, v57, v28
  v_mul_f32 v58, v58, v28
  v_mul_f32 v59, v59, v28
  v_mul_f32 v60, v60, v28
  v_mul_f32 v61, v61, v28
  v_mul_f32 v62, v62, v28
  v_mul_f32 v63, v63, v28
  v_mul_f32 v64, v64, v28
  v_mul_f32 v65, v65, v28
  v_mul_f32 v66, v66, v28
  v_mul_f32 v67, v67, v28
  v_mul_f32 v68, v68, v28
  v_mul_f32 v69, v69, v28
  v_mul_f32 v70, v70, v28
  v_mul_f32 v71, v71, v28
  v_mul_f32 v72, v72, v28
  v_mul_f32 v73, v73, v28
  v_mul_f32 v74, v74, v28
  v_mul_f32 v75, v75, v28
  v_mul_f32 v76, v76, v28
  v_mul_f32 v77, v77, v28
  v_mul_f32 v78, v78, v28
  v_mul_f32 v79, v79, v28
  v_mul_f32 v80, v80, v28
  v_mul_f32 v81, v81, v28
  v_mul_f32 v82, v82, v28
  v_mul_f32 v83, v83, v28
  v_mul_f32 v84, v84, v28
  v_mul_f32 v85, v85, v28
  v_mul_f32 v86, v86, v28
  v_mul_f32 v87, v87, v28
  v_mul_f32 v88, v88, v28
  v_mul_f32 v89, v89, v28
  v_mul_f32 v90, v90, v28
  v_mul_f32 v91, v91, v28
  v_mul_f32 v92, v92, v28
  v_mul_f32 v93, v93, v28
  v_mul_f32 v94, v94, v28
  v_mul_f32 v95, v95, v28
  v_mul_f32 v22, v22, v28
  s_nop 1
2:
  s_cmp_eq_u32 s25, s23
  s_cbranch_scc1 attn_kernel_fin0
  s_branch attn_kernel_body0
attn_kernel_fin0:
  s_waitcnt lgkmcnt(0)
  ds_read_b128 v[192:195], v13 offset:0
  ds_read_b128 v[196:199], v13 offset:4096
  ds_read_b128 v[200:203], v13 offset:8192
  ds_read_b128 v[204:207], v13 offset:12288
  ds_read_b128 v[208:211], v14 offset:0
  ds_read_b128 v[212:215], v14 offset:4096
  ds_read_b128 v[216:219], v14 offset:8192
  ds_read_b128 v[220:223], v14 offset:12288
  v_exp_f32 v96, v96
  v_exp_f32 v97, v97
  v_exp_f32 v98, v98
  v_exp_f32 v99, v99
  v_add_f32 v22, v22, v96
  v_add_f32 v22, v22, v97
  v_cvt_pk_bf16_f32 v96, v96, v97
  v_exp_f32 v104, v104
  v_exp_f32 v105, v105
  v_add_f32 v22, v22, v98
  v_add_f32 v22, v22, v99
  v_cvt_pk_bf16_f32 v97, v98, v99
  v_exp_f32 v106, v106
  v_exp_f32 v107, v107
  v_add_f32 v22, v22, v104
  v_add_f32 v22, v22, v105
  v_cvt_pk_bf16_f32 v98, v104, v105
  s_nop 0
  v_add_f32 v22, v22, v106
  v_add_f32 v22, v22, v107
  v_cvt_pk_bf16_f32 v99, v106, v107
  s_nop 1
  s_waitcnt lgkmcnt(7)
  v_mfma_f32_32x32x16_bf16 v[32:47], v[192:195], v[96:99], v[32:47]
  ds_read_b128 v[192:195], v15 offset:0
  v_exp_f32 v100, v100
  v_exp_f32 v101, v101
  v_exp_f32 v102, v102
  v_exp_f32 v103, v103
  v_add_f32 v22, v22, v100
  v_add_f32 v22, v22, v101
  v_cvt_pk_bf16_f32 v100, v100, v101
  s_waitcnt lgkmcnt(7)
  s_add_u32 m0, s21, 0x0
  v_mfma_f32_32x32x16_bf16 v[48:63], v[196:199], v[96:99], v[48:63]
  buffer_load_dwordx4 v17, s[4:7], s26 offen lds
  ds_read_b128 v[196:199], v15 offset:4096
  v_exp_f32 v108, v108
  v_exp_f32 v109, v109
  v_add_f32 v22, v22, v102
  v_add_f32 v22, v22, v103
  v_cvt_pk_bf16_f32 v101, v102, v103
  v_exp_f32 v110, v110
  v_exp_f32 v111, v111
  s_waitcnt lgkmcnt(7)
  v_mfma_f32_32x32x16_bf16 v[64:79], v[200:203], v[96:99], v[64:79]
  ds_read_b128 v[200:203], v15 offset:8192
  v_add_f32 v22, v22, v108
  v_add_f32 v22, v22, v109
  v_cvt_pk_bf16_f32 v102, v108, v109
  s_nop 0
  v_add_f32 v22, v22, v110
  v_add_f32 v22, v22, v111
  v_cvt_pk_bf16_f32 v103, v110, v111
  s_waitcnt lgkmcnt(7)
  v_mfma_f32_32x32x16_bf16 v[80:95], v[204:207], v[96:99], v[80:95]
  ds_read_b128 v[204:207], v15 offset:12288
  s_nop 1
  s_waitcnt lgkmcnt(7)
  v_mfma_f32_32x32x16_bf16 v[32:47], v[208:211], v[100:103], v[32:47]
  ds_read_b128 v[208:211], v16 offset:0
  v_exp_f32 v112, v112
  v_exp_f32 v113, v113
  v_exp_f32 v114, v114
  v_exp_f32 v115, v115
  v_add_f32 v22, v22, v112
  v_add_f32 v22, v22, v113
  v_cvt_pk_bf16_f32 v112, v112, v113
  s_waitcnt lgkmcnt(7)
  s_add_u32 m0, s21, 0x2000
  v_mfma_f32_32x32x16_bf16 v[48:63], v[212:215], v[100:103], v[48:63]
  buffer_load_dwordx4 v18, s[4:7], s26 offen lds
  ds_read_b128 v[212:215], v16 offset:4096
  v_exp_f32 v120, v120
  v_exp_f32 v121, v121
  v_add_f32 v22, v22, v114
  v_add_f32 v22, v22, v115
  v_cvt_pk_bf16_f32 v113, v114, v115
  v_exp_f32 v122, v122
  v_exp_f32 v123, v123
  s_waitcnt lgkmcnt(7)
  v_mfma_f32_32x32x16_bf16 v[64:79], v[216:219], v[100:103], v[64:79]
  ds_read_b128 v[216:219], v16 offset:8192
  v_add_f32 v22, v22, v120
  v_add_f32 v22, v22, v121
  v_cvt_pk_bf16_f32 v114, v120, v121
  s_nop 0
  v_add_f32 v22, v22, v122
  v_add_f32 v22, v22, v123
  v_cvt_pk_bf16_f32 v115, v122, v123
  s_waitcnt lgkmcnt(7)
  v_mfma_f32_32x32x16_bf16 v[80:95], v[220:223], v[100:103], v[80:95]
  ds_read_b128 v[220:223], v16 offset:12288
  s_nop 1
  s_waitcnt lgkmcnt(7)
  v_mfma_f32_32x32x16_bf16 v[32:47], v[192:195], v[112:115], v[32:47]
  v_exp_f32 v116, v116
  v_exp_f32 v117, v117
  v_exp_f32 v118, v118
  v_exp_f32 v119, v119
  v_add_f32 v22, v22, v116
  v_add_f32 v22, v22, v117
  v_cvt_pk_bf16_f32 v116, v116, v117
  s_waitcnt lgkmcnt(6)
  s_add_u32 m0, s21, 0x1c000
  v_mfma_f32_32x32x16_bf16 v[48:63], v[196:199], v[112:115], v[48:63]
  buffer_load_dwordx4 v19, s[8:11], s27 offen lds
  v_exp_f32 v124, v124
  v_exp_f32 v125, v125
  v_add_f32 v22, v22, v118
  v_add_f32 v22, v22, v119
  v_cvt_pk_bf16_f32 v117, v118, v119
  v_exp_f32 v126, v126
  v_exp_f32 v127, v127
  s_waitcnt lgkmcnt(5)
  v_mfma_f32_32x32x16_bf16 v[64:79], v[200:203], v[112:115], v[64:79]
  v_add_f32 v22, v22, v124
  v_add_f32 v22, v22, v125
  v_cvt_pk_bf16_f32 v118, v124, v125
  s_nop 0
  v_add_f32 v22, v22, v126
  v_add_f32 v22, v22, v127
  v_cvt_pk_bf16_f32 v119, v126, v127
  s_waitcnt lgkmcnt(4)
  v_mfma_f32_32x32x16_bf16 v[80:95], v[204:207], v[112:115], v[80:95]
  s_nop 1
  s_waitcnt lgkmcnt(3)
  v_mfma_f32_32x32x16_bf16 v[32:47], v[208:211], v[116:119], v[32:47]
  s_waitcnt lgkmcnt(2)
  s_add_u32 m0, s21, 0x1e000
  v_mfma_f32_32x32x16_bf16 v[48:63], v[212:215], v[116:119], v[48:63]
  buffer_load_dwordx4 v20, s[8:11], s27 offen lds
  s_add_u32 s26, s26, 0x80000
  s_add_u32 s27, s27, 128
  s_waitcnt lgkmcnt(1)
  v_mfma_f32_32x32x16_bf16 v[64:79], v[216:219], v[116:119], v[64:79]
  s_waitcnt lgkmcnt(0)
  v_mfma_f32_32x32x16_bf16 v[80:95], v[220:223], v[116:119], v[80:95]
  s_branch attn_kernel_loader
attn_kernel_fin1:
  s_waitcnt lgkmcnt(0)
  ds_read_b128 v[192:195], v13 offset:16384
  ds_read_b128 v[196:199], v13 offset:20480
  ds_read_b128 v[200:203], v13 offset:24576
  ds_read_b128 v[204:207], v13 offset:28672
  ds_read_b128 v[208:211], v14 offset:16384
  ds_read_b128 v[212:215], v14 offset:20480
  ds_read_b128 v[216:219], v14 offset:24576
  ds_read_b128 v[220:223], v14 offset:28672
  v_exp_f32 v128, v128
  v_exp_f32 v129, v129
  v_exp_f32 v130, v130
  v_exp_f32 v131, v131
  v_add_f32 v22, v22, v128
  v_add_f32 v22, v22, v129
  v_cvt_pk_bf16_f32 v128, v128, v129
  v_exp_f32 v136, v136
  v_exp_f32 v137, v137
  v_add_f32 v22, v22, v130
  v_add_f32 v22, v22, v131
  v_cvt_pk_bf16_f32 v129, v130, v131
  v_exp_f32 v138, v138
  v_exp_f32 v139, v139
  v_add_f32 v22, v22, v136
  v_add_f32 v22, v22, v137
  v_cvt_pk_bf16_f32 v130, v136, v137
  s_nop 0
  v_add_f32 v22, v22, v138
  v_add_f32 v22, v22, v139
  v_cvt_pk_bf16_f32 v131, v138, v139
  s_nop 1
  s_waitcnt lgkmcnt(7)
  v_mfma_f32_32x32x16_bf16 v[32:47], v[192:195], v[128:131], v[32:47]
  ds_read_b128 v[192:195], v15 offset:16384
  v_exp_f32 v132, v132
  v_exp_f32 v133, v133
  v_exp_f32 v134, v134
  v_exp_f32 v135, v135
  v_add_f32 v22, v22, v132
  v_add_f32 v22, v22, v133
  v_cvt_pk_bf16_f32 v132, v132, v133
  s_waitcnt lgkmcnt(7)
  s_add_u32 m0, s21, 0x4000
  v_mfma_f32_32x32x16_bf16 v[48:63], v[196:199], v[128:131], v[48:63]
  buffer_load_dwordx4 v17, s[4:7], s26 offen lds
  ds_read_b128 v[196:199], v15 offset:20480
  v_exp_f32 v140, v140
  v_exp_f32 v141, v141
  v_add_f32 v22, v22, v134
  v_add_f32 v22, v22, v135
  v_cvt_pk_bf16_f32 v133, v134, v135
  v_exp_f32 v142, v142
  v_exp_f32 v143, v143
  s_waitcnt lgkmcnt(7)
  v_mfma_f32_32x32x16_bf16 v[64:79], v[200:203], v[128:131], v[64:79]
  ds_read_b128 v[200:203], v15 offset:24576
  v_add_f32 v22, v22, v140
  v_add_f32 v22, v22, v141
  v_cvt_pk_bf16_f32 v134, v140, v141
  s_nop 0
  v_add_f32 v22, v22, v142
  v_add_f32 v22, v22, v143
  v_cvt_pk_bf16_f32 v135, v142, v143
  s_waitcnt lgkmcnt(7)
  v_mfma_f32_32x32x16_bf16 v[80:95], v[204:207], v[128:131], v[80:95]
  ds_read_b128 v[204:207], v15 offset:28672
  s_nop 1
  s_waitcnt lgkmcnt(7)
  v_mfma_f32_32x32x16_bf16 v[32:47], v[208:211], v[132:135], v[32:47]
  ds_read_b128 v[208:211], v16 offset:16384
  v_exp_f32 v144, v144
  v_exp_f32 v145, v145
  v_exp_f32 v146, v146
  v_exp_f32 v147, v147
  v_add_f32 v22, v22, v144
  v_add_f32 v22, v22, v145
  v_cvt_pk_bf16_f32 v144, v144, v145
  s_waitcnt lgkmcnt(7)
  s_add_u32 m0, s21, 0x6000
  v_mfma_f32_32x32x16_bf16 v[48:63], v[212:215], v[132:135], v[48:63]
  buffer_load_dwordx4 v18, s[4:7], s26 offen lds
  ds_read_b128 v[212:215], v16 offset:20480
  v_exp_f32 v152, v152
  v_exp_f32 v153, v153
  v_add_f32 v22, v22, v146
  v_add_f32 v22, v22, v147
  v_cvt_pk_bf16_f32 v145, v146, v147
  v_exp_f32 v154, v154
  v_exp_f32 v155, v155
  s_waitcnt lgkmcnt(7)
  v_mfma_f32_32x32x16_bf16 v[64:79], v[216:219], v[132:135], v[64:79]
  ds_read_b128 v[216:219], v16 offset:24576
  v_add_f32 v22, v22, v152
  v_add_f32 v22, v22, v153
  v_cvt_pk_bf16_f32 v146, v152, v153
  s_nop 0
  v_add_f32 v22, v22, v154
  v_add_f32 v22, v22, v155
  v_cvt_pk_bf16_f32 v147, v154, v155
  s_waitcnt lgkmcnt(7)
  v_mfma_f32_32x32x16_bf16 v[80:95], v[220:223], v[132:135], v[80:95]
  ds_read_b128 v[220:223], v16 offset:28672
  s_nop 1
  s_waitcnt lgkmcnt(7)
  v_mfma_f32_32x32x16_bf16 v[32:47], v[192:195], v[144:147], v[32:47]
  v_exp_f32 v148, v148
  v_exp_f32 v149, v149
  v_exp_f32 v150, v150
  v_exp_f32 v151, v151
  v_add_f32 v22, v22, v148
  v_add_f32 v22, v22, v149
  v_cvt_pk_bf16_f32 v148, v148, v149
  s_waitcnt lgkmcnt(6)
  s_add_u32 m0, s21, 0x10000
  v_mfma_f32_32x32x16_bf16 v[48:63], v[196:199], v[144:147], v[48:63]
  buffer_load_dwordx4 v19, s[8:11], s27 offen lds
  v_exp_f32 v156, v156
  v_exp_f32 v157, v157
  v_add_f32 v22, v22, v150
  v_add_f32 v22, v22, v151
  v_cvt_pk_bf16_f32 v149, v150, v151
  v_exp_f32 v158, v158
  v_exp_f32 v159, v159
  s_waitcnt lgkmcnt(5)
  v_mfma_f32_32x32x16_bf16 v[64:79], v[200:203], v[144:147], v[64:79]
  v_add_f32 v22, v22, v156
  v_add_f32 v22, v22, v157
  v_cvt_pk_bf16_f32 v150, v156, v157
  s_nop 0
  v_add_f32 v22, v22, v158
  v_add_f32 v22, v22, v159
  v_cvt_pk_bf16_f32 v151, v158, v159
  s_waitcnt lgkmcnt(4)
  v_mfma_f32_32x32x16_bf16 v[80:95], v[204:207], v[144:147], v[80:95]
  s_nop 1
  s_waitcnt lgkmcnt(3)
  v_mfma_f32_32x32x16_bf16 v[32:47], v[208:211], v[148:151], v[32:47]
  s_waitcnt lgkmcnt(2)
  s_add_u32 m0, s21, 0x12000
  v_mfma_f32_32x32x16_bf16 v[48:63], v[212:215], v[148:151], v[48:63]
  buffer_load_dwordx4 v20, s[8:11], s27 offen lds
  s_add_u32 s26, s26, 0x80000
  s_add_u32 s27, s27, 128
  s_waitcnt lgkmcnt(1)
  v_mfma_f32_32x32x16_bf16 v[64:79], v[216:219], v[148:151], v[64:79]
  s_waitcnt lgkmcnt(0)
  v_mfma_f32_32x32x16_bf16 v[80:95], v[220:223], v[148:151], v[80:95]
  s_branch attn_kernel_loader
attn_kernel_fin2:
  s_waitcnt lgkmcnt(0)
  ds_read_b128 v[192:195], v13 offset:32768
  ds_read_b128 v[196:199], v13 offset:36864
  ds_read_b128 v[200:203], v13 offset:40960
  ds_read_b128 v[204:207], v13 offset:45056
  ds_read_b128 v[208:211], v14 offset:32768
  ds_read_b128 v[212:215], v14 offset:36864
  ds_read_b128 v[216:219], v14 offset:40960
  ds_read_b128 v[220:223], v14 offset:45056
  v_exp_f32 v96, v96
  v_exp_f32 v97, v97
  v_exp_f32 v98, v98
  v_exp_f32 v99, v99
  v_add_f32 v22, v22, v96
  v_add_f32 v22, v22, v97
  v_cvt_pk_bf16_f32 v96, v96, v97
  v_exp_f32 v104, v104
  v_exp_f32 v105, v105
  v_add_f32 v22, v22, v98
  v_add_f32 v22, v22, v99
  v_cvt_pk_bf16_f32 v97, v98, v99
  v_exp_f32 v106, v106
  v_exp_f32 v107, v107
  v_add_f32 v22, v22, v104
  v_add_f32 v22, v22, v105
  v_cvt_pk_bf16_f32 v98, v104, v105
  s_nop 0
  v_add_f32 v22, v22, v106
  v_add_f32 v22, v22, v107
  v_cvt_pk_bf16_f32 v99, v106, v107
  s_nop 1
  s_waitcnt lgkmcnt(7)
  v_mfma_f32_32x32x16_bf16 v[32:47], v[192:195], v[96:99], v[32:47]
  ds_read_b128 v[192:195], v15 offset:32768
  v_exp_f32 v100, v100
  v_exp_f32 v101, v101
  v_exp_f32 v102, v102
  v_exp_f32 v103, v103
  v_add_f32 v22, v22, v100
  v_add_f32 v22, v22, v101
  v_cvt_pk_bf16_f32 v100, v100, v101
  s_waitcnt lgkmcnt(7)
  s_add_u32 m0, s21, 0x8000
  v_mfma_f32_32x32x16_bf16 v[48:63], v[196:199], v[96:99], v[48:63]
  buffer_load_dwordx4 v17, s[4:7], s26 offen lds
  ds_read_b128 v[196:199], v15 offset:36864
  v_exp_f32 v108, v108
  v_exp_f32 v109, v109
  v_add_f32 v22, v22, v102
  v_add_f32 v22, v22, v103
  v_cvt_pk_bf16_f32 v101, v102, v103
  v_exp_f32 v110, v110
  v_exp_f32 v111, v111
  s_waitcnt lgkmcnt(7)
  v_mfma_f32_32x32x16_bf16 v[64:79], v[200:203], v[96:99], v[64:79]
  ds_read_b128 v[200:203], v15 offset:40960
  v_add_f32 v22, v22, v108
  v_add_f32 v22, v22, v109
  v_cvt_pk_bf16_f32 v102, v108, v109
  s_nop 0
  v_add_f32 v22, v22, v110
  v_add_f32 v22, v22, v111
  v_cvt_pk_bf16_f32 v103, v110, v111
  s_waitcnt lgkmcnt(7)
  v_mfma_f32_32x32x16_bf16 v[80:95], v[204:207], v[96:99], v[80:95]
  ds_read_b128 v[204:207], v15 offset:45056
  s_nop 1
  s_waitcnt lgkmcnt(7)
  v_mfma_f32_32x32x16_bf16 v[32:47], v[208:211], v[100:103], v[32:47]
  ds_read_b128 v[208:211], v16 offset:32768
  v_exp_f32 v112, v112
  v_exp_f32 v113, v113
  v_exp_f32 v114, v114
  v_exp_f32 v115, v115
  v_add_f32 v22, v22, v112
  v_add_f32 v22, v22, v113
  v_cvt_pk_bf16_f32 v112, v112, v113
  s_waitcnt lgkmcnt(7)
  s_add_u32 m0, s21, 0xa000
  v_mfma_f32_32x32x16_bf16 v[48:63], v[212:215], v[100:103], v[48:63]
  buffer_load_dwordx4 v18, s[4:7], s26 offen lds
  ds_read_b128 v[212:215], v16 offset:36864
  v_exp_f32 v120, v120
  v_exp_f32 v121, v121
  v_add_f32 v22, v22, v114
  v_add_f32 v22, v22, v115
  v_cvt_pk_bf16_f32 v113, v114, v115
  v_exp_f32 v122, v122
  v_exp_f32 v123, v123
  s_waitcnt lgkmcnt(7)
  v_mfma_f32_32x32x16_bf16 v[64:79], v[216:219], v[100:103], v[64:79]
  ds_read_b128 v[216:219], v16 offset:40960
  v_add_f32 v22, v22, v120
  v_add_f32 v22, v22, v121
  v_cvt_pk_bf16_f32 v114, v120, v121
  s_nop 0
  v_add_f32 v22, v22, v122
  v_add_f32 v22, v22, v123
  v_cvt_pk_bf16_f32 v115, v122, v123
  s_waitcnt lgkmcnt(7)
  v_mfma_f32_32x32x16_bf16 v[80:95], v[220:223], v[100:103], v[80:95]
  ds_read_b128 v[220:223], v16 offset:45056
  s_nop 1
  s_waitcnt lgkmcnt(7)
  v_mfma_f32_32x32x16_bf16 v[32:47], v[192:195], v[112:115], v[32:47]
  v_exp_f32 v116, v116
  v_exp_f32 v117, v117
  v_exp_f32 v118, v118
  v_exp_f32 v119, v119
  v_add_f32 v22, v22, v116
  v_add_f32 v22, v22, v117
  v_cvt_pk_bf16_f32 v116, v116, v117
  s_waitcnt lgkmcnt(6)
  s_add_u32 m0, s21, 0x14000
  v_mfma_f32_32x32x16_bf16 v[48:63], v[196:199], v[112:115], v[48:63]
  buffer_load_dwordx4 v19, s[8:11], s27 offen lds
  v_exp_f32 v124, v124
  v_exp_f32 v125, v125
  v_add_f32 v22, v22, v118
  v_add_f32 v22, v22, v119
  v_cvt_pk_bf16_f32 v117, v118, v119
  v_exp_f32 v126, v126
  v_exp_f32 v127, v127
  s_waitcnt lgkmcnt(5)
  v_mfma_f32_32x32x16_bf16 v[64:79], v[200:203], v[112:115], v[64:79]
  v_add_f32 v22, v22, v124
  v_add_f32 v22, v22, v125
  v_cvt_pk_bf16_f32 v118, v124, v125
  s_nop 0
  v_add_f32 v22, v22, v126
  v_add_f32 v22, v22, v127
  v_cvt_pk_bf16_f32 v119, v126, v127
  s_waitcnt lgkmcnt(4)
  v_mfma_f32_32x32x16_bf16 v[80:95], v[204:207], v[112:115], v[80:95]
  s_nop 1
  s_waitcnt lgkmcnt(3)
  v_mfma_f32_32x32x16_bf16 v[32:47], v[208:211], v[116:119], v[32:47]
  s_waitcnt lgkmcnt(2)
  s_add_u32 m0, s21, 0x16000
  v_mfma_f32_32x32x16_bf16 v[48:63], v[212:215], v[116:119], v[48:63]
  buffer_load_dwordx4 v20, s[8:11], s27 offen lds
  s_add_u32 s26, s26, 0x80000
  s_add_u32 s27, s27, 128
  s_waitcnt lgkmcnt(1)
  v_mfma_f32_32x32x16_bf16 v[64:79], v[216:219], v[116:119], v[64:79]
  s_waitcnt lgkmcnt(0)
  v_mfma_f32_32x32x16_bf16 v[80:95], v[220:223], v[116:119], v[80:95]
  s_branch attn_kernel_loader
attn_kernel_fin3:
  s_waitcnt lgkmcnt(0)
  ds_read_b128 v[192:195], v13 offset:49152
  ds_read_b128 v[196:199], v13 offset:53248
  ds_read_b128 v[200:203], v13 offset:57344
  ds_read_b128 v[204:207], v13 offset:61440
  ds_read_b128 v[208:211], v14 offset:49152
  ds_read_b128 v[212:215], v14 offset:53248
  ds_read_b128 v[216:219], v14 offset:57344
  ds_read_b128 v[220:223], v14 offset:61440
  v_exp_f32 v128, v128
  v_exp_f32 v129, v129
  v_exp_f32 v130, v130
  v_exp_f32 v131, v131
  v_add_f32 v22, v22, v128
  v_add_f32 v22, v22, v129
  v_cvt_pk_bf16_f32 v128, v128, v129
  v_exp_f32 v136, v136
  v_exp_f32 v137, v137
  v_add_f32 v22, v22, v130
  v_add_f32 v22, v22, v131
  v_cvt_pk_bf16_f32 v129, v130, v131
  v_exp_f32 v138, v138
  v_exp_f32 v139, v139
  v_add_f32 v22, v22, v136
  v_add_f32 v22, v22, v137
  v_cvt_pk_bf16_f32 v130, v136, v137
  s_nop 0
  v_add_f32 v22, v22, v138
  v_add_f32 v22, v22, v139
  v_cvt_pk_bf16_f32 v131, v138, v139
  s_nop 1
  s_waitcnt lgkmcnt(7)
  v_mfma_f32_32x32x16_bf16 v[32:47], v[192:195], v[128:131], v[32:47]
  ds_read_b128 v[192:195], v15 offset:49152
  v_exp_f32 v132, v132
  v_exp_f32 v133, v133
  v_exp_f32 v134, v134
  v_exp_f32 v135, v135
  v_add_f32 v22, v22, v132
  v_add_f32 v22, v22, v133
  v_cvt_pk_bf16_f32 v132, v132, v133
  s_waitcnt lgkmcnt(7)
  s_add_u32 m0, s21, 0xc000
  v_mfma_f32_32x32x16_bf16 v[48:63], v[196:199], v[128:131], v[48:63]
  buffer_load_dwordx4 v17, s[4:7], s26 offen lds
  ds_read_b128 v[196:199], v15 offset:53248
  v_exp_f32 v140, v140
  v_exp_f32 v141, v141
  v_add_f32 v22, v22, v134
  v_add_f32 v22, v22, v135
  v_cvt_pk_bf16_f32 v133, v134, v135
  v_exp_f32 v142, v142
  v_exp_f32 v143, v143
  s_waitcnt lgkmcnt(7)
  v_mfma_f32_32x32x16_bf16 v[64:79], v[200:203], v[128:131], v[64:79]
  ds_read_b128 v[200:203], v15 offset:57344
  v_add_f32 v22, v22, v140
  v_add_f32 v22, v22, v141
  v_cvt_pk_bf16_f32 v134, v140, v141
  s_nop 0
  v_add_f32 v22, v22, v142
  v_add_f32 v22, v22, v143
  v_cvt_pk_bf16_f32 v135, v142, v143
  s_waitcnt lgkmcnt(7)
  v_mfma_f32_32x32x16_bf16 v[80:95], v[204:207], v[128:131], v[80:95]
  ds_read_b128 v[204:207], v15 offset:61440
  s_nop 1
  s_waitcnt lgkmcnt(7)
  v_mfma_f32_32x32x16_bf16 v[32:47], v[208:211], v[132:135], v[32:47]
  ds_read_b128 v[208:211], v16 offset:49152
  v_exp_f32 v144, v144
  v_exp_f32 v145, v145
  v_exp_f32 v146, v146
  v_exp_f32 v147, v147
  v_add_f32 v22, v22, v144
  v_add_f32 v22, v22, v145
  v_cvt_pk_bf16_f32 v144, v144, v145
  s_waitcnt lgkmcnt(7)
  s_add_u32 m0, s21, 0xe000
  v_mfma_f32_32x32x16_bf16 v[48:63], v[212:215], v[132:135], v[48:63]
  buffer_load_dwordx4 v18, s[4:7], s26 offen lds
  ds_read_b128 v[212:215], v16 offset:53248
  v_exp_f32 v152, v152
  v_exp_f32 v153, v153
  v_add_f32 v22, v22, v146
  v_add_f32 v22, v22, v147
  v_cvt_pk_bf16_f32 v145, v146, v147
  v_exp_f32 v154, v154
  v_exp_f32 v155, v155
  s_waitcnt lgkmcnt(7)
  v_mfma_f32_32x32x16_bf16 v[64:79], v[216:219], v[132:135], v[64:79]
  ds_read_b128 v[216:219], v16 offset:57344
  v_add_f32 v22, v22, v152
  v_add_f32 v22, v22, v153
  v_cvt_pk_bf16_f32 v146, v152, v153
  s_nop 0
  v_add_f32 v22, v22, v154
  v_add_f32 v22, v22, v155
  v_cvt_pk_bf16_f32 v147, v154, v155
  s_waitcnt lgkmcnt(7)
  v_mfma_f32_32x32x16_bf16 v[80:95], v[220:223], v[132:135], v[80:95]
  ds_read_b128 v[220:223], v16 offset:61440
  s_nop 1
  s_waitcnt lgkmcnt(7)
  v_mfma_f32_32x32x16_bf16 v[32:47], v[192:195], v[144:147], v[32:47]
  v_exp_f32 v148, v148
  v_exp_f32 v149, v149
  v_exp_f32 v150, v150
  v_exp_f32 v151, v151
  v_add_f32 v22, v22, v148
  v_add_f32 v22, v22, v149
  v_cvt_pk_bf16_f32 v148, v148, v149
  s_waitcnt lgkmcnt(6)
  s_add_u32 m0, s21, 0x18000
  v_mfma_f32_32x32x16_bf16 v[48:63], v[196:199], v[144:147], v[48:63]
  buffer_load_dwordx4 v19, s[8:11], s27 offen lds
  v_exp_f32 v156, v156
  v_exp_f32 v157, v157
  v_add_f32 v22, v22, v150
  v_add_f32 v22, v22, v151
  v_cvt_pk_bf16_f32 v149, v150, v151
  v_exp_f32 v158, v158
  v_exp_f32 v159, v159
  s_waitcnt lgkmcnt(5)
  v_mfma_f32_32x32x16_bf16 v[64:79], v[200:203], v[144:147], v[64:79]
  v_add_f32 v22, v22, v156
  v_add_f32 v22, v22, v157
  v_cvt_pk_bf16_f32 v150, v156, v157
  s_nop 0
  v_add_f32 v22, v22, v158
  v_add_f32 v22, v22, v159
  v_cvt_pk_bf16_f32 v151, v158, v159
  s_waitcnt lgkmcnt(4)
  v_mfma_f32_32x32x16_bf16 v[80:95], v[204:207], v[144:147], v[80:95]
  s_nop 1
  s_waitcnt lgkmcnt(3)
  v_mfma_f32_32x32x16_bf16 v[32:47], v[208:211], v[148:151], v[32:47]
  s_waitcnt lgkmcnt(2)
  s_add_u32 m0, s21, 0x1a000
  v_mfma_f32_32x32x16_bf16 v[48:63], v[212:215], v[148:151], v[48:63]
  buffer_load_dwordx4 v20, s[8:11], s27 offen lds
  s_add_u32 s26, s26, 0x80000
  s_add_u32 s27, s27, 128
  s_waitcnt lgkmcnt(1)
  v_mfma_f32_32x32x16_bf16 v[64:79], v[216:219], v[148:151], v[64:79]
  s_waitcnt lgkmcnt(0)
  v_mfma_f32_32x32x16_bf16 v[80:95], v[220:223], v[148:151], v[80:95]
attn_kernel_loader:
  s_cmp_lt_u32 s20, 4
  s_cbranch_scc1 attn_kernel_loader_l
  s_load_dwordx2 s[34:35], s[0:1], 40
  s_load_dwordx2 s[36:37], s[0:1], 56
  s_load_dwordx2 s[38:39], s[0:1], 72
  s_lshl_b32 s46, s2, 2
  s_add_u32 s46, s46, s20
  s_sub_u32 s46, s46, 4
  s_mul_i32 s46, s46, 6144
  v_lshlrev_b32 v2, 4, v1
  s_waitcnt lgkmcnt(0)
  s_mov_b32 s12, s34
  s_mov_b32 s13, s35
  s_mov_b32 s14, 0x480000
  s_mov_b32 s15, 0x00020000
  s_add_u32 s47, s46, 4096
  buffer_load_dwordx4 v[248:251], v2, s[12:15], s46 offen offset:0
  buffer_load_dwordx4 v[248:251], v2, s[12:15], s46 offen offset:1024
  buffer_load_dwordx4 v[248:251], v2, s[12:15], s46 offen offset:2048
  buffer_load_dwordx4 v[248:251], v2, s[12:15], s46 offen offset:3072
  buffer_load_dwordx4 v[248:251], v2, s[12:15], s47 offen offset:0
  buffer_load_dwordx4 v[248:251], v2, s[12:15], s47 offen offset:1024
  s_mov_b32 s12, s36
  s_mov_b32 s13, s37
  s_mov_b32 s14, 0x510000
  s_mov_b32 s15, 0x00020000
  s_add_u32 s47, s46, 4096
  buffer_load_dwordx4 v[248:251], v2, s[12:15], s46 offen offset:0
  buffer_load_dwordx4 v[248:251], v2, s[12:15], s46 offen offset:1024
  buffer_load_dwordx4 v[248:251], v2, s[12:15], s46 offen offset:2048
  buffer_load_dwordx4 v[248:251], v2, s[12:15], s46 offen offset:3072
  buffer_load_dwordx4 v[248:251], v2, s[12:15], s47 offen offset:0
  buffer_load_dwordx4 v[248:251], v2, s[12:15], s47 offen offset:1024
  s_mov_b32 s12, s38
  s_mov_b32 s13, s39
  s_mov_b32 s14, 0x510000
  s_mov_b32 s15, 0x00020000
  s_add_u32 s47, s46, 4096
  buffer_load_dwordx4 v[248:251], v2, s[12:15], s46 offen offset:0
  buffer_load_dwordx4 v[248:251], v2, s[12:15], s46 offen offset:1024
  buffer_load_dwordx4 v[248:251], v2, s[12:15], s46 offen offset:2048
  buffer_load_dwordx4 v[248:251], v2, s[12:15], s46 offen offset:3072
  buffer_load_dwordx4 v[248:251], v2, s[12:15], s47 offen offset:0
  buffer_load_dwordx4 v[248:251], v2, s[12:15], s47 offen offset:1024
attn_kernel_loader_l:
  s_add_u32 s25, s25, 1
  s_cmp_ge_u32 s25, s24
  s_cbranch_scc1 attn_kernel_epi
  s_waitcnt vmcnt(8) lgkmcnt(0)
  s_barrier
  s_and_b32 s47, s25, 3
  s_lshl_b32 s47, s47, 14
  s_add_u32 s47, s47, s21
  s_add_u32 m0, s47, 0x0
  s_nop 0
  buffer_load_dwordx4 v17, s[4:7], s26 offen lds
  s_add_u32 m0, s47, 0x2000
  s_nop 0
  buffer_load_dwordx4 v18, s[4:7], s26 offen lds
  s_add_u32 s46, s25, 3
  s_and_b32 s47, s46, 3
  s_lshl_b32 s47, s47, 14
  s_add_u32 s47, s47, s21
  s_add_u32 m0, s47, 0x10000
  s_nop 0
  buffer_load_dwordx4 v19, s[8:11], s27 offen lds
  s_add_u32 m0, s47, 0x12000
  s_nop 0
  buffer_load_dwordx4 v20, s[8:11], s27 offen lds
  s_add_u32 s26, s26, 0x80000
  s_add_u32 s27, s27, 128
  s_branch attn_kernel_loader_l
attn_kernel_epi:
  s_waitcnt vmcnt(0)
  s_barrier
  s_lshl_b32 s46, s22, 13
  s_add_u32 s46, s46, s44
  s_sub_u32 s47, 16777216, s46
  s_add_u32 s16, s40, 0x2240000
  s_addc_u32 s17, s41, 0
  s_add_u32 s16, s16, s46
  s_addc_u32 s17, s17, 0
  s_mov_b32 s18, s47
  s_mov_b32 s19, 0x00020000
  v_mov_b32 v26, v22
  s_lshl_b32 s33, s20, 13
  s_nop 0
  v_permlane32_swap_b32 v22, v26
  s_nop 1
  v_add_f32 v22, v22, v26
  v_rcp_f32 v22, v22
  v_add_u32 v5, s33, v5
  v_add_u32 v6, s33, v6
  v_add_u32 v7, s33, v7
  v_add_u32 v8, s33, v8
  v_add_u32 v9, s33, v9
  v_add_u32 v10, s33, v10
  v_add_u32 v11, s33, v11
  v_add_u32 v12, s33, v12
  v_lshlrev_b32 v2, 4, v1
  v_add_u32 v2, s33, v2
  v_lshrrev_b32 v3, 4, v1
  v_mul_f32 v32, v32, v22
  v_mul_f32 v33, v33, v22
  v_mul_f32 v34, v34, v22
  v_mul_f32 v35, v35, v22
  v_mul_f32 v40, v40, v22
  v_mul_f32 v41, v41, v22
  v_mul_f32 v42, v42, v22
  v_mul_f32 v43, v43, v22
  v_cvt_pk_bf16_f32 v32, v32, v33
  v_cvt_pk_bf16_f32 v33, v34, v35
  v_cvt_pk_bf16_f32 v34, v40, v41
  v_cvt_pk_bf16_f32 v35, v42, v43
  ds_write_b128 v5, v[32:35]
  v_mul_f32 v36, v36, v22
  v_mul_f32 v37, v37, v22
  v_mul_f32 v38, v38, v22
  v_mul_f32 v39, v39, v22
  v_mul_f32 v44, v44, v22
  v_mul_f32 v45, v45, v22
  v_mul_f32 v46, v46, v22
  v_mul_f32 v47, v47, v22
  v_cvt_pk_bf16_f32 v36, v36, v37
  v_cvt_pk_bf16_f32 v37, v38, v39
  v_cvt_pk_bf16_f32 v38, v44, v45
  v_cvt_pk_bf16_f32 v39, v46, v47
  ds_write_b128 v6, v[36:39]
  v_mul_f32 v48, v48, v22
  v_mul_f32 v49, v49, v22
  v_mul_f32 v50, v50, v22
  v_mul_f32 v51, v51, v22
  v_mul_f32 v56, v56, v22
  v_mul_f32 v57, v57, v22
  v_mul_f32 v58, v58, v22
  v_mul_f32 v59, v59, v22
  v_cvt_pk_bf16_f32 v48, v48, v49
  v_cvt_pk_bf16_f32 v49, v50, v51
  v_cvt_pk_bf16_f32 v50, v56, v57
  v_cvt_pk_bf16_f32 v51, v58, v59
  ds_write_b128 v7, v[48:51]
  v_mul_f32 v52, v52, v22
  v_mul_f32 v53, v53, v22
  v_mul_f32 v54, v54, v22
  v_mul_f32 v55, v55, v22
  v_mul_f32 v60, v60, v22
  v_mul_f32 v61, v61, v22
  v_mul_f32 v62, v62, v22
  v_mul_f32 v63, v63, v22
  v_cvt_pk_bf16_f32 v52, v52, v53
  v_cvt_pk_bf16_f32 v53, v54, v55
  v_cvt_pk_bf16_f32 v54, v60, v61
  v_cvt_pk_bf16_f32 v55, v62, v63
  ds_write_b128 v8, v[52:55]
  v_mul_f32 v64, v64, v22
  v_mul_f32 v65, v65, v22
  v_mul_f32 v66, v66, v22
  v_mul_f32 v67, v67, v22
  v_mul_f32 v72, v72, v22
  v_mul_f32 v73, v73, v22
  v_mul_f32 v74, v74, v22
  v_mul_f32 v75, v75, v22
  v_cvt_pk_bf16_f32 v64, v64, v65
  v_cvt_pk_bf16_f32 v65, v66, v67
  v_cvt_pk_bf16_f32 v66, v72, v73
  v_cvt_pk_bf16_f32 v67, v74, v75
  ds_write_b128 v9, v[64:67]
  v_mul_f32 v68, v68, v22
  v_mul_f32 v69, v69, v22
  v_mul_f32 v70, v70, v22
  v_mul_f32 v71, v71, v22
  v_mul_f32 v76, v76, v22
  v_mul_f32 v77, v77, v22
  v_mul_f32 v78, v78, v22
  v_mul_f32 v79, v79, v22
  v_cvt_pk_bf16_f32 v68, v68, v69
  v_cvt_pk_bf16_f32 v69, v70, v71
  v_cvt_pk_bf16_f32 v70, v76, v77
  v_cvt_pk_bf16_f32 v71, v78, v79
  ds_write_b128 v10, v[68:71]
  v_mul_f32 v80, v80, v22
  v_mul_f32 v81, v81, v22
  v_mul_f32 v82, v82, v22
  v_mul_f32 v83, v83, v22
  v_mul_f32 v88, v88, v22
  v_mul_f32 v89, v89, v22
  v_mul_f32 v90, v90, v22
  v_mul_f32 v91, v91, v22
  v_cvt_pk_bf16_f32 v80, v80, v81
  v_cvt_pk_bf16_f32 v81, v82, v83
  v_cvt_pk_bf16_f32 v82, v88, v89
  v_cvt_pk_bf16_f32 v83, v90, v91
  ds_write_b128 v11, v[80:83]
  v_mul_f32 v84, v84, v22
  v_mul_f32 v85, v85, v22
  v_mul_f32 v86, v86, v22
  v_mul_f32 v87, v87, v22
  v_mul_f32 v92, v92, v22
  v_mul_f32 v93, v93, v22
  v_mul_f32 v94, v94, v22
  v_mul_f32 v95, v95, v22
  v_cvt_pk_bf16_f32 v84, v84, v85
  v_cvt_pk_bf16_f32 v85, v86, v87
  v_cvt_pk_bf16_f32 v86, v92, v93
  v_cvt_pk_bf16_f32 v87, v94, v95
  ds_write_b128 v12, v[84:87]
  v_add_u32 v4, 0, v3
  v_xor_b32 v28, v4, v1
  v_and_b32 v28, 15, v28
  v_lshlrev_b32 v28, 4, v28
  v_lshl_add_u32 v13, v4, 13, v28
  v_add_u32 v4, 4, v3
  v_xor_b32 v28, v4, v1
  v_and_b32 v28, 15, v28
  v_lshlrev_b32 v28, 4, v28
  v_lshl_add_u32 v14, v4, 13, v28
  v_add_u32 v4, 8, v3
  v_xor_b32 v28, v4, v1
  v_and_b32 v28, 15, v28
  v_lshlrev_b32 v28, 4, v28
  v_lshl_add_u32 v15, v4, 13, v28
  v_add_u32 v4, 12, v3
  v_xor_b32 v28, v4, v1
  v_and_b32 v28, 15, v28
  v_lshlrev_b32 v28, 4, v28
  v_lshl_add_u32 v16, v4, 13, v28
  s_waitcnt lgkmcnt(0)
  ds_read_b128 v[96:99], v2 offset:0
  ds_read_b128 v[100:103], v2 offset:1024
  ds_read_b128 v[104:107], v2 offset:2048
  ds_read_b128 v[108:111], v2 offset:3072
  ds_read_b128 v[112:115], v2 offset:4096
  ds_read_b128 v[116:119], v2 offset:5120
  ds_read_b128 v[120:123], v2 offset:6144
  ds_read_b128 v[124:127], v2 offset:7168
  s_mov_b32 s46, 0x20000
  s_waitcnt lgkmcnt(7)
  buffer_store_dwordx4 v[96:99], v13, s[16:19], 0 offen sc1
  s_waitcnt lgkmcnt(6)
  buffer_store_dwordx4 v[100:103], v14, s[16:19], 0 offen sc1
  s_waitcnt lgkmcnt(5)
  buffer_store_dwordx4 v[104:107], v15, s[16:19], 0 offen sc1
  s_waitcnt lgkmcnt(4)
  buffer_store_dwordx4 v[108:111], v16, s[16:19], 0 offen sc1
  s_waitcnt lgkmcnt(3)
  buffer_store_dwordx4 v[112:115], v13, s[16:19], s46 offen sc1
  s_waitcnt lgkmcnt(2)
  buffer_store_dwordx4 v[116:119], v14, s[16:19], s46 offen sc1
  s_waitcnt lgkmcnt(1)
  buffer_store_dwordx4 v[120:123], v15, s[16:19], s46 offen sc1
  s_waitcnt lgkmcnt(0)
  buffer_store_dwordx4 v[124:127], v16, s[16:19], s46 offen sc1
attn_kernel_end:
  s_endpgm
.globl oproj_kernel
.p2align 8
.type oproj_kernel,@function
oproj_kernel:
  s_cmp_ge_u32 s2, 256
  s_cbranch_scc1 oproj_kernel_end
  v_and_b32 v1, 63, v0
  v_lshrrev_b32 v2, 6, v0
  s_nop 0
  v_readfirstlane_b32 s20, v2
  s_load_dwordx2 s[36:37], s[0:1], 40
  s_load_dwordx2 s[40:41], s[0:1], 104
  s_and_b32 s44, s2, 7
  s_lshr_b32 s45, s2, 3
  s_and_b32 s42, s45, 3
  s_lshr_b32 s45, s45, 2
  s_and_b32 s46, s44, 1
  s_lshl_b32 s46, s46, 3
  s_add_u32 s45, s45, s46
  s_lshr_b32 s43, s44, 1
  s_waitcnt lgkmcnt(0)
  s_mul_i32 s46, s45, 1048576
  s_mul_i32 s47, s43, 2048
  s_add_u32 s46, s46, s47
  s_sub_u32 s47, 16777216, s46
  s_add_u32 s4, s40, 0x2240000
  s_addc_u32 s5, s41, 0
  s_add_u32 s4, s4, s46
  s_addc_u32 s5, s5, 0
  s_mov_b32 s6, s47
  s_mov_b32 s7, 0x00020000
  s_mul_i32 s46, s43, 1179648
  s_mul_i32 s47, s42, 288
  s_add_u32 s46, s46, s47
  s_sub_u32 s47, 4718592, s46
  s_mov_b32 s8, s36
  s_mov_b32 s9, s37
  s_add_u32 s8, s8, s46
  s_addc_u32 s9, s9, 0
  s_mov_b32 s10, s47
  s_mov_b32 s11, 0x00020000
  s_and_b32 s26, s42, 1
  s_mul_i32 s46, s43, 2359296
  s_mul_i32 s47, s45, 147456
  s_add_u32 s46, s46, s47
  s_mul_i32 s47, s42, 288
  s_and_b32 s47, s47, 0xffffffc0
  s_add_u32 s46, s46, s47
  s_sub_u32 s47, 9437184, s46
  s_add_u32 s12, s40, 0x3240000
  s_addc_u32 s13, s41, 0
  s_add_u32 s12, s12, s46
  s_addc_u32 s13, s13, 0
  s_mov_b32 s14, s47
  s_mov_b32 s15, 0x00020000
  s_lshl_b32 s21, s20, 10
  s_and_b32 s22, s20, 0
  s_lshr_b32 s23, s20, 0
  s_and_b32 s24, s23, 3
  s_lshr_b32 s25, s23, 2
  s_and_b32 s28, s20, 1
  s_lshl_b32 s28, s28, 2
  v_lshrrev_b32 v2, 4, v1
  v_add_u32 v2, s28, v2
  v_xor_b32 v2, v2, v1
  v_and_b32 v2, 7, v2
  v_lshlrev_b32 v2, 4, v2
  v_lshrrev_b32 v3, 3, v1
  s_lshl_b32 s28, s20, 3
  v_add_u32 v3, s28, v3
  s_mov_b32 s28, 8192
  v_mul_lo_u32 v3, v3, s28
  v_add_u32 v5, v3, v2
  v_add_u32 v6, 0x80000, v5
  s_mov_b32 s29, 1152
  s_lshl_b32 s28, s20, 6
  s_add_u32 s28, s28, 0
  v_add_u32 v2, s28, v1
  v_mul_u32_u24 v3, 3641, v2
  v_lshrrev_b32 v3, 16, v3
  v_mul_u32_u24 v4, 18, v3
  v_sub_u32 v2, v2, v4
  v_lshlrev_b32 v2, 4, v2
  v_mul_lo_u32 v3, v3, s29
  v_add_u32 v7, v3, v2
  s_lshl_b32 s28, s20, 6
  s_add_u32 s28, s28, 512
  v_add_u32 v2, s28, v1
  v_mul_u32_u24 v3, 3641, v2
  v_lshrrev_b32 v3, 16, v3
  v_mul_u32_u24 v4, 18, v3
  v_sub_u32 v2, v2, v4
  v_lshlrev_b32 v2, 4, v2
  v_mul_lo_u32 v3, v3, s29
  v_add_u32 v8, v3, v2
  s_lshl_b32 s28, s20, 6
  s_add_u32 s28, s28, 1024
  v_add_u32 v2, s28, v1
  v_mul_u32_u24 v3, 3641, v2
  v_lshrrev_b32 v3, 16, v3
  v_mul_u32_u24 v4, 18, v3
  v_sub_u32 v2, v2, v4
  v_lshlrev_b32 v2, 4, v2
  v_mul_lo_u32 v3, v3, s29
  v_add_u32 v9, v3, v2
  s_mov_b32 s30, 0
  s_mov_b32 s31, 0
  v_lshrrev_b32 v10, 4, v1
  v_and_b32 v2, 15, v1
  v_lshrrev_b32 v3, 1, v2
  v_xor_b32 v3, v3, v10
  s_lshl_b32 s28, s25, 2
  v_xor_b32 v3, s28, v3
  v_lshlrev_b32 v3, 4, v3
  s_mul_i32 s28, s24, 4096
  v_lshl_add_u32 v3, v2, 7, v3
  v_add_u32 v11, s28, v3
  v_bfe_u32 v2, v1, 2, 2
  v_and_b32 v3, 3, v1
  v_lshlrev_b32 v3, 3, v3
  v_lshl_add_u32 v4, v10, 2, v2
  v_mul_u32_u24 v2, 288, v4
  v_add_u32 v12, v2, v3
  s_mul_i32 s28, s25, 9216
  s_add_u32 s28, s28, 0x10000
  v_add_u32 v12, s28, v12
  s_add_u32 m0, s21, 0x0
  s_nop 0
  buffer_load_dwordx4 v5, s[4:7], s30 offen lds
  s_add_u32 m0, s21, 0x2000
  s_nop 0
  buffer_load_dwordx4 v6, s[4:7], s30 offen lds
  s_add_u32 s30, s30, 128
  s_cmp_lt_u32 s20, 2
  s_cbranch_scc0 1f
  s_add_u32 m0, s21, 0x14000
  s_nop 0
  buffer_load_dwordx4 v9, s[8:11], s31 offen lds
1:
  s_add_u32 m0, s21, 0x10000
  s_nop 0
  buffer_load_dwordx4 v7, s[8:11], s31 offen lds
  s_add_u32 m0, s21, 0x12000
  s_nop 0
  buffer_load_dwordx4 v8, s[8:11], s31 offen lds
  s_add_u32 s31, s31, 0x12000
  s_add_u32 m0, s21, 0x4000
  s_nop 0
  buffer_load_dwordx4 v5, s[4:7], s30 offen lds
  s_add_u32 m0, s21, 0x6000
  s_nop 0
  buffer_load_dwordx4 v6, s[4:7], s30 offen lds
  s_add_u32 s30, s30, 128
  s_cmp_lt_u32 s20, 2
  s_cbranch_scc0 1f
  s_add_u32 m0, s21, 0x18800
  s_nop 0
  buffer_load_dwordx4 v9, s[8:11], s31 offen lds
1:
  s_add_u32 m0, s21, 0x14800
  s_nop 0
  buffer_load_dwordx4 v7, s[8:11], s31 offen lds
  s_add_u32 m0, s21, 0x16800
  s_nop 0
  buffer_load_dwordx4 v8, s[8:11], s31 offen lds
  s_add_u32 s31, s31, 0x12000
  s_add_u32 m0, s21, 0x8000
  s_nop 0
  buffer_load_dwordx4 v5, s[4:7], s30 offen lds
  s_add_u32 m0, s21, 0xa000
  s_nop 0
  buffer_load_dwordx4 v6, s[4:7], s30 offen lds
  s_add_u32 s30, s30, 128
  s_cmp_lt_u32 s20, 2
  s_cbranch_scc0 1f
  s_add_u32 m0, s21, 0x1d000
  s_nop 0
  buffer_load_dwordx4 v9, s[8:11], s31 offen lds
1:
  s_add_u32 m0, s21, 0x19000
  s_nop 0
  buffer_load_dwordx4 v7, s[8:11], s31 offen lds
  s_add_u32 m0, s21, 0x1b000
  s_nop 0
  buffer_load_dwordx4 v8, s[8:11], s31 offen lds
  s_add_u32 s31, s31, 0x12000
  s_add_u32 m0, s21, 0xc000
  s_nop 0
  buffer_load_dwordx4 v5, s[4:7], s30 offen lds
  s_add_u32 m0, s21, 0xe000
  s_nop 0
  buffer_load_dwordx4 v6, s[4:7], s30 offen lds
  s_add_u32 s30, s30, 128
  s_cmp_lt_u32 s20, 2
  s_cbranch_scc0 1f
  s_add_u32 m0, s21, 0x21800
  s_nop 0
  buffer_load_dwordx4 v9, s[8:11], s31 offen lds
1:
  s_add_u32 m0, s21, 0x1d800
  s_nop 0
  buffer_load_dwordx4 v7, s[8:11], s31 offen lds
  s_add_u32 m0, s21, 0x1f800
  s_nop 0
  buffer_load_dwordx4 v8, s[8:11], s31 offen lds
  s_add_u32 s31, s31, 0x12000
  s_waitcnt vmcnt(8)
  s_barrier
  ds_read_b128 v[112:115], v11 offset:0
  ds_read_b64_tr_b16 v[88:89], v12 offset:0
  ds_read_b64_tr_b16 v[90:91], v12 offset:4608
  ds_read_b128 v[116:119], v11 offset:2048
  ds_read_b64_tr_b16 v[92:93], v12 offset:32
  ds_read_b64_tr_b16 v[94:95], v12 offset:4640
  ds_read_b64_tr_b16 v[96:97], v12 offset:64
  ds_read_b64_tr_b16 v[98:99], v12 offset:4672
  ds_read_b64_tr_b16 v[100:101], v12 offset:96
  ds_read_b64_tr_b16 v[102:103], v12 offset:4704
  ds_read_b64_tr_b16 v[104:105], v12 offset:128
  ds_read_b64_tr_b16 v[106:107], v12 offset:4736
  s_waitcnt lgkmcnt(9)
  v_mfma_f32_16x16x32_bf16 v[16:19], v[88:91], v[112:115], 0
  s_waitcnt lgkmcnt(8)
  v_mfma_f32_16x16x32_bf16 v[52:55], v[88:91], v[116:119], 0
  ds_read_b64_tr_b16 v[108:109], v12 offset:160
  ds_read_b64_tr_b16 v[110:111], v12 offset:4768
  s_waitcnt lgkmcnt(8)
  v_mfma_f32_16x16x32_bf16 v[20:23], v[92:95], v[112:115], 0
  v_mfma_f32_16x16x32_bf16 v[56:59], v[92:95], v[116:119], 0
  ds_read_b64_tr_b16 v[88:89], v12 offset:192
  ds_read_b64_tr_b16 v[90:91], v12 offset:4800
  s_waitcnt lgkmcnt(8)
  v_mfma_f32_16x16x32_bf16 v[24:27], v[96:99], v[112:115], 0
  v_mfma_f32_16x16x32_bf16 v[60:63], v[96:99], v[116:119], 0
  ds_read_b64_tr_b16 v[92:93], v12 offset:224
  ds_read_b64_tr_b16 v[94:95], v12 offset:4832
  s_waitcnt lgkmcnt(8)
  v_mfma_f32_16x16x32_bf16 v[28:31], v[100:103], v[112:115], 0
  v_mfma_f32_16x16x32_bf16 v[64:67], v[100:103], v[116:119], 0
  ds_read_b64_tr_b16 v[96:97], v12 offset:256
  ds_read_b64_tr_b16 v[98:99], v12 offset:4864
  s_waitcnt lgkmcnt(8)
  v_mfma_f32_16x16x32_bf16 v[32:35], v[104:107], v[112:115], 0
  v_mfma_f32_16x16x32_bf16 v[68:71], v[104:107], v[116:119], 0
  s_waitcnt lgkmcnt(6)
  v_mfma_f32_16x16x32_bf16 v[36:39], v[108:111], v[112:115], 0
  v_mfma_f32_16x16x32_bf16 v[72:75], v[108:111], v[116:119], 0
  v_add_u32 v11, 0x4000, v11
  v_add_u32 v12, 0x4800, v12
  ds_read_b128 v[120:123], v11 offset:0
  ds_read_b64_tr_b16 v[100:101], v12 offset:0
  ds_read_b64_tr_b16 v[102:103], v12 offset:4608
  ds_read_b128 v[124:127], v11 offset:2048
  ds_read_b64_tr_b16 v[104:105], v12 offset:32
  ds_read_b64_tr_b16 v[106:107], v12 offset:4640
  s_waitcnt lgkmcnt(10)
  v_mfma_f32_16x16x32_bf16 v[40:43], v[88:91], v[112:115], 0
  v_mfma_f32_16x16x32_bf16 v[76:79], v[88:91], v[116:119], 0
  ds_read_b64_tr_b16 v[108:109], v12 offset:64
  ds_read_b64_tr_b16 v[110:111], v12 offset:4672
  s_waitcnt lgkmcnt(10)
  v_mfma_f32_16x16x32_bf16 v[44:47], v[92:95], v[112:115], 0
  v_mfma_f32_16x16x32_bf16 v[80:83], v[92:95], v[116:119], 0
  ds_read_b64_tr_b16 v[88:89], v12 offset:96
  ds_read_b64_tr_b16 v[90:91], v12 offset:4704
  s_waitcnt lgkmcnt(10)
  v_mfma_f32_16x16x32_bf16 v[48:51], v[96:99], v[112:115], 0
  v_mfma_f32_16x16x32_bf16 v[84:87], v[96:99], v[116:119], 0
  ds_read_b64_tr_b16 v[92:93], v12 offset:128
  ds_read_b64_tr_b16 v[94:95], v12 offset:4736
  s_waitcnt lgkmcnt(9)
  v_mfma_f32_16x16x32_bf16 v[16:19], v[100:103], v[120:123], v[16:19]
  s_waitcnt lgkmcnt(8)
  v_mfma_f32_16x16x32_bf16 v[52:55], v[100:103], v[124:127], v[52:55]
  ds_read_b64_tr_b16 v[96:97], v12 offset:160
  ds_read_b64_tr_b16 v[98:99], v12 offset:4768
  s_waitcnt lgkmcnt(8)
  v_mfma_f32_16x16x32_bf16 v[20:23], v[104:107], v[120:123], v[20:23]
  v_mfma_f32_16x16x32_bf16 v[56:59], v[104:107], v[124:127], v[56:59]
  ds_read_b64_tr_b16 v[100:101], v12 offset:192
  ds_read_b64_tr_b16 v[102:103], v12 offset:4800
  s_waitcnt lgkmcnt(8)
  v_mfma_f32_16x16x32_bf16 v[24:27], v[108:111], v[120:123], v[24:27]
  v_mfma_f32_16x16x32_bf16 v[60:63], v[108:111], v[124:127], v[60:63]
  ds_read_b64_tr_b16 v[104:105], v12 offset:224
  ds_read_b64_tr_b16 v[106:107], v12 offset:4832
  s_waitcnt lgkmcnt(8)
  v_mfma_f32_16x16x32_bf16 v[28:31], v[88:91], v[120:123], v[28:31]
  v_mfma_f32_16x16x32_bf16 v[64:67], v[88:91], v[124:127], v[64:67]
  ds_read_b64_tr_b16 v[108:109], v12 offset:256
  ds_read_b64_tr_b16 v[110:111], v12 offset:4864
  s_waitcnt lgkmcnt(8)
  v_mfma_f32_16x16x32_bf16 v[32:35], v[92:95], v[120:123], v[32:35]
  v_mfma_f32_16x16x32_bf16 v[68:71], v[92:95], v[124:127], v[68:71]
  s_waitcnt lgkmcnt(6)
  v_mfma_f32_16x16x32_bf16 v[36:39], v[96:99], v[120:123], v[36:39]
  v_mfma_f32_16x16x32_bf16 v[72:75], v[96:99], v[124:127], v[72:75]
  s_mov_b32 s33, 3
oproj_kernel_loop1:
  s_waitcnt vmcnt(0) lgkmcnt(0)
  s_barrier
  v_add_u32 v11, 0x4000, v11
  v_add_u32 v12, 0x4800, v12
  ds_read_b128 v[112:115], v11 offset:0
  ds_read_b64_tr_b16 v[88:89], v12 offset:0
  ds_read_b64_tr_b16 v[90:91], v12 offset:4608
  ds_read_b128 v[116:119], v11 offset:2048
  ds_read_b64_tr_b16 v[92:93], v12 offset:32
  ds_read_b64_tr_b16 v[94:95], v12 offset:4640
  v_mfma_f32_16x16x32_bf16 v[40:43], v[100:103], v[120:123], v[40:43]
  s_add_u32 m0, s21, 0x0
  s_nop 0
  buffer_load_dwordx4 v5, s[4:7], s30 offen lds
  v_mfma_f32_16x16x32_bf16 v[76:79], v[100:103], v[124:127], v[76:79]
  s_add_u32 m0, s21, 0x2000
  s_nop 0
  buffer_load_dwordx4 v6, s[4:7], s30 offen lds
  s_add_u32 s30, s30, 128
  ds_read_b64_tr_b16 v[96:97], v12 offset:64
  ds_read_b64_tr_b16 v[98:99], v12 offset:4672
  v_mfma_f32_16x16x32_bf16 v[44:47], v[104:107], v[120:123], v[44:47]
  s_cmp_lt_u32 s20, 2
  s_cbranch_scc0 1f
  s_add_u32 m0, s21, 0x14000
  s_nop 0
  buffer_load_dwordx4 v9, s[8:11], s31 offen lds
1:
  v_mfma_f32_16x16x32_bf16 v[80:83], v[104:107], v[124:127], v[80:83]
  s_add_u32 m0, s21, 0x10000
  s_nop 0
  buffer_load_dwordx4 v7, s[8:11], s31 offen lds
  ds_read_b64_tr_b16 v[100:101], v12 offset:96
  ds_read_b64_tr_b16 v[102:103], v12 offset:4704
  v_mfma_f32_16x16x32_bf16 v[48:51], v[108:111], v[120:123], v[48:51]
  s_add_u32 m0, s21, 0x12000
  s_nop 0
  buffer_load_dwordx4 v8, s[8:11], s31 offen lds
  s_add_u32 s31, s31, 0x12000
  v_mfma_f32_16x16x32_bf16 v[84:87], v[108:111], v[124:127], v[84:87]
  s_add_u32 m0, s21, 0x4000
  s_nop 0
  buffer_load_dwordx4 v5, s[4:7], s30 offen lds
  ds_read_b64_tr_b16 v[104:105], v12 offset:128
  ds_read_b64_tr_b16 v[106:107], v12 offset:4736
  s_waitcnt lgkmcnt(9)
  v_mfma_f32_16x16x32_bf16 v[16:19], v[88:91], v[112:115], v[16:19]
  s_add_u32 m0, s21, 0x6000
  s_nop 0
  buffer_load_dwordx4 v6, s[4:7], s30 offen lds
  s_add_u32 s30, s30, 128
  s_waitcnt lgkmcnt(8)
  v_mfma_f32_16x16x32_bf16 v[52:55], v[88:91], v[116:119], v[52:55]
  s_cmp_lt_u32 s20, 2
  s_cbranch_scc0 1f
  s_add_u32 m0, s21, 0x18800
  s_nop 0
  buffer_load_dwordx4 v9, s[8:11], s31 offen lds
1:
  ds_read_b64_tr_b16 v[108:109], v12 offset:160
  ds_read_b64_tr_b16 v[110:111], v12 offset:4768
  s_waitcnt lgkmcnt(8)
  v_mfma_f32_16x16x32_bf16 v[20:23], v[92:95], v[112:115], v[20:23]
  s_add_u32 m0, s21, 0x14800
  s_nop 0
  buffer_load_dwordx4 v7, s[8:11], s31 offen lds
  v_mfma_f32_16x16x32_bf16 v[56:59], v[92:95], v[116:119], v[56:59]
  s_add_u32 m0, s21, 0x16800
  s_nop 0
  buffer_load_dwordx4 v8, s[8:11], s31 offen lds
  s_add_u32 s31, s31, 0x12000
  ds_read_b64_tr_b16 v[88:89], v12 offset:192
  ds_read_b64_tr_b16 v[90:91], v12 offset:4800
  s_waitcnt lgkmcnt(8)
  v_mfma_f32_16x16x32_bf16 v[24:27], v[96:99], v[112:115], v[24:27]
  v_mfma_f32_16x16x32_bf16 v[60:63], v[96:99], v[116:119], v[60:63]
  ds_read_b64_tr_b16 v[92:93], v12 offset:224
  ds_read_b64_tr_b16 v[94:95], v12 offset:4832
  s_waitcnt lgkmcnt(8)
  v_mfma_f32_16x16x32_bf16 v[28:31], v[100:103], v[112:115], v[28:31]
  v_mfma_f32_16x16x32_bf16 v[64:67], v[100:103], v[116:119], v[64:67]
  ds_read_b64_tr_b16 v[96:97], v12 offset:256
  ds_read_b64_tr_b16 v[98:99], v12 offset:4864
  s_waitcnt lgkmcnt(8)
  v_mfma_f32_16x16x32_bf16 v[32:35], v[104:107], v[112:115], v[32:35]
  v_mfma_f32_16x16x32_bf16 v[68:71], v[104:107], v[116:119], v[68:71]
  s_waitcnt lgkmcnt(6)
  v_mfma_f32_16x16x32_bf16 v[36:39], v[108:111], v[112:115], v[36:39]
  v_mfma_f32_16x16x32_bf16 v[72:75], v[108:111], v[116:119], v[72:75]
  v_add_u32 v11, 0x4000, v11
  v_add_u32 v12, 0x4800, v12
  ds_read_b128 v[120:123], v11 offset:0
  ds_read_b64_tr_b16 v[100:101], v12 offset:0
  ds_read_b64_tr_b16 v[102:103], v12 offset:4608
  ds_read_b128 v[124:127], v11 offset:2048
  ds_read_b64_tr_b16 v[104:105], v12 offset:32
  ds_read_b64_tr_b16 v[106:107], v12 offset:4640
  s_waitcnt lgkmcnt(10)
  v_mfma_f32_16x16x32_bf16 v[40:43], v[88:91], v[112:115], v[40:43]
  v_mfma_f32_16x16x32_bf16 v[76:79], v[88:91], v[116:119], v[76:79]
  ds_read_b64_tr_b16 v[108:109], v12 offset:64
  ds_read_b64_tr_b16 v[110:111], v12 offset:4672
  s_waitcnt lgkmcnt(10)
  v_mfma_f32_16x16x32_bf16 v[44:47], v[92:95], v[112:115], v[44:47]
  v_mfma_f32_16x16x32_bf16 v[80:83], v[92:95], v[116:119], v[80:83]
  ds_read_b64_tr_b16 v[88:89], v12 offset:96
  ds_read_b64_tr_b16 v[90:91], v12 offset:4704
  s_waitcnt lgkmcnt(10)
  v_mfma_f32_16x16x32_bf16 v[48:51], v[96:99], v[112:115], v[48:51]
  v_mfma_f32_16x16x32_bf16 v[84:87], v[96:99], v[116:119], v[84:87]
  ds_read_b64_tr_b16 v[92:93], v12 offset:128
  ds_read_b64_tr_b16 v[94:95], v12 offset:4736
  s_waitcnt lgkmcnt(9)
  v_mfma_f32_16x16x32_bf16 v[16:19], v[100:103], v[120:123], v[16:19]
  s_waitcnt lgkmcnt(8)
  v_mfma_f32_16x16x32_bf16 v[52:55], v[100:103], v[124:127], v[52:55]
  ds_read_b64_tr_b16 v[96:97], v12 offset:160
  ds_read_b64_tr_b16 v[98:99], v12 offset:4768
  s_waitcnt lgkmcnt(8)
  v_mfma_f32_16x16x32_bf16 v[20:23], v[104:107], v[120:123], v[20:23]
  v_mfma_f32_16x16x32_bf16 v[56:59], v[104:107], v[124:127], v[56:59]
  ds_read_b64_tr_b16 v[100:101], v12 offset:192
  ds_read_b64_tr_b16 v[102:103], v12 offset:4800
  s_waitcnt lgkmcnt(8)
  v_mfma_f32_16x16x32_bf16 v[24:27], v[108:111], v[120:123], v[24:27]
  v_mfma_f32_16x16x32_bf16 v[60:63], v[108:111], v[124:127], v[60:63]
  ds_read_b64_tr_b16 v[104:105], v12 offset:224
  ds_read_b64_tr_b16 v[106:107], v12 offset:4832
  s_waitcnt lgkmcnt(8)
  v_mfma_f32_16x16x32_bf16 v[28:31], v[88:91], v[120:123], v[28:31]
  v_mfma_f32_16x16x32_bf16 v[64:67], v[88:91], v[124:127], v[64:67]
  ds_read_b64_tr_b16 v[108:109], v12 offset:256
  ds_read_b64_tr_b16 v[110:111], v12 offset:4864
  s_waitcnt lgkmcnt(8)
  v_mfma_f32_16x16x32_bf16 v[32:35], v[92:95], v[120:123], v[32:35]
  v_mfma_f32_16x16x32_bf16 v[68:71], v[92:95], v[124:127], v[68:71]
  s_waitcnt lgkmcnt(6)
  v_mfma_f32_16x16x32_bf16 v[36:39], v[96:99], v[120:123], v[36:39]
  v_mfma_f32_16x16x32_bf16 v[72:75], v[96:99], v[124:127], v[72:75]
  s_waitcnt vmcnt(0) lgkmcnt(0)
  s_barrier
  v_subrev_u32 v11, 0xc000, v11
  v_subrev_u32 v12, 0xd800, v12
  ds_read_b128 v[112:115], v11 offset:0
  ds_read_b64_tr_b16 v[88:89], v12 offset:0
  ds_read_b64_tr_b16 v[90:91], v12 offset:4608
  ds_read_b128 v[116:119], v11 offset:2048
  ds_read_b64_tr_b16 v[92:93], v12 offset:32
  ds_read_b64_tr_b16 v[94:95], v12 offset:4640
  v_mfma_f32_16x16x32_bf16 v[40:43], v[100:103], v[120:123], v[40:43]
  s_add_u32 m0, s21, 0x8000
  s_nop 0
  buffer_load_dwordx4 v5, s[4:7], s30 offen lds
  v_mfma_f32_16x16x32_bf16 v[76:79], v[100:103], v[124:127], v[76:79]
  s_add_u32 m0, s21, 0xa000
  s_nop 0
  buffer_load_dwordx4 v6, s[4:7], s30 offen lds
  s_add_u32 s30, s30, 128
  ds_read_b64_tr_b16 v[96:97], v12 offset:64
  ds_read_b64_tr_b16 v[98:99], v12 offset:4672
  v_mfma_f32_16x16x32_bf16 v[44:47], v[104:107], v[120:123], v[44:47]
  s_cmp_lt_u32 s20, 2
  s_cbranch_scc0 1f
  s_add_u32 m0, s21, 0x1d000
  s_nop 0
  buffer_load_dwordx4 v9, s[8:11], s31 offen lds
1:
  v_mfma_f32_16x16x32_bf16 v[80:83], v[104:107], v[124:127], v[80:83]
  s_add_u32 m0, s21, 0x19000
  s_nop 0
  buffer_load_dwordx4 v7, s[8:11], s31 offen lds
  ds_read_b64_tr_b16 v[100:101], v12 offset:96
  ds_read_b64_tr_b16 v[102:103], v12 offset:4704
  v_mfma_f32_16x16x32_bf16 v[48:51], v[108:111], v[120:123], v[48:51]
  s_add_u32 m0, s21, 0x1b000
  s_nop 0
  buffer_load_dwordx4 v8, s[8:11], s31 offen lds
  s_add_u32 s31, s31, 0x12000
  v_mfma_f32_16x16x32_bf16 v[84:87], v[108:111], v[124:127], v[84:87]
  s_add_u32 m0, s21, 0xc000
  s_nop 0
  buffer_load_dwordx4 v5, s[4:7], s30 offen lds
  ds_read_b64_tr_b16 v[104:105], v12 offset:128
  ds_read_b64_tr_b16 v[106:107], v12 offset:4736
  s_waitcnt lgkmcnt(9)
  v_mfma_f32_16x16x32_bf16 v[16:19], v[88:91], v[112:115], v[16:19]
  s_add_u32 m0, s21, 0xe000
  s_nop 0
  buffer_load_dwordx4 v6, s[4:7], s30 offen lds
  s_add_u32 s30, s30, 128
  s_waitcnt lgkmcnt(8)
  v_mfma_f32_16x16x32_bf16 v[52:55], v[88:91], v[116:119], v[52:55]
  s_cmp_lt_u32 s20, 2
  s_cbranch_scc0 1f
  s_add_u32 m0, s21, 0x21800
  s_nop 0
  buffer_load_dwordx4 v9, s[8:11], s31 offen lds
1:
  ds_read_b64_tr_b16 v[108:109], v12 offset:160
  ds_read_b64_tr_b16 v[110:111], v12 offset:4768
  s_waitcnt lgkmcnt(8)
  v_mfma_f32_16x16x32_bf16 v[20:23], v[92:95], v[112:115], v[20:23]
  s_add_u32 m0, s21, 0x1d800
  s_nop 0
  buffer_load_dwordx4 v7, s[8:11], s31 offen lds
  v_mfma_f32_16x16x32_bf16 v[56:59], v[92:95], v[116:119], v[56:59]
  s_add_u32 m0, s21, 0x1f800
  s_nop 0
  buffer_load_dwordx4 v8, s[8:11], s31 offen lds
  s_add_u32 s31, s31, 0x12000
  ds_read_b64_tr_b16 v[88:89], v12 offset:192
  ds_read_b64_tr_b16 v[90:91], v12 offset:4800
  s_waitcnt lgkmcnt(8)
  v_mfma_f32_16x16x32_bf16 v[24:27], v[96:99], v[112:115], v[24:27]
  v_mfma_f32_16x16x32_bf16 v[60:63], v[96:99], v[116:119], v[60:63]
  ds_read_b64_tr_b16 v[92:93], v12 offset:224
  ds_read_b64_tr_b16 v[94:95], v12 offset:4832
  s_waitcnt lgkmcnt(8)
  v_mfma_f32_16x16x32_bf16 v[28:31], v[100:103], v[112:115], v[28:31]
  v_mfma_f32_16x16x32_bf16 v[64:67], v[100:103], v[116:119], v[64:67]
  ds_read_b64_tr_b16 v[96:97], v12 offset:256
  ds_read_b64_tr_b16 v[98:99], v12 offset:4864
  s_waitcnt lgkmcnt(8)
  v_mfma_f32_16x16x32_bf16 v[32:35], v[104:107], v[112:115], v[32:35]
  v_mfma_f32_16x16x32_bf16 v[68:71], v[104:107], v[116:119], v[68:71]
  s_waitcnt lgkmcnt(6)
  v_mfma_f32_16x16x32_bf16 v[36:39], v[108:111], v[112:115], v[36:39]
  v_mfma_f32_16x16x32_bf16 v[72:75], v[108:111], v[116:119], v[72:75]
  v_add_u32 v11, 0x4000, v11
  v_add_u32 v12, 0x4800, v12
  ds_read_b128 v[120:123], v11 offset:0
  ds_read_b64_tr_b16 v[100:101], v12 offset:0
  ds_read_b64_tr_b16 v[102:103], v12 offset:4608
  ds_read_b128 v[124:127], v11 offset:2048
  ds_read_b64_tr_b16 v[104:105], v12 offset:32
  ds_read_b64_tr_b16 v[106:107], v12 offset:4640
  s_waitcnt lgkmcnt(10)
  v_mfma_f32_16x16x32_bf16 v[40:43], v[88:91], v[112:115], v[40:43]
  v_mfma_f32_16x16x32_bf16 v[76:79], v[88:91], v[116:119], v[76:79]
  ds_read_b64_tr_b16 v[108:109], v12 offset:64
  ds_read_b64_tr_b16 v[110:111], v12 offset:4672
  s_waitcnt lgkmcnt(10)
  v_mfma_f32_16x16x32_bf16 v[44:47], v[92:95], v[112:115], v[44:47]
  v_mfma_f32_16x16x32_bf16 v[80:83], v[92:95], v[116:119], v[80:83]
  ds_read_b64_tr_b16 v[88:89], v12 offset:96
  ds_read_b64_tr_b16 v[90:91], v12 offset:4704
  s_waitcnt lgkmcnt(10)
  v_mfma_f32_16x16x32_bf16 v[48:51], v[96:99], v[112:115], v[48:51]
  v_mfma_f32_16x16x32_bf16 v[84:87], v[96:99], v[116:119], v[84:87]
  ds_read_b64_tr_b16 v[92:93], v12 offset:128
  ds_read_b64_tr_b16 v[94:95], v12 offset:4736
  s_waitcnt lgkmcnt(9)
  v_mfma_f32_16x16x32_bf16 v[16:19], v[100:103], v[120:123], v[16:19]
  s_waitcnt lgkmcnt(8)
  v_mfma_f32_16x16x32_bf16 v[52:55], v[100:103], v[124:127], v[52:55]
  ds_read_b64_tr_b16 v[96:97], v12 offset:160
  ds_read_b64_tr_b16 v[98:99], v12 offset:4768
  s_waitcnt lgkmcnt(8)
  v_mfma_f32_16x16x32_bf16 v[20:23], v[104:107], v[120:123], v[20:23]
  v_mfma_f32_16x16x32_bf16 v[56:59], v[104:107], v[124:127], v[56:59]
  ds_read_b64_tr_b16 v[100:101], v12 offset:192
  ds_read_b64_tr_b16 v[102:103], v12 offset:4800
  s_waitcnt lgkmcnt(8)
  v_mfma_f32_16x16x32_bf16 v[24:27], v[108:111], v[120:123], v[24:27]
  v_mfma_f32_16x16x32_bf16 v[60:63], v[108:111], v[124:127], v[60:63]
  ds_read_b64_tr_b16 v[104:105], v12 offset:224
  ds_read_b64_tr_b16 v[106:107], v12 offset:4832
  s_waitcnt lgkmcnt(8)
  v_mfma_f32_16x16x32_bf16 v[28:31], v[88:91], v[120:123], v[28:31]
  v_mfma_f32_16x16x32_bf16 v[64:67], v[88:91], v[124:127], v[64:67]
  ds_read_b64_tr_b16 v[108:109], v12 offset:256
  ds_read_b64_tr_b16 v[110:111], v12 offset:4864
  s_waitcnt lgkmcnt(8)
  v_mfma_f32_16x16x32_bf16 v[32:35], v[92:95], v[120:123], v[32:35]
  v_mfma_f32_16x16x32_bf16 v[68:71], v[92:95], v[124:127], v[68:71]
  s_waitcnt lgkmcnt(6)
  v_mfma_f32_16x16x32_bf16 v[36:39], v[96:99], v[120:123], v[36:39]
  v_mfma_f32_16x16x32_bf16 v[72:75], v[96:99], v[124:127], v[72:75]
  s_sub_u32 s33, s33, 1
  s_cmp_lg_u32 s33, 0
  s_cbranch_scc1 oproj_kernel_loop1
  s_waitcnt vmcnt(0) lgkmcnt(0)
  s_barrier
  v_add_u32 v11, 0x4000, v11
  v_add_u32 v12, 0x4800, v12
  ds_read_b128 v[112:115], v11 offset:0
  ds_read_b64_tr_b16 v[88:89], v12 offset:0
  ds_read_b64_tr_b16 v[90:91], v12 offset:4608
  ds_read_b128 v[116:119], v11 offset:2048
  ds_read_b64_tr_b16 v[92:93], v12 offset:32
  ds_read_b64_tr_b16 v[94:95], v12 offset:4640
  v_mfma_f32_16x16x32_bf16 v[40:43], v[100:103], v[120:123], v[40:43]
  v_mfma_f32_16x16x32_bf16 v[76:79], v[100:103], v[124:127], v[76:79]
  ds_read_b64_tr_b16 v[96:97], v12 offset:64
  ds_read_b64_tr_b16 v[98:99], v12 offset:4672
  v_mfma_f32_16x16x32_bf16 v[44:47], v[104:107], v[120:123], v[44:47]
  v_mfma_f32_16x16x32_bf16 v[80:83], v[104:107], v[124:127], v[80:83]
  ds_read_b64_tr_b16 v[100:101], v12 offset:96
  ds_read_b64_tr_b16 v[102:103], v12 offset:4704
  v_mfma_f32_16x16x32_bf16 v[48:51], v[108:111], v[120:123], v[48:51]
  v_mfma_f32_16x16x32_bf16 v[84:87], v[108:111], v[124:127], v[84:87]
  ds_read_b64_tr_b16 v[104:105], v12 offset:128
  ds_read_b64_tr_b16 v[106:107], v12 offset:4736
  s_waitcnt lgkmcnt(9)
  v_mfma_f32_16x16x32_bf16 v[16:19], v[88:91], v[112:115], v[16:19]
  s_waitcnt lgkmcnt(8)
  v_mfma_f32_16x16x32_bf16 v[52:55], v[88:91], v[116:119], v[52:55]
  ds_read_b64_tr_b16 v[108:109], v12 offset:160
  ds_read_b64_tr_b16 v[110:111], v12 offset:4768
  s_waitcnt lgkmcnt(8)
  v_mfma_f32_16x16x32_bf16 v[20:23], v[92:95], v[112:115], v[20:23]
  v_mfma_f32_16x16x32_bf16 v[56:59], v[92:95], v[116:119], v[56:59]
  ds_read_b64_tr_b16 v[88:89], v12 offset:192
  ds_read_b64_tr_b16 v[90:91], v12 offset:4800
  s_waitcnt lgkmcnt(8)
  v_mfma_f32_16x16x32_bf16 v[24:27], v[96:99], v[112:115], v[24:27]
  v_mfma_f32_16x16x32_bf16 v[60:63], v[96:99], v[116:119], v[60:63]
  ds_read_b64_tr_b16 v[92:93], v12 offset:224
  ds_read_b64_tr_b16 v[94:95], v12 offset:4832
  s_waitcnt lgkmcnt(8)
  v_mfma_f32_16x16x32_bf16 v[28:31], v[100:103], v[112:115], v[28:31]
  v_mfma_f32_16x16x32_bf16 v[64:67], v[100:103], v[116:119], v[64:67]
  ds_read_b64_tr_b16 v[96:97], v12 offset:256
  ds_read_b64_tr_b16 v[98:99], v12 offset:4864
  s_waitcnt lgkmcnt(8)
  v_mfma_f32_16x16x32_bf16 v[32:35], v[104:107], v[112:115], v[32:35]
  v_mfma_f32_16x16x32_bf16 v[68:71], v[104:107], v[116:119], v[68:71]
  s_waitcnt lgkmcnt(6)
  v_mfma_f32_16x16x32_bf16 v[36:39], v[108:111], v[112:115], v[36:39]
  v_mfma_f32_16x16x32_bf16 v[72:75], v[108:111], v[116:119], v[72:75]
  v_add_u32 v11, 0x4000, v11
  v_add_u32 v12, 0x4800, v12
  ds_read_b128 v[120:123], v11 offset:0
  ds_read_b64_tr_b16 v[100:101], v12 offset:0
  ds_read_b64_tr_b16 v[102:103], v12 offset:4608
  ds_read_b128 v[124:127], v11 offset:2048
  ds_read_b64_tr_b16 v[104:105], v12 offset:32
  ds_read_b64_tr_b16 v[106:107], v12 offset:4640
  s_waitcnt lgkmcnt(10)
  v_mfma_f32_16x16x32_bf16 v[40:43], v[88:91], v[112:115], v[40:43]
  v_mfma_f32_16x16x32_bf16 v[76:79], v[88:91], v[116:119], v[76:79]
  ds_read_b64_tr_b16 v[108:109], v12 offset:64
  ds_read_b64_tr_b16 v[110:111], v12 offset:4672
  s_waitcnt lgkmcnt(10)
  v_mfma_f32_16x16x32_bf16 v[44:47], v[92:95], v[112:115], v[44:47]
  v_mfma_f32_16x16x32_bf16 v[80:83], v[92:95], v[116:119], v[80:83]
  ds_read_b64_tr_b16 v[88:89], v12 offset:96
  ds_read_b64_tr_b16 v[90:91], v12 offset:4704
  s_waitcnt lgkmcnt(10)
  v_mfma_f32_16x16x32_bf16 v[48:51], v[96:99], v[112:115], v[48:51]
  v_mfma_f32_16x16x32_bf16 v[84:87], v[96:99], v[116:119], v[84:87]
  ds_read_b64_tr_b16 v[92:93], v12 offset:128
  ds_read_b64_tr_b16 v[94:95], v12 offset:4736
  s_waitcnt lgkmcnt(9)
  v_mfma_f32_16x16x32_bf16 v[16:19], v[100:103], v[120:123], v[16:19]
  s_waitcnt lgkmcnt(8)
  v_mfma_f32_16x16x32_bf16 v[52:55], v[100:103], v[124:127], v[52:55]
  ds_read_b64_tr_b16 v[96:97], v12 offset:160
  ds_read_b64_tr_b16 v[98:99], v12 offset:4768
  s_waitcnt lgkmcnt(8)
  v_mfma_f32_16x16x32_bf16 v[20:23], v[104:107], v[120:123], v[20:23]
  v_mfma_f32_16x16x32_bf16 v[56:59], v[104:107], v[124:127], v[56:59]
  ds_read_b64_tr_b16 v[100:101], v12 offset:192
  ds_read_b64_tr_b16 v[102:103], v12 offset:4800
  s_waitcnt lgkmcnt(8)
  v_mfma_f32_16x16x32_bf16 v[24:27], v[108:111], v[120:123], v[24:27]
  v_mfma_f32_16x16x32_bf16 v[60:63], v[108:111], v[124:127], v[60:63]
  ds_read_b64_tr_b16 v[104:105], v12 offset:224
  ds_read_b64_tr_b16 v[106:107], v12 offset:4832
  s_waitcnt lgkmcnt(8)
  v_mfma_f32_16x16x32_bf16 v[28:31], v[88:91], v[120:123], v[28:31]
  v_mfma_f32_16x16x32_bf16 v[64:67], v[88:91], v[124:127], v[64:67]
  ds_read_b64_tr_b16 v[108:109], v12 offset:256
  ds_read_b64_tr_b16 v[110:111], v12 offset:4864
  s_waitcnt lgkmcnt(8)
  v_mfma_f32_16x16x32_bf16 v[32:35], v[92:95], v[120:123], v[32:35]
  v_mfma_f32_16x16x32_bf16 v[68:71], v[92:95], v[124:127], v[68:71]
  s_waitcnt lgkmcnt(6)
  v_mfma_f32_16x16x32_bf16 v[36:39], v[96:99], v[120:123], v[36:39]
  v_mfma_f32_16x16x32_bf16 v[72:75], v[96:99], v[124:127], v[72:75]
  s_waitcnt lgkmcnt(4)
  v_mfma_f32_16x16x32_bf16 v[40:43], v[100:103], v[120:123], v[40:43]
  v_mfma_f32_16x16x32_bf16 v[76:79], v[100:103], v[124:127], v[76:79]
  s_waitcnt lgkmcnt(2)
  v_mfma_f32_16x16x32_bf16 v[44:47], v[104:107], v[120:123], v[44:47]
  v_mfma_f32_16x16x32_bf16 v[80:83], v[104:107], v[124:127], v[80:83]
  s_waitcnt lgkmcnt(0)
  v_mfma_f32_16x16x32_bf16 v[48:51], v[108:111], v[120:123], v[48:51]
  v_mfma_f32_16x16x32_bf16 v[84:87], v[108:111], v[124:127], v[84:87]
  s_nop 15
  s_barrier
  s_mul_i32 s28, s20, 9216
  v_lshlrev_b32 v2, 4, v1
  v_add_u32 v3, s28, v2
  s_xor_b32 s28, s20, 4
  s_mul_i32 s28, s28, 9216
  v_add_u32 v4, s28, v2
  s_cmp_eq_u32 s25, 0
  s_cbranch_scc0 oproj_kernel_kg12
  ds_write_b128 v3, v[52:55] offset:0
  ds_write_b128 v3, v[56:59] offset:1024
  ds_write_b128 v3, v[60:63] offset:2048
  ds_write_b128 v3, v[64:67] offset:3072
  ds_write_b128 v3, v[68:71] offset:4096
  ds_write_b128 v3, v[72:75] offset:5120
  ds_write_b128 v3, v[76:79] offset:6144
  ds_write_b128 v3, v[80:83] offset:7168
  ds_write_b128 v3, v[84:87] offset:8192
  s_waitcnt lgkmcnt(0)
  s_barrier
  ds_read_b128 v[88:91], v4 offset:0
  ds_read_b128 v[92:95], v4 offset:1024
  ds_read_b128 v[96:99], v4 offset:2048
  ds_read_b128 v[100:103], v4 offset:3072
  ds_read_b128 v[104:107], v4 offset:4096
  ds_read_b128 v[108:111], v4 offset:5120
  ds_read_b128 v[112:115], v4 offset:6144
  ds_read_b128 v[116:119], v4 offset:7168
  ds_read_b128 v[120:123], v4 offset:8192
  s_waitcnt lgkmcnt(8)
  v_add_f32 v16, v16, v88
  v_add_f32 v17, v17, v89
  v_add_f32 v18, v18, v90
  v_add_f32 v19, v19, v91
  s_waitcnt lgkmcnt(7)
  v_add_f32 v20, v20, v92
  v_add_f32 v21, v21, v93
  v_add_f32 v22, v22, v94
  v_add_f32 v23, v23, v95
  s_waitcnt lgkmcnt(6)
  v_add_f32 v24, v24, v96
  v_add_f32 v25, v25, v97
  v_add_f32 v26, v26, v98
  v_add_f32 v27, v27, v99
  s_waitcnt lgkmcnt(5)
  v_add_f32 v28, v28, v100
  v_add_f32 v29, v29, v101
  v_add_f32 v30, v30, v102
  v_add_f32 v31, v31, v103
  s_waitcnt lgkmcnt(4)
  v_add_f32 v32, v32, v104
  v_add_f32 v33, v33, v105
  v_add_f32 v34, v34, v106
  v_add_f32 v35, v35, v107
  s_waitcnt lgkmcnt(3)
  v_add_f32 v36, v36, v108
  v_add_f32 v37, v37, v109
  v_add_f32 v38, v38, v110
  v_add_f32 v39, v39, v111
  s_waitcnt lgkmcnt(2)
  v_add_f32 v40, v40, v112
  v_add_f32 v41, v41, v113
  v_add_f32 v42, v42, v114
  v_add_f32 v43, v43, v115
  s_waitcnt lgkmcnt(1)
  v_add_f32 v44, v44, v116
  v_add_f32 v45, v45, v117
  v_add_f32 v46, v46, v118
  v_add_f32 v47, v47, v119
  s_waitcnt lgkmcnt(0)
  v_add_f32 v48, v48, v120
  v_add_f32 v49, v49, v121
  v_add_f32 v50, v50, v122
  v_add_f32 v51, v51, v123
  v_and_b32 v2, 15, v1
  v_mul_u32_u24 v2, 1152, v2
  v_lshl_add_u32 v2, v10, 4, v2
  s_mul_i32 s28, s24, 36864
  v_add_u32 v2, s28, v2
  s_cmp_eq_u32 s26, 0
  s_cbranch_scc0 oproj_kernel_odd4
  s_mov_b32 s28, 0x0
  v_cvt_pk_bf16_f32 v16, v16, v17
  v_cvt_pk_bf16_f32 v17, v18, v19
  v_cvt_pk_bf16_f32 v18, v20, v21
  v_cvt_pk_bf16_f32 v19, v22, v23
  buffer_store_dwordx4 v[16:19], v2, s[12:15], s28 offen offset:0 sc1
  v_cvt_pk_bf16_f32 v24, v24, v25
  v_cvt_pk_bf16_f32 v25, v26, v27
  v_cvt_pk_bf16_f32 v26, v28, v29
  v_cvt_pk_bf16_f32 v27, v30, v31
  buffer_store_dwordx4 v[24:27], v2, s[12:15], s28 offen offset:64 sc1
  v_cvt_pk_bf16_f32 v32, v32, v33
  v_cvt_pk_bf16_f32 v33, v34, v35
  v_cvt_pk_bf16_f32 v34, v36, v37
  v_cvt_pk_bf16_f32 v35, v38, v39
  buffer_store_dwordx4 v[32:35], v2, s[12:15], s28 offen offset:128 sc1
  v_cvt_pk_bf16_f32 v40, v40, v41
  v_cvt_pk_bf16_f32 v41, v42, v43
  v_cvt_pk_bf16_f32 v42, v44, v45
  v_cvt_pk_bf16_f32 v43, v46, v47
  buffer_store_dwordx4 v[40:43], v2, s[12:15], s28 offen offset:192 sc1
  v_cvt_pk_bf16_f32 v48, v48, v49
  v_cvt_pk_bf16_f32 v49, v50, v51
  buffer_store_dwordx2 v[48:49], v2, s[12:15], s28 offen offset:256 sc1
  s_branch oproj_kernel_join5
oproj_kernel_odd4:
  s_mov_b32 s28, 0x0
  v_cvt_pk_bf16_f32 v16, v16, v17
  v_cvt_pk_bf16_f32 v17, v18, v19
  buffer_store_dwordx2 v[16:17], v2, s[12:15], s28 offen offset:8 sc1
  v_cvt_pk_bf16_f32 v20, v20, v21
  v_cvt_pk_bf16_f32 v21, v22, v23
  v_cvt_pk_bf16_f32 v22, v24, v25
  v_cvt_pk_bf16_f32 v23, v26, v27
  buffer_store_dwordx4 v[20:23], v2, s[12:15], s28 offen offset:64 sc1
  v_cvt_pk_bf16_f32 v28, v28, v29
  v_cvt_pk_bf16_f32 v29, v30, v31
  v_cvt_pk_bf16_f32 v30, v32, v33
  v_cvt_pk_bf16_f32 v31, v34, v35
  buffer_store_dwordx4 v[28:31], v2, s[12:15], s28 offen offset:128 sc1
  v_cvt_pk_bf16_f32 v36, v36, v37
  v_cvt_pk_bf16_f32 v37, v38, v39
  v_cvt_pk_bf16_f32 v38, v40, v41
  v_cvt_pk_bf16_f32 v39, v42, v43
  buffer_store_dwordx4 v[36:39], v2, s[12:15], s28 offen offset:192 sc1
  v_cvt_pk_bf16_f32 v44, v44, v45
  v_cvt_pk_bf16_f32 v45, v46, v47
  v_cvt_pk_bf16_f32 v46, v48, v49
  v_cvt_pk_bf16_f32 v47, v50, v51
  buffer_store_dwordx4 v[44:47], v2, s[12:15], s28 offen offset:256 sc1
oproj_kernel_join5:
  s_branch oproj_kernel_end_d
oproj_kernel_kg12:
  ds_write_b128 v3, v[16:19] offset:0
  ds_write_b128 v3, v[20:23] offset:1024
  ds_write_b128 v3, v[24:27] offset:2048
  ds_write_b128 v3, v[28:31] offset:3072
  ds_write_b128 v3, v[32:35] offset:4096
  ds_write_b128 v3, v[36:39] offset:5120
  ds_write_b128 v3, v[40:43] offset:6144
  ds_write_b128 v3, v[44:47] offset:7168
  ds_write_b128 v3, v[48:51] offset:8192
  s_waitcnt lgkmcnt(0)
  s_barrier
  ds_read_b128 v[88:91], v4 offset:0
  ds_read_b128 v[92:95], v4 offset:1024
  ds_read_b128 v[96:99], v4 offset:2048
  ds_read_b128 v[100:103], v4 offset:3072
  ds_read_b128 v[104:107], v4 offset:4096
  ds_read_b128 v[108:111], v4 offset:5120
  ds_read_b128 v[112:115], v4 offset:6144
  ds_read_b128 v[116:119], v4 offset:7168
  ds_read_b128 v[120:123], v4 offset:8192
  s_waitcnt lgkmcnt(8)
  v_add_f32 v52, v52, v88
  v_add_f32 v53, v53, v89
  v_add_f32 v54, v54, v90
  v_add_f32 v55, v55, v91
  s_waitcnt lgkmcnt(7)
  v_add_f32 v56, v56, v92
  v_add_f32 v57, v57, v93
  v_add_f32 v58, v58, v94
  v_add_f32 v59, v59, v95
  s_waitcnt lgkmcnt(6)
  v_add_f32 v60, v60, v96
  v_add_f32 v61, v61, v97
  v_add_f32 v62, v62, v98
  v_add_f32 v63, v63, v99
  s_waitcnt lgkmcnt(5)
  v_add_f32 v64, v64, v100
  v_add_f32 v65, v65, v101
  v_add_f32 v66, v66, v102
  v_add_f32 v67, v67, v103
  s_waitcnt lgkmcnt(4)
  v_add_f32 v68, v68, v104
  v_add_f32 v69, v69, v105
  v_add_f32 v70, v70, v106
  v_add_f32 v71, v71, v107
  s_waitcnt lgkmcnt(3)
  v_add_f32 v72, v72, v108
  v_add_f32 v73, v73, v109
  v_add_f32 v74, v74, v110
  v_add_f32 v75, v75, v111
  s_waitcnt lgkmcnt(2)
  v_add_f32 v76, v76, v112
  v_add_f32 v77, v77, v113
  v_add_f32 v78, v78, v114
  v_add_f32 v79, v79, v115
  s_waitcnt lgkmcnt(1)
  v_add_f32 v80, v80, v116
  v_add_f32 v81, v81, v117
  v_add_f32 v82, v82, v118
  v_add_f32 v83, v83, v119
  s_waitcnt lgkmcnt(0)
  v_add_f32 v84, v84, v120
  v_add_f32 v85, v85, v121
  v_add_f32 v86, v86, v122
  v_add_f32 v87, v87, v123
  v_and_b32 v2, 15, v1
  v_mul_u32_u24 v2, 1152, v2
  v_lshl_add_u32 v2, v10, 4, v2
  s_mul_i32 s28, s24, 36864
  v_add_u32 v2, s28, v2
  s_cmp_eq_u32 s26, 0
  s_cbranch_scc0 oproj_kernel_odd6
  s_mov_b32 s28, 0x4800
  v_cvt_pk_bf16_f32 v52, v52, v53
  v_cvt_pk_bf16_f32 v53, v54, v55
  v_cvt_pk_bf16_f32 v54, v56, v57
  v_cvt_pk_bf16_f32 v55, v58, v59
  buffer_store_dwordx4 v[52:55], v2, s[12:15], s28 offen offset:0 sc1
  v_cvt_pk_bf16_f32 v60, v60, v61
  v_cvt_pk_bf16_f32 v61, v62, v63
  v_cvt_pk_bf16_f32 v62, v64, v65
  v_cvt_pk_bf16_f32 v63, v66, v67
  buffer_store_dwordx4 v[60:63], v2, s[12:15], s28 offen offset:64 sc1
  v_cvt_pk_bf16_f32 v68, v68, v69
  v_cvt_pk_bf16_f32 v69, v70, v71
  v_cvt_pk_bf16_f32 v70, v72, v73
  v_cvt_pk_bf16_f32 v71, v74, v75
  buffer_store_dwordx4 v[68:71], v2, s[12:15], s28 offen offset:128 sc1
  v_cvt_pk_bf16_f32 v76, v76, v77
  v_cvt_pk_bf16_f32 v77, v78, v79
  v_cvt_pk_bf16_f32 v78, v80, v81
  v_cvt_pk_bf16_f32 v79, v82, v83
  buffer_store_dwordx4 v[76:79], v2, s[12:15], s28 offen offset:192 sc1
  v_cvt_pk_bf16_f32 v84, v84, v85
  v_cvt_pk_bf16_f32 v85, v86, v87
  buffer_store_dwordx2 v[84:85], v2, s[12:15], s28 offen offset:256 sc1
  s_branch oproj_kernel_join7
oproj_kernel_odd6:
  s_mov_b32 s28, 0x4800
  v_cvt_pk_bf16_f32 v52, v52, v53
  v_cvt_pk_bf16_f32 v53, v54, v55
  buffer_store_dwordx2 v[52:53], v2, s[12:15], s28 offen offset:8 sc1
  v_cvt_pk_bf16_f32 v56, v56, v57
  v_cvt_pk_bf16_f32 v57, v58, v59
  v_cvt_pk_bf16_f32 v58, v60, v61
  v_cvt_pk_bf16_f32 v59, v62, v63
  buffer_store_dwordx4 v[56:59], v2, s[12:15], s28 offen offset:64 sc1
  v_cvt_pk_bf16_f32 v64, v64, v65
  v_cvt_pk_bf16_f32 v65, v66, v67
  v_cvt_pk_bf16_f32 v66, v68, v69
  v_cvt_pk_bf16_f32 v67, v70, v71
  buffer_store_dwordx4 v[64:67], v2, s[12:15], s28 offen offset:128 sc1
  v_cvt_pk_bf16_f32 v72, v72, v73
  v_cvt_pk_bf16_f32 v73, v74, v75
  v_cvt_pk_bf16_f32 v74, v76, v77
  v_cvt_pk_bf16_f32 v75, v78, v79
  buffer_store_dwordx4 v[72:75], v2, s[12:15], s28 offen offset:192 sc1
  v_cvt_pk_bf16_f32 v80, v80, v81
  v_cvt_pk_bf16_f32 v81, v82, v83
  v_cvt_pk_bf16_f32 v82, v84, v85
  v_cvt_pk_bf16_f32 v83, v86, v87
  buffer_store_dwordx4 v[80:83], v2, s[12:15], s28 offen offset:256 sc1
oproj_kernel_join7:
oproj_kernel_end_d:
oproj_kernel_end:
  s_endpgm
.globl red1_kernel
.p2align 8
.type red1_kernel,@function
red1_kernel:
  s_cmp_ge_u32 s2, 256
  s_cbranch_scc1 red1_kernel_end
  v_lshrrev_b32 v4, 6, v0
  s_load_dwordx2 s[40:41], s[0:1], 104
  s_load_dwordx2 s[42:43], s[0:1], 0
  s_load_dwordx2 s[44:45], s[0:1], 80
  s_load_dwordx2 s[36:37], s[0:1], 88
  v_readfirstlane_b32 s20, v4
  s_lshl_b32 s21, s2, 3
  s_add_u32 s21, s21, s20
  s_mul_i32 s22, s21, 1152
  v_and_b32 v1, 63, v0
  v_cmp_gt_u32 vcc, 36, v1
  s_mov_b64 s[46:47], vcc
  v_add_u32 v4, 0, v1
  v_lshrrev_b32 v5, 2, v4
  v_and_b32 v4, 3, v4
  v_lshlrev_b32 v4, 3, v4
  v_lshl_add_u32 v2, v5, 6, v4
  v_add_u32 v4, 36, v1
  v_lshrrev_b32 v5, 2, v4
  v_and_b32 v4, 3, v4
  v_lshlrev_b32 v4, 3, v4
  v_lshl_add_u32 v3, v5, 6, v4
  v_lshlrev_b32 v1, 4, v1
  s_waitcnt lgkmcnt(0)
  s_sub_u32 s24, 9437184, s22
  s_add_u32 s4, s40, 0x3240000
  s_addc_u32 s5, s41, 0
  s_add_u32 s4, s4, s22
  s_addc_u32 s5, s5, 0
  s_mov_b32 s6, s24
  s_mov_b32 s7, 0x00020000
  s_mov_b32 s8, s42
  s_mov_b32 s9, s43
  s_add_u32 s8, s8, s22
  s_addc_u32 s9, s9, 0
  s_mov_b32 s10, 0x480
  s_mov_b32 s11, 0x00020000
  s_add_u32 s12, s40, 0x5640000
  s_addc_u32 s13, s41, 0
  s_add_u32 s12, s12, s22
  s_addc_u32 s13, s13, 0
  s_mov_b32 s14, 0x480
  s_mov_b32 s15, 0x00020000
  s_add_u32 s16, s40, 0x5880000
  s_addc_u32 s17, s41, 0
  s_add_u32 s16, s16, s22
  s_addc_u32 s17, s17, 0
  s_mov_b32 s18, 0x480
  s_mov_b32 s19, 0x00020000
  s_mov_b64 exec, s[46:47]
  s_mov_b32 s25, 0x0
  buffer_load_dwordx4 v[8:11], v1, s[4:7], s25 offen offset:0
  buffer_load_dwordx4 v[12:15], v1, s[4:7], s25 offen offset:576
  s_mov_b32 s25, 0x240000
  buffer_load_dwordx4 v[16:19], v1, s[4:7], s25 offen offset:0
  buffer_load_dwordx4 v[20:23], v1, s[4:7], s25 offen offset:576
  s_mov_b32 s25, 0x480000
  buffer_load_dwordx4 v[24:27], v1, s[4:7], s25 offen offset:0
  buffer_load_dwordx4 v[28:31], v1, s[4:7], s25 offen offset:576
  s_mov_b32 s25, 0x6c0000
  buffer_load_dwordx4 v[32:35], v1, s[4:7], s25 offen offset:0
  buffer_load_dwordx4 v[36:39], v1, s[4:7], s25 offen offset:576
  buffer_load_dwordx2 v[40:41], v2, s[8:11], 0 offen offset:0
  buffer_load_dwordx2 v[42:43], v2, s[8:11], 0 offen offset:32
  buffer_load_dwordx2 v[44:45], v3, s[8:11], 0 offen offset:0
  buffer_load_dwordx2 v[46:47], v3, s[8:11], 0 offen offset:32
  s_waitcnt vmcnt(10)
  v_lshlrev_b32 v56, 16, v8
  v_and_b32 v57, 0xffff0000, v8
  v_lshlrev_b32 v58, 16, v9
  v_and_b32 v59, 0xffff0000, v9
  v_lshlrev_b32 v60, 16, v10
  v_and_b32 v61, 0xffff0000, v10
  v_lshlrev_b32 v62, 16, v11
  v_and_b32 v63, 0xffff0000, v11
  v_lshlrev_b32 v64, 16, v12
  v_and_b32 v65, 0xffff0000, v12
  v_lshlrev_b32 v66, 16, v13
  v_and_b32 v67, 0xffff0000, v13
  v_lshlrev_b32 v68, 16, v14
  v_and_b32 v69, 0xffff0000, v14
  v_lshlrev_b32 v70, 16, v15
  v_and_b32 v71, 0xffff0000, v15
  s_waitcnt vmcnt(8)
  v_lshlrev_b32 v72, 16, v16
  v_and_b32 v73, 0xffff0000, v16
  v_add_f32 v56, v56, v72
  v_add_f32 v57, v57, v73
  v_lshlrev_b32 v72, 16, v17
  v_and_b32 v73, 0xffff0000, v17
  v_add_f32 v58, v58, v72
  v_add_f32 v59, v59, v73
  v_lshlrev_b32 v72, 16, v18
  v_and_b32 v73, 0xffff0000, v18
  v_add_f32 v60, v60, v72
  v_add_f32 v61, v61, v73
  v_lshlrev_b32 v72, 16, v19
  v_and_b32 v73, 0xffff0000, v19
  v_add_f32 v62, v62, v72
  v_add_f32 v63, v63, v73
  v_lshlrev_b32 v72, 16, v20
  v_and_b32 v73, 0xffff0000, v20
  v_add_f32 v64, v64, v72
  v_add_f32 v65, v65, v73
  v_lshlrev_b32 v72, 16, v21
  v_and_b32 v73, 0xffff0000, v21
  v_add_f32 v66, v66, v72
  v_add_f32 v67, v67, v73
  v_lshlrev_b32 v72, 16, v22
  v_and_b32 v73, 0xffff0000, v22
  v_add_f32 v68, v68, v72
  v_add_f32 v69, v69, v73
  v_lshlrev_b32 v72, 16, v23
  v_and_b32 v73, 0xffff0000, v23
  v_add_f32 v70, v70, v72
  v_add_f32 v71, v71, v73
  s_waitcnt vmcnt(6)
  v_lshlrev_b32 v72, 16, v24
  v_and_b32 v73, 0xffff0000, v24
  v_add_f32 v56, v56, v72
  v_add_f32 v57, v57, v73
  v_lshlrev_b32 v72, 16, v25
  v_and_b32 v73, 0xffff0000, v25
  v_add_f32 v58, v58, v72
  v_add_f32 v59, v59, v73
  v_lshlrev_b32 v72, 16, v26
  v_and_b32 v73, 0xffff0000, v26
  v_add_f32 v60, v60, v72
  v_add_f32 v61, v61, v73
  v_lshlrev_b32 v72, 16, v27
  v_and_b32 v73, 0xffff0000, v27
  v_add_f32 v62, v62, v72
  v_add_f32 v63, v63, v73
  v_lshlrev_b32 v72, 16, v28
  v_and_b32 v73, 0xffff0000, v28
  v_add_f32 v64, v64, v72
  v_add_f32 v65, v65, v73
  v_lshlrev_b32 v72, 16, v29
  v_and_b32 v73, 0xffff0000, v29
  v_add_f32 v66, v66, v72
  v_add_f32 v67, v67, v73
  v_lshlrev_b32 v72, 16, v30
  v_and_b32 v73, 0xffff0000, v30
  v_add_f32 v68, v68, v72
  v_add_f32 v69, v69, v73
  v_lshlrev_b32 v72, 16, v31
  v_and_b32 v73, 0xffff0000, v31
  v_add_f32 v70, v70, v72
  v_add_f32 v71, v71, v73
  s_waitcnt vmcnt(4)
  v_lshlrev_b32 v72, 16, v32
  v_and_b32 v73, 0xffff0000, v32
  v_add_f32 v56, v56, v72
  v_add_f32 v57, v57, v73
  v_lshlrev_b32 v72, 16, v33
  v_and_b32 v73, 0xffff0000, v33
  v_add_f32 v58, v58, v72
  v_add_f32 v59, v59, v73
  v_lshlrev_b32 v72, 16, v34
  v_and_b32 v73, 0xffff0000, v34
  v_add_f32 v60, v60, v72
  v_add_f32 v61, v61, v73
  v_lshlrev_b32 v72, 16, v35
  v_and_b32 v73, 0xffff0000, v35
  v_add_f32 v62, v62, v72
  v_add_f32 v63, v63, v73
  v_lshlrev_b32 v72, 16, v36
  v_and_b32 v73, 0xffff0000, v36
  v_add_f32 v64, v64, v72
  v_add_f32 v65, v65, v73
  v_lshlrev_b32 v72, 16, v37
  v_and_b32 v73, 0xffff0000, v37
  v_add_f32 v66, v66, v72
  v_add_f32 v67, v67, v73
  v_lshlrev_b32 v72, 16, v38
  v_and_b32 v73, 0xffff0000, v38
  v_add_f32 v68, v68, v72
  v_add_f32 v69, v69, v73
  v_lshlrev_b32 v72, 16, v39
  v_and_b32 v73, 0xffff0000, v39
  v_add_f32 v70, v70, v72
  v_add_f32 v71, v71, v73
  s_waitcnt vmcnt(0)
  v_cvt_pk_bf16_f32 v56, v56, v56
  v_and_b32 v56, 0xffff0000, v56
  v_cvt_pk_bf16_f32 v57, v57, v57
  v_and_b32 v57, 0xffff0000, v57
  v_lshlrev_b32 v72, 16, v40
  v_and_b32 v73, 0xffff0000, v40
  v_add_f32 v56, v56, v72
  v_add_f32 v57, v57, v73
  v_cvt_pk_bf16_f32 v40, v56, v57
  v_cvt_pk_bf16_f32 v58, v58, v58
  v_and_b32 v58, 0xffff0000, v58
  v_cvt_pk_bf16_f32 v59, v59, v59
  v_and_b32 v59, 0xffff0000, v59
  v_lshlrev_b32 v72, 16, v41
  v_and_b32 v73, 0xffff0000, v41
  v_add_f32 v58, v58, v72
  v_add_f32 v59, v59, v73
  v_cvt_pk_bf16_f32 v41, v58, v59
  v_cvt_pk_bf16_f32 v60, v60, v60
  v_and_b32 v60, 0xffff0000, v60
  v_cvt_pk_bf16_f32 v61, v61, v61
  v_and_b32 v61, 0xffff0000, v61
  v_lshlrev_b32 v72, 16, v42
  v_and_b32 v73, 0xffff0000, v42
  v_add_f32 v60, v60, v72
  v_add_f32 v61, v61, v73
  v_cvt_pk_bf16_f32 v42, v60, v61
  v_cvt_pk_bf16_f32 v62, v62, v62
  v_and_b32 v62, 0xffff0000, v62
  v_cvt_pk_bf16_f32 v63, v63, v63
  v_and_b32 v63, 0xffff0000, v63
  v_lshlrev_b32 v72, 16, v43
  v_and_b32 v73, 0xffff0000, v43
  v_add_f32 v62, v62, v72
  v_add_f32 v63, v63, v73
  v_cvt_pk_bf16_f32 v43, v62, v63
  v_cvt_pk_bf16_f32 v64, v64, v64
  v_and_b32 v64, 0xffff0000, v64
  v_cvt_pk_bf16_f32 v65, v65, v65
  v_and_b32 v65, 0xffff0000, v65
  v_lshlrev_b32 v72, 16, v44
  v_and_b32 v73, 0xffff0000, v44
  v_add_f32 v64, v64, v72
  v_add_f32 v65, v65, v73
  v_cvt_pk_bf16_f32 v44, v64, v65
  v_cvt_pk_bf16_f32 v66, v66, v66
  v_and_b32 v66, 0xffff0000, v66
  v_cvt_pk_bf16_f32 v67, v67, v67
  v_and_b32 v67, 0xffff0000, v67
  v_lshlrev_b32 v72, 16, v45
  v_and_b32 v73, 0xffff0000, v45
  v_add_f32 v66, v66, v72
  v_add_f32 v67, v67, v73
  v_cvt_pk_bf16_f32 v45, v66, v67
  v_cvt_pk_bf16_f32 v68, v68, v68
  v_and_b32 v68, 0xffff0000, v68
  v_cvt_pk_bf16_f32 v69, v69, v69
  v_and_b32 v69, 0xffff0000, v69
  v_lshlrev_b32 v72, 16, v46
  v_and_b32 v73, 0xffff0000, v46
  v_add_f32 v68, v68, v72
  v_add_f32 v69, v69, v73
  v_cvt_pk_bf16_f32 v46, v68, v69
  v_cvt_pk_bf16_f32 v70, v70, v70
  v_and_b32 v70, 0xffff0000, v70
  v_cvt_pk_bf16_f32 v71, v71, v71
  v_and_b32 v71, 0xffff0000, v71
  v_lshlrev_b32 v72, 16, v47
  v_and_b32 v73, 0xffff0000, v47
  v_add_f32 v70, v70, v72
  v_add_f32 v71, v71, v73
  v_cvt_pk_bf16_f32 v47, v70, v71
  buffer_store_dwordx2 v[40:41], v2, s[12:15], 0 offen offset:0 sc1
  buffer_store_dwordx2 v[42:43], v2, s[12:15], 0 offen offset:32 sc1
  buffer_store_dwordx2 v[44:45], v3, s[12:15], 0 offen offset:0 sc1
  buffer_store_dwordx2 v[46:47], v3, s[12:15], 0 offen offset:32 sc1
  v_lshlrev_b32 v56, 16, v40
  v_and_b32 v57, 0xffff0000, v40
  v_lshlrev_b32 v58, 16, v41
  v_and_b32 v59, 0xffff0000, v41
  v_lshlrev_b32 v60, 16, v42
  v_and_b32 v61, 0xffff0000, v42
  v_lshlrev_b32 v62, 16, v43
  v_and_b32 v63, 0xffff0000, v43
  v_lshlrev_b32 v64, 16, v44
  v_and_b32 v65, 0xffff0000, v44
  v_lshlrev_b32 v66, 16, v45
  v_and_b32 v67, 0xffff0000, v45
  v_lshlrev_b32 v68, 16, v46
  v_and_b32 v69, 0xffff0000, v46
  v_lshlrev_b32 v70, 16, v47
  v_and_b32 v71, 0xffff0000, v47
  s_mov_b64 exec, -1
  v_mov_b32 v74, 0
  s_mov_b64 exec, s[46:47]
  v_add_f32 v74, v74, v56
  v_add_f32 v74, v74, v57
  v_add_f32 v74, v74, v58
  v_add_f32 v74, v74, v59
  v_add_f32 v74, v74, v60
  v_add_f32 v74, v74, v61
  v_add_f32 v74, v74, v62
  v_add_f32 v74, v74, v63
  v_add_f32 v74, v74, v64
  v_add_f32 v74, v74, v65
  v_add_f32 v74, v74, v66
  v_add_f32 v74, v74, v67
  v_add_f32 v74, v74, v68
  v_add_f32 v74, v74, v69
  v_add_f32 v74, v74, v70
  v_add_f32 v74, v74, v71
  s_mov_b64 exec, -1
  s_nop 1
  v_add_f32_dpp v74, v74, v74 quad_perm:[1,0,3,2] row_mask:0xf bank_mask:0xf
  s_nop 1
  v_add_f32_dpp v74, v74, v74 quad_perm:[2,3,0,1] row_mask:0xf bank_mask:0xf
  s_nop 1
  v_add_f32_dpp v74, v74, v74 row_half_mirror row_mask:0xf bank_mask:0xf
  s_nop 1
  v_add_f32_dpp v74, v74, v74 row_mirror row_mask:0xf bank_mask:0xf
  v_mov_b32 v75, v74
  s_nop 1
  v_permlane16_swap_b32 v74, v75
  s_nop 1
  v_add_f32 v74, v74, v75
  v_mov_b32 v75, v74
  s_nop 1
  v_permlane32_swap_b32 v74, v75
  s_nop 1
  v_add_f32 v74, v74, v75
  v_mul_f32 v76, 0x3ae38e39, v74
  v_mov_b32 v74, 0
  s_mov_b64 exec, s[46:47]
  v_sub_f32 v77, v56, v76
  v_fmac_f32 v74, v77, v77
  v_sub_f32 v77, v57, v76
  v_fmac_f32 v74, v77, v77
  v_sub_f32 v77, v58, v76
  v_fmac_f32 v74, v77, v77
  v_sub_f32 v77, v59, v76
  v_fmac_f32 v74, v77, v77
  v_sub_f32 v77, v60, v76
  v_fmac_f32 v74, v77, v77
  v_sub_f32 v77, v61, v76
  v_fmac_f32 v74, v77, v77
  v_sub_f32 v77, v62, v76
  v_fmac_f32 v74, v77, v77
  v_sub_f32 v77, v63, v76
  v_fmac_f32 v74, v77, v77
  v_sub_f32 v77, v64, v76
  v_fmac_f32 v74, v77, v77
  v_sub_f32 v77, v65, v76
  v_fmac_f32 v74, v77, v77
  v_sub_f32 v77, v66, v76
  v_fmac_f32 v74, v77, v77
  v_sub_f32 v77, v67, v76
  v_fmac_f32 v74, v77, v77
  v_sub_f32 v77, v68, v76
  v_fmac_f32 v74, v77, v77
  v_sub_f32 v77, v69, v76
  v_fmac_f32 v74, v77, v77
  v_sub_f32 v77, v70, v76
  v_fmac_f32 v74, v77, v77
  v_sub_f32 v77, v71, v76
  v_fmac_f32 v74, v77, v77
  s_mov_b64 exec, -1
  s_nop 1
  v_add_f32_dpp v74, v74, v74 quad_perm:[1,0,3,2] row_mask:0xf bank_mask:0xf
  s_nop 1
  v_add_f32_dpp v74, v74, v74 quad_perm:[2,3,0,1] row_mask:0xf bank_mask:0xf
  s_nop 1
  v_add_f32_dpp v74, v74, v74 row_half_mirror row_mask:0xf bank_mask:0xf
  s_nop 1
  v_add_f32_dpp v74, v74, v74 row_mirror row_mask:0xf bank_mask:0xf
  v_mov_b32 v75, v74
  s_nop 1
  v_permlane16_swap_b32 v74, v75
  s_nop 1
  v_add_f32 v74, v74, v75
  v_mov_b32 v75, v74
  s_nop 1
  v_permlane32_swap_b32 v74, v75
  s_nop 1
  v_add_f32 v74, v74, v75
  v_mul_f32 v74, 0x3ae38e39, v74
  v_cvt_pk_bf16_f32 v74, v74, v74
  v_and_b32 v74, 0xffff0000, v74
  v_cvt_pk_bf16_f32 v76, v76, v76
  v_and_b32 v76, 0xffff0000, v76
  v_add_f32 v74, 0x3727c5ac, v74
  v_cvt_pk_bf16_f32 v74, v74, v74
  v_and_b32 v74, 0xffff0000, v74
  v_sqrt_f32 v74, v74
  s_nop 0
  v_cvt_pk_bf16_f32 v74, v74, v74
  v_and_b32 v74, 0xffff0000, v74
  v_rcp_f32 v74, v74
  s_mov_b64 exec, s[46:47]
  v_sub_f32 v56, v56, v76
  v_cvt_pk_bf16_f32 v56, v56, v56
  v_and_b32 v56, 0xffff0000, v56
  v_mul_f32 v56, v56, v74
  v_sub_f32 v57, v57, v76
  v_cvt_pk_bf16_f32 v57, v57, v57
  v_and_b32 v57, 0xffff0000, v57
  v_mul_f32 v57, v57, v74
  v_sub_f32 v58, v58, v76
  v_cvt_pk_bf16_f32 v58, v58, v58
  v_and_b32 v58, 0xffff0000, v58
  v_mul_f32 v58, v58, v74
  v_sub_f32 v59, v59, v76
  v_cvt_pk_bf16_f32 v59, v59, v59
  v_and_b32 v59, 0xffff0000, v59
  v_mul_f32 v59, v59, v74
  v_sub_f32 v60, v60, v76
  v_cvt_pk_bf16_f32 v60, v60, v60
  v_and_b32 v60, 0xffff0000, v60
  v_mul_f32 v60, v60, v74
  v_sub_f32 v61, v61, v76
  v_cvt_pk_bf16_f32 v61, v61, v61
  v_and_b32 v61, 0xffff0000, v61
  v_mul_f32 v61, v61, v74
  v_sub_f32 v62, v62, v76
  v_cvt_pk_bf16_f32 v62, v62, v62
  v_and_b32 v62, 0xffff0000, v62
  v_mul_f32 v62, v62, v74
  v_sub_f32 v63, v63, v76
  v_cvt_pk_bf16_f32 v63, v63, v63
  v_and_b32 v63, 0xffff0000, v63
  v_mul_f32 v63, v63, v74
  v_sub_f32 v64, v64, v76
  v_cvt_pk_bf16_f32 v64, v64, v64
  v_and_b32 v64, 0xffff0000, v64
  v_mul_f32 v64, v64, v74
  v_sub_f32 v65, v65, v76
  v_cvt_pk_bf16_f32 v65, v65, v65
  v_and_b32 v65, 0xffff0000, v65
  v_mul_f32 v65, v65, v74
  v_sub_f32 v66, v66, v76
  v_cvt_pk_bf16_f32 v66, v66, v66
  v_and_b32 v66, 0xffff0000, v66
  v_mul_f32 v66, v66, v74
  v_sub_f32 v67, v67, v76
  v_cvt_pk_bf16_f32 v67, v67, v67
  v_and_b32 v67, 0xffff0000, v67
  v_mul_f32 v67, v67, v74
  v_sub_f32 v68, v68, v76
  v_cvt_pk_bf16_f32 v68, v68, v68
  v_and_b32 v68, 0xffff0000, v68
  v_mul_f32 v68, v68, v74
  v_sub_f32 v69, v69, v76
  v_cvt_pk_bf16_f32 v69, v69, v69
  v_and_b32 v69, 0xffff0000, v69
  v_mul_f32 v69, v69, v74
  v_sub_f32 v70, v70, v76
  v_cvt_pk_bf16_f32 v70, v70, v70
  v_and_b32 v70, 0xffff0000, v70
  v_mul_f32 v70, v70, v74
  v_sub_f32 v71, v71, v76
  v_cvt_pk_bf16_f32 v71, v71, v71
  v_and_b32 v71, 0xffff0000, v71
  v_mul_f32 v71, v71, v74
  v_cvt_pk_bf16_f32 v48, v56, v57
  v_cvt_pk_bf16_f32 v49, v58, v59
  v_cvt_pk_bf16_f32 v50, v60, v61
  v_cvt_pk_bf16_f32 v51, v62, v63
  v_cvt_pk_bf16_f32 v52, v64, v65
  v_cvt_pk_bf16_f32 v53, v66, v67
  v_cvt_pk_bf16_f32 v54, v68, v69
  v_cvt_pk_bf16_f32 v55, v70, v71
  buffer_store_dwordx2 v[48:49], v2, s[16:19], 0 offen offset:0 sc1
  buffer_store_dwordx2 v[50:51], v2, s[16:19], 0 offen offset:32 sc1
  buffer_store_dwordx2 v[52:53], v3, s[16:19], 0 offen offset:0 sc1
  buffer_store_dwordx2 v[54:55], v3, s[16:19], 0 offen offset:32 sc1
red1_kernel_end:
  s_endpgm
.globl ffn1_kernel
.p2align 8
.type ffn1_kernel,@function
ffn1_kernel:
  s_cmp_ge_u32 s2, 256
  s_cbranch_scc1 ffn1_kernel_end
  v_and_b32 v1, 63, v0
  v_lshrrev_b32 v2, 6, v0
  s_nop 0
  v_readfirstlane_b32 s20, v2
  s_load_dwordx4 s[36:39], s[0:1], 56
  s_load_dwordx2 s[40:41], s[0:1], 104
  s_and_b32 s44, s2, 7
  s_lshr_b32 s45, s2, 3
  s_and_b32 s46, s45, 3
  s_lshl_b32 s44, s44, 2
  s_add_u32 s44, s44, s46
  s_lshr_b32 s45, s45, 2
  s_and_b32 s26, s44, 1
  s_waitcnt lgkmcnt(0)
  s_mul_i32 s46, s45, 294912
  s_sub_u32 s47, 2359296, s46
  s_add_u32 s4, s40, 0x5880000
  s_addc_u32 s5, s41, 0
  s_add_u32 s4, s4, s46
  s_addc_u32 s5, s5, 0
  s_mov_b32 s6, s47
  s_mov_b32 s7, 0x00020000
  s_mul_i32 s46, s44, 288
  s_sub_u32 s47, 5308416, s46
  s_mov_b32 s8, s36
  s_mov_b32 s9, s37
  s_add_u32 s8, s8, s46
  s_addc_u32 s9, s9, 0
  s_mov_b32 s10, s47
  s_mov_b32 s11, 0x00020000
  s_sub_u32 s47, 9216, s46
  s_mov_b32 s16, s38
  s_mov_b32 s17, s39
  s_add_u32 s16, s16, s46
  s_addc_u32 s17, s17, 0
  s_mov_b32 s18, s47
  s_mov_b32 s19, 0x00020000
  s_and_b32 s46, s46, 0xffffffc0
  s_mul_i32 s47, s45, 2359296
  s_add_u32 s46, s46, s47
  s_sub_u32 s47, 18874368, s46
  s_add_u32 s12, s40, 0x5ac0000
  s_addc_u32 s13, s41, 0
  s_add_u32 s12, s12, s46
  s_addc_u32 s13, s13, 0
  s_mov_b32 s14, s47
  s_mov_b32 s15, 0x00020000
  s_lshl_b32 s21, s20, 10
  s_and_b32 s22, s20, 0
  s_lshr_b32 s23, s20, 0
  s_and_b32 s24, s23, 7
  s_lshr_b32 s25, s23, 3
  s_and_b32 s28, s20, 1
  s_lshl_b32 s28, s28, 2
  v_lshrrev_b32 v2, 4, v1
  v_add_u32 v2, s28, v2
  v_xor_b32 v2, v2, v1
  v_and_b32 v2, 7, v2
  v_lshlrev_b32 v2, 4, v2
  v_lshrrev_b32 v3, 3, v1
  s_lshl_b32 s28, s20, 3
  v_add_u32 v3, s28, v3
  s_mov_b32 s28, 1152
  v_mul_lo_u32 v3, v3, s28
  v_add_u32 v5, v3, v2
  v_add_u32 v6, 0x12000, v5
  v_add_u32 v7, 0x24000, v5
  v_add_u32 v8, 0x36000, v5
  s_mov_b32 s29, 9216
  s_lshl_b32 s28, s20, 6
  s_add_u32 s28, s28, 0
  v_add_u32 v2, s28, v1
  v_mul_u32_u24 v3, 3641, v2
  v_lshrrev_b32 v3, 16, v3
  v_mul_u32_u24 v4, 18, v3
  v_sub_u32 v2, v2, v4
  v_lshlrev_b32 v2, 4, v2
  v_lshrrev_b32 v4, 1, v3
  v_and_b32 v4, 4, v4
  v_xor_b32 v3, v3, v4
  v_mul_lo_u32 v3, v3, s29
  v_add_u32 v9, v3, v2
  s_lshl_b32 s28, s20, 6
  s_add_u32 s28, s28, 512
  v_add_u32 v2, s28, v1
  v_mul_u32_u24 v3, 3641, v2
  v_lshrrev_b32 v3, 16, v3
  v_mul_u32_u24 v4, 18, v3
  v_sub_u32 v2, v2, v4
  v_lshlrev_b32 v2, 4, v2
  v_lshrrev_b32 v4, 1, v3
  v_and_b32 v4, 4, v4
  v_xor_b32 v3, v3, v4
  v_mul_lo_u32 v3, v3, s29
  v_add_u32 v10, v3, v2
  s_lshl_b32 s28, s20, 6
  s_add_u32 s28, s28, 1024
  v_add_u32 v2, s28, v1
  v_mul_u32_u24 v3, 3641, v2
  v_lshrrev_b32 v3, 16, v3
  v_mul_u32_u24 v4, 18, v3
  v_sub_u32 v2, v2, v4
  v_lshlrev_b32 v2, 4, v2
  v_lshrrev_b32 v4, 1, v3
  v_and_b32 v4, 4, v4
  v_xor_b32 v3, v3, v4
  v_mul_lo_u32 v3, v3, s29
  v_add_u32 v11, v3, v2
  s_mov_b32 s30, 0
  s_mov_b32 s31, 0
  v_lshrrev_b32 v12, 4, v1
  v_and_b32 v2, 15, v1
  v_lshrrev_b32 v3, 1, v2
  v_xor_b32 v3, v3, v12
  v_lshlrev_b32 v3, 4, v3
  s_mul_i32 s28, s24, 4096
  v_lshl_add_u32 v3, v2, 7, v3
  v_add_u32 v13, s28, v3
  v_xor_b32 v14, 64, v13
  v_bfe_u32 v2, v1, 2, 2
  v_and_b32 v3, 3, v1
  v_lshlrev_b32 v3, 3, v3
  v_and_b32 v4, 1, v12
  v_lshl_add_u32 v4, v4, 2, v2
  v_lshl_add_u32 v4, v12, 3, v4
  v_mul_u32_u24 v2, 288, v4
  v_add_u32 v15, v2, v3
  v_xor_b32 v4, 4, v4
  v_mul_u32_u24 v2, 288, v4
  v_add_u32 v16, v2, v3
  s_mov_b32 s28, 0x18000
  v_add_u32 v15, s28, v15
  v_add_u32 v16, s28, v16
  s_add_u32 m0, s21, 0x0
  s_nop 0
  buffer_load_dwordx4 v5, s[4:7], s30 offen lds
  s_add_u32 m0, s21, 0x2000
  s_nop 0
  buffer_load_dwordx4 v6, s[4:7], s30 offen lds
  s_add_u32 m0, s21, 0x4000
  s_nop 0
  buffer_load_dwordx4 v7, s[4:7], s30 offen lds
  s_add_u32 m0, s21, 0x6000
  s_nop 0
  buffer_load_dwordx4 v8, s[4:7], s30 offen lds
  s_add_u32 s30, s30, 128
  s_cmp_lt_u32 s20, 2
  s_cbranch_scc0 1f
  s_add_u32 m0, s21, 0x1c000
  s_nop 0
  buffer_load_dwordx4 v11, s[8:11], s31 offen lds
1:
  s_add_u32 m0, s21, 0x18000
  s_nop 0
  buffer_load_dwordx4 v9, s[8:11], s31 offen lds
  s_add_u32 m0, s21, 0x1a000
  s_nop 0
  buffer_load_dwordx4 v10, s[8:11], s31 offen lds
  s_add_u32 s31, s31, 0x90000
  s_add_u32 m0, s21, 0x8000
  s_nop 0
  buffer_load_dwordx4 v5, s[4:7], s30 offen lds
  s_add_u32 m0, s21, 0xa000
  s_nop 0
  buffer_load_dwordx4 v6, s[4:7], s30 offen lds
  s_add_u32 m0, s21, 0xc000
  s_nop 0
  buffer_load_dwordx4 v7, s[4:7], s30 offen lds
  s_add_u32 m0, s21, 0xe000
  s_nop 0
  buffer_load_dwordx4 v8, s[4:7], s30 offen lds
  s_add_u32 s30, s30, 128
  s_cmp_lt_u32 s20, 2
  s_cbranch_scc0 1f
  s_add_u32 m0, s21, 0x20800
  s_nop 0
  buffer_load_dwordx4 v11, s[8:11], s31 offen lds
1:
  s_add_u32 m0, s21, 0x1c800
  s_nop 0
  buffer_load_dwordx4 v9, s[8:11], s31 offen lds
  s_add_u32 m0, s21, 0x1e800
  s_nop 0
  buffer_load_dwordx4 v10, s[8:11], s31 offen lds
  s_add_u32 s31, s31, 0x90000
  s_add_u32 m0, s21, 0x10000
  s_nop 0
  buffer_load_dwordx4 v5, s[4:7], s30 offen lds
  s_add_u32 m0, s21, 0x12000
  s_nop 0
  buffer_load_dwordx4 v6, s[4:7], s30 offen lds
  s_add_u32 m0, s21, 0x14000
  s_nop 0
  buffer_load_dwordx4 v7, s[4:7], s30 offen lds
  s_add_u32 m0, s21, 0x16000
  s_nop 0
  buffer_load_dwordx4 v8, s[4:7], s30 offen lds
  s_add_u32 s30, s30, 128
  s_cmp_lt_u32 s20, 2
  s_cbranch_scc0 1f
  s_add_u32 m0, s21, 0x25000
  s_nop 0
  buffer_load_dwordx4 v11, s[8:11], s31 offen lds
1:
  s_add_u32 m0, s21, 0x21000
  s_nop 0
  buffer_load_dwordx4 v9, s[8:11], s31 offen lds
  s_add_u32 m0, s21, 0x23000
  s_nop 0
  buffer_load_dwordx4 v10, s[8:11], s31 offen lds
  s_add_u32 s31, s31, 0x90000
  s_waitcnt vmcnt(12)
  s_barrier
  v_bfe_u32 v36, v0, 4, 2
  v_lshlrev_b32 v36, 3, v36
  buffer_load_dwordx2 v[18:19], v36, s[16:19], 0 offen offset:0
  buffer_load_dwordx2 v[20:21], v36, s[16:19], 0 offen offset:32
  buffer_load_dwordx2 v[22:23], v36, s[16:19], 0 offen offset:64
  buffer_load_dwordx2 v[24:25], v36, s[16:19], 0 offen offset:96
  buffer_load_dwordx2 v[26:27], v36, s[16:19], 0 offen offset:128
  buffer_load_dwordx2 v[28:29], v36, s[16:19], 0 offen offset:160
  buffer_load_dwordx2 v[30:31], v36, s[16:19], 0 offen offset:192
  buffer_load_dwordx2 v[32:33], v36, s[16:19], 0 offen offset:224
  buffer_load_dwordx2 v[34:35], v36, s[16:19], 0 offen offset:256
  ds_read_b128 v[136:139], v13 offset:0
  ds_read_b64_tr_b16 v[112:113], v15 offset:0
  ds_read_b64_tr_b16 v[114:115], v16 offset:0
  ds_read_b128 v[140:143], v13 offset:2048
  ds_read_b64_tr_b16 v[116:117], v15 offset:32
  ds_read_b64_tr_b16 v[118:119], v16 offset:32
  ds_read_b64_tr_b16 v[120:121], v15 offset:64
  ds_read_b64_tr_b16 v[122:123], v16 offset:64
  ds_read_b64_tr_b16 v[124:125], v15 offset:96
  ds_read_b64_tr_b16 v[126:127], v16 offset:96
  ds_read_b64_tr_b16 v[128:129], v15 offset:128
  ds_read_b64_tr_b16 v[130:131], v16 offset:128
  s_waitcnt lgkmcnt(9)
  v_mfma_f32_16x16x32_bf16 v[40:43], v[112:115], v[136:139], 0
  ds_read_b128 v[144:147], v14 offset:0
  s_waitcnt lgkmcnt(9)
  v_mfma_f32_16x16x32_bf16 v[76:79], v[112:115], v[140:143], 0
  ds_read_b64_tr_b16 v[132:133], v15 offset:160
  ds_read_b64_tr_b16 v[134:135], v16 offset:160
  s_waitcnt lgkmcnt(9)
  v_mfma_f32_16x16x32_bf16 v[44:47], v[116:119], v[136:139], 0
  v_mfma_f32_16x16x32_bf16 v[80:83], v[116:119], v[140:143], 0
  ds_read_b64_tr_b16 v[112:113], v15 offset:192
  ds_read_b64_tr_b16 v[114:115], v16 offset:192
  s_waitcnt lgkmcnt(9)
  v_mfma_f32_16x16x32_bf16 v[48:51], v[120:123], v[136:139], 0
  v_mfma_f32_16x16x32_bf16 v[84:87], v[120:123], v[140:143], 0
  ds_read_b64_tr_b16 v[116:117], v15 offset:224
  ds_read_b64_tr_b16 v[118:119], v16 offset:224
  s_waitcnt lgkmcnt(9)
  v_mfma_f32_16x16x32_bf16 v[52:55], v[124:127], v[136:139], 0
  ds_read_b128 v[148:151], v14 offset:2048
  v_mfma_f32_16x16x32_bf16 v[88:91], v[124:127], v[140:143], 0
  ds_read_b64_tr_b16 v[120:121], v15 offset:256
  ds_read_b64_tr_b16 v[122:123], v16 offset:256
  s_waitcnt lgkmcnt(10)
  v_mfma_f32_16x16x32_bf16 v[56:59], v[128:131], v[136:139], 0
  v_mfma_f32_16x16x32_bf16 v[92:95], v[128:131], v[140:143], 0
  ds_read_b64_tr_b16 v[124:125], v15 offset:9216
  ds_read_b64_tr_b16 v[126:127], v16 offset:9216
  s_waitcnt lgkmcnt(9)
  v_mfma_f32_16x16x32_bf16 v[60:63], v[132:135], v[136:139], 0
  v_mfma_f32_16x16x32_bf16 v[96:99], v[132:135], v[140:143], 0
  ds_read_b64_tr_b16 v[128:129], v15 offset:9248
  ds_read_b64_tr_b16 v[130:131], v16 offset:9248
  s_waitcnt lgkmcnt(9)
  v_mfma_f32_16x16x32_bf16 v[64:67], v[112:115], v[136:139], 0
  v_mfma_f32_16x16x32_bf16 v[100:103], v[112:115], v[140:143], 0
  ds_read_b64_tr_b16 v[132:133], v15 offset:9280
  ds_read_b64_tr_b16 v[134:135], v16 offset:9280
  s_waitcnt lgkmcnt(9)
  v_mfma_f32_16x16x32_bf16 v[68:71], v[116:119], v[136:139], 0
  v_mfma_f32_16x16x32_bf16 v[104:107], v[116:119], v[140:143], 0
  ds_read_b64_tr_b16 v[112:113], v15 offset:9312
  ds_read_b64_tr_b16 v[114:115], v16 offset:9312
  s_waitcnt lgkmcnt(8)
  v_mfma_f32_16x16x32_bf16 v[72:75], v[120:123], v[136:139], 0
  v_mfma_f32_16x16x32_bf16 v[108:111], v[120:123], v[140:143], 0
  ds_read_b64_tr_b16 v[116:117], v15 offset:9344
  ds_read_b64_tr_b16 v[118:119], v16 offset:9344
  s_waitcnt lgkmcnt(8)
  v_mfma_f32_16x16x32_bf16 v[40:43], v[124:127], v[144:147], v[40:43]
  v_mfma_f32_16x16x32_bf16 v[76:79], v[124:127], v[148:151], v[76:79]
  ds_read_b64_tr_b16 v[120:121], v15 offset:9376
  ds_read_b64_tr_b16 v[122:123], v16 offset:9376
  s_waitcnt lgkmcnt(8)
  v_mfma_f32_16x16x32_bf16 v[44:47], v[128:131], v[144:147], v[44:47]
  v_mfma_f32_16x16x32_bf16 v[80:83], v[128:131], v[148:151], v[80:83]
  ds_read_b64_tr_b16 v[124:125], v15 offset:9408
  ds_read_b64_tr_b16 v[126:127], v16 offset:9408
  s_waitcnt lgkmcnt(8)
  v_mfma_f32_16x16x32_bf16 v[48:51], v[132:135], v[144:147], v[48:51]
  v_mfma_f32_16x16x32_bf16 v[84:87], v[132:135], v[148:151], v[84:87]
  ds_read_b64_tr_b16 v[128:129], v15 offset:9440
  ds_read_b64_tr_b16 v[130:131], v16 offset:9440
  s_waitcnt lgkmcnt(8)
  v_mfma_f32_16x16x32_bf16 v[52:55], v[112:115], v[144:147], v[52:55]
  v_mfma_f32_16x16x32_bf16 v[88:91], v[112:115], v[148:151], v[88:91]
  ds_read_b64_tr_b16 v[132:133], v15 offset:9472
  ds_read_b64_tr_b16 v[134:135], v16 offset:9472
  s_waitcnt lgkmcnt(8)
  v_mfma_f32_16x16x32_bf16 v[56:59], v[116:119], v[144:147], v[56:59]
  v_mfma_f32_16x16x32_bf16 v[92:95], v[116:119], v[148:151], v[92:95]
  s_waitcnt lgkmcnt(6)
  v_mfma_f32_16x16x32_bf16 v[60:63], v[120:123], v[144:147], v[60:63]
  v_mfma_f32_16x16x32_bf16 v[96:99], v[120:123], v[148:151], v[96:99]
  s_mov_b32 s33, 2
ffn1_kernel_loop1:
  s_waitcnt vmcnt(6) lgkmcnt(0)
  s_barrier
  v_add_u32 v13, 0x8000, v13
  v_add_u32 v14, 0x8000, v14
  v_add_u32 v15, 0x4800, v15
  v_add_u32 v16, 0x4800, v16
  ds_read_b128 v[136:139], v13 offset:0
  ds_read_b64_tr_b16 v[112:113], v15 offset:0
  ds_read_b64_tr_b16 v[114:115], v16 offset:0
  ds_read_b128 v[140:143], v13 offset:2048
  ds_read_b64_tr_b16 v[116:117], v15 offset:32
  ds_read_b64_tr_b16 v[118:119], v16 offset:32
  v_mfma_f32_16x16x32_bf16 v[64:67], v[124:127], v[144:147], v[64:67]
  s_add_u32 m0, s21, 0x0
  s_nop 0
  buffer_load_dwordx4 v5, s[4:7], s30 offen lds
  v_mfma_f32_16x16x32_bf16 v[100:103], v[124:127], v[148:151], v[100:103]
  s_add_u32 m0, s21, 0x2000
  s_nop 0
  buffer_load_dwordx4 v6, s[4:7], s30 offen lds
  ds_read_b64_tr_b16 v[120:121], v15 offset:64
  ds_read_b64_tr_b16 v[122:123], v16 offset:64
  v_mfma_f32_16x16x32_bf16 v[68:71], v[128:131], v[144:147], v[68:71]
  s_add_u32 m0, s21, 0x4000
  s_nop 0
  buffer_load_dwordx4 v7, s[4:7], s30 offen lds
  v_mfma_f32_16x16x32_bf16 v[104:107], v[128:131], v[148:151], v[104:107]
  s_add_u32 m0, s21, 0x6000
  s_nop 0
  buffer_load_dwordx4 v8, s[4:7], s30 offen lds
  s_add_u32 s30, s30, 128
  ds_read_b64_tr_b16 v[124:125], v15 offset:96
  ds_read_b64_tr_b16 v[126:127], v16 offset:96
  v_mfma_f32_16x16x32_bf16 v[72:75], v[132:135], v[144:147], v[72:75]
  s_cmp_lt_u32 s20, 2
  s_cbranch_scc0 1f
  s_add_u32 m0, s21, 0x1c000
  s_nop 0
  buffer_load_dwordx4 v11, s[8:11], s31 offen lds
1:
  v_mfma_f32_16x16x32_bf16 v[108:111], v[132:135], v[148:151], v[108:111]
  s_add_u32 m0, s21, 0x18000
  s_nop 0
  buffer_load_dwordx4 v9, s[8:11], s31 offen lds
  ds_read_b64_tr_b16 v[128:129], v15 offset:128
  ds_read_b64_tr_b16 v[130:131], v16 offset:128
  s_waitcnt lgkmcnt(9)
  v_mfma_f32_16x16x32_bf16 v[40:43], v[112:115], v[136:139], v[40:43]
  s_add_u32 m0, s21, 0x1a000
  s_nop 0
  buffer_load_dwordx4 v10, s[8:11], s31 offen lds
  s_add_u32 s31, s31, 0x90000
  ds_read_b128 v[144:147], v14 offset:0
  s_waitcnt lgkmcnt(9)
  v_mfma_f32_16x16x32_bf16 v[76:79], v[112:115], v[140:143], v[76:79]
  ds_read_b64_tr_b16 v[132:133], v15 offset:160
  ds_read_b64_tr_b16 v[134:135], v16 offset:160
  s_waitcnt lgkmcnt(9)
  v_mfma_f32_16x16x32_bf16 v[44:47], v[116:119], v[136:139], v[44:47]
  v_mfma_f32_16x16x32_bf16 v[80:83], v[116:119], v[140:143], v[80:83]
  ds_read_b64_tr_b16 v[112:113], v15 offset:192
  ds_read_b64_tr_b16 v[114:115], v16 offset:192
  s_waitcnt lgkmcnt(9)
  v_mfma_f32_16x16x32_bf16 v[48:51], v[120:123], v[136:139], v[48:51]
  v_mfma_f32_16x16x32_bf16 v[84:87], v[120:123], v[140:143], v[84:87]
  ds_read_b64_tr_b16 v[116:117], v15 offset:224
  ds_read_b64_tr_b16 v[118:119], v16 offset:224
  s_waitcnt lgkmcnt(9)
  v_mfma_f32_16x16x32_bf16 v[52:55], v[124:127], v[136:139], v[52:55]
  ds_read_b128 v[148:151], v14 offset:2048
  v_mfma_f32_16x16x32_bf16 v[88:91], v[124:127], v[140:143], v[88:91]
  ds_read_b64_tr_b16 v[120:121], v15 offset:256
  ds_read_b64_tr_b16 v[122:123], v16 offset:256
  s_waitcnt lgkmcnt(10)
  v_mfma_f32_16x16x32_bf16 v[56:59], v[128:131], v[136:139], v[56:59]
  v_mfma_f32_16x16x32_bf16 v[92:95], v[128:131], v[140:143], v[92:95]
  ds_read_b64_tr_b16 v[124:125], v15 offset:9216
  ds_read_b64_tr_b16 v[126:127], v16 offset:9216
  s_waitcnt lgkmcnt(9)
  v_mfma_f32_16x16x32_bf16 v[60:63], v[132:135], v[136:139], v[60:63]
  v_mfma_f32_16x16x32_bf16 v[96:99], v[132:135], v[140:143], v[96:99]
  ds_read_b64_tr_b16 v[128:129], v15 offset:9248
  ds_read_b64_tr_b16 v[130:131], v16 offset:9248
  s_waitcnt lgkmcnt(9)
  v_mfma_f32_16x16x32_bf16 v[64:67], v[112:115], v[136:139], v[64:67]
  v_mfma_f32_16x16x32_bf16 v[100:103], v[112:115], v[140:143], v[100:103]
  ds_read_b64_tr_b16 v[132:133], v15 offset:9280
  ds_read_b64_tr_b16 v[134:135], v16 offset:9280
  s_waitcnt lgkmcnt(9)
  v_mfma_f32_16x16x32_bf16 v[68:71], v[116:119], v[136:139], v[68:71]
  v_mfma_f32_16x16x32_bf16 v[104:107], v[116:119], v[140:143], v[104:107]
  ds_read_b64_tr_b16 v[112:113], v15 offset:9312
  ds_read_b64_tr_b16 v[114:115], v16 offset:9312
  s_waitcnt lgkmcnt(8)
  v_mfma_f32_16x16x32_bf16 v[72:75], v[120:123], v[136:139], v[72:75]
  v_mfma_f32_16x16x32_bf16 v[108:111], v[120:123], v[140:143], v[108:111]
  ds_read_b64_tr_b16 v[116:117], v15 offset:9344
  ds_read_b64_tr_b16 v[118:119], v16 offset:9344
  s_waitcnt lgkmcnt(8)
  v_mfma_f32_16x16x32_bf16 v[40:43], v[124:127], v[144:147], v[40:43]
  v_mfma_f32_16x16x32_bf16 v[76:79], v[124:127], v[148:151], v[76:79]
  ds_read_b64_tr_b16 v[120:121], v15 offset:9376
  ds_read_b64_tr_b16 v[122:123], v16 offset:9376
  s_waitcnt lgkmcnt(8)
  v_mfma_f32_16x16x32_bf16 v[44:47], v[128:131], v[144:147], v[44:47]
  v_mfma_f32_16x16x32_bf16 v[80:83], v[128:131], v[148:151], v[80:83]
  ds_read_b64_tr_b16 v[124:125], v15 offset:9408
  ds_read_b64_tr_b16 v[126:127], v16 offset:9408
  s_waitcnt lgkmcnt(8)
  v_mfma_f32_16x16x32_bf16 v[48:51], v[132:135], v[144:147], v[48:51]
  v_mfma_f32_16x16x32_bf16 v[84:87], v[132:135], v[148:151], v[84:87]
  ds_read_b64_tr_b16 v[128:129], v15 offset:9440
  ds_read_b64_tr_b16 v[130:131], v16 offset:9440
  s_waitcnt lgkmcnt(8)
  v_mfma_f32_16x16x32_bf16 v[52:55], v[112:115], v[144:147], v[52:55]
  v_mfma_f32_16x16x32_bf16 v[88:91], v[112:115], v[148:151], v[88:91]
  ds_read_b64_tr_b16 v[132:133], v15 offset:9472
  ds_read_b64_tr_b16 v[134:135], v16 offset:9472
  s_waitcnt lgkmcnt(8)
  v_mfma_f32_16x16x32_bf16 v[56:59], v[116:119], v[144:147], v[56:59]
  v_mfma_f32_16x16x32_bf16 v[92:95], v[116:119], v[148:151], v[92:95]
  s_waitcnt lgkmcnt(6)
  v_mfma_f32_16x16x32_bf16 v[60:63], v[120:123], v[144:147], v[60:63]
  v_mfma_f32_16x16x32_bf16 v[96:99], v[120:123], v[148:151], v[96:99]
  s_waitcnt vmcnt(6) lgkmcnt(0)
  s_barrier
  v_add_u32 v13, 0x8000, v13
  v_add_u32 v14, 0x8000, v14
  v_add_u32 v15, 0x4800, v15
  v_add_u32 v16, 0x4800, v16
  ds_read_b128 v[136:139], v13 offset:0
  ds_read_b64_tr_b16 v[112:113], v15 offset:0
  ds_read_b64_tr_b16 v[114:115], v16 offset:0
  ds_read_b128 v[140:143], v13 offset:2048
  ds_read_b64_tr_b16 v[116:117], v15 offset:32
  ds_read_b64_tr_b16 v[118:119], v16 offset:32
  v_mfma_f32_16x16x32_bf16 v[64:67], v[124:127], v[144:147], v[64:67]
  s_add_u32 m0, s21, 0x8000
  s_nop 0
  buffer_load_dwordx4 v5, s[4:7], s30 offen lds
  v_mfma_f32_16x16x32_bf16 v[100:103], v[124:127], v[148:151], v[100:103]
  s_add_u32 m0, s21, 0xa000
  s_nop 0
  buffer_load_dwordx4 v6, s[4:7], s30 offen lds
  ds_read_b64_tr_b16 v[120:121], v15 offset:64
  ds_read_b64_tr_b16 v[122:123], v16 offset:64
  v_mfma_f32_16x16x32_bf16 v[68:71], v[128:131], v[144:147], v[68:71]
  s_add_u32 m0, s21, 0xc000
  s_nop 0
  buffer_load_dwordx4 v7, s[4:7], s30 offen lds
  v_mfma_f32_16x16x32_bf16 v[104:107], v[128:131], v[148:151], v[104:107]
  s_add_u32 m0, s21, 0xe000
  s_nop 0
  buffer_load_dwordx4 v8, s[4:7], s30 offen lds
  s_add_u32 s30, s30, 128
  ds_read_b64_tr_b16 v[124:125], v15 offset:96
  ds_read_b64_tr_b16 v[126:127], v16 offset:96
  v_mfma_f32_16x16x32_bf16 v[72:75], v[132:135], v[144:147], v[72:75]
  s_cmp_lt_u32 s20, 2
  s_cbranch_scc0 1f
  s_add_u32 m0, s21, 0x20800
  s_nop 0
  buffer_load_dwordx4 v11, s[8:11], s31 offen lds
1:
  v_mfma_f32_16x16x32_bf16 v[108:111], v[132:135], v[148:151], v[108:111]
  s_add_u32 m0, s21, 0x1c800
  s_nop 0
  buffer_load_dwordx4 v9, s[8:11], s31 offen lds
  ds_read_b64_tr_b16 v[128:129], v15 offset:128
  ds_read_b64_tr_b16 v[130:131], v16 offset:128
  s_waitcnt lgkmcnt(9)
  v_mfma_f32_16x16x32_bf16 v[40:43], v[112:115], v[136:139], v[40:43]
  s_add_u32 m0, s21, 0x1e800
  s_nop 0
  buffer_load_dwordx4 v10, s[8:11], s31 offen lds
  s_add_u32 s31, s31, 0x90000
  ds_read_b128 v[144:147], v14 offset:0
  s_waitcnt lgkmcnt(9)
  v_mfma_f32_16x16x32_bf16 v[76:79], v[112:115], v[140:143], v[76:79]
  ds_read_b64_tr_b16 v[132:133], v15 offset:160
  ds_read_b64_tr_b16 v[134:135], v16 offset:160
  s_waitcnt lgkmcnt(9)
  v_mfma_f32_16x16x32_bf16 v[44:47], v[116:119], v[136:139], v[44:47]
  v_mfma_f32_16x16x32_bf16 v[80:83], v[116:119], v[140:143], v[80:83]
  ds_read_b64_tr_b16 v[112:113], v15 offset:192
  ds_read_b64_tr_b16 v[114:115], v16 offset:192
  s_waitcnt lgkmcnt(9)
  v_mfma_f32_16x16x32_bf16 v[48:51], v[120:123], v[136:139], v[48:51]
  v_mfma_f32_16x16x32_bf16 v[84:87], v[120:123], v[140:143], v[84:87]
  ds_read_b64_tr_b16 v[116:117], v15 offset:224
  ds_read_b64_tr_b16 v[118:119], v16 offset:224
  s_waitcnt lgkmcnt(9)
  v_mfma_f32_16x16x32_bf16 v[52:55], v[124:127], v[136:139], v[52:55]
  ds_read_b128 v[148:151], v14 offset:2048
  v_mfma_f32_16x16x32_bf16 v[88:91], v[124:127], v[140:143], v[88:91]
  ds_read_b64_tr_b16 v[120:121], v15 offset:256
  ds_read_b64_tr_b16 v[122:123], v16 offset:256
  s_waitcnt lgkmcnt(10)
  v_mfma_f32_16x16x32_bf16 v[56:59], v[128:131], v[136:139], v[56:59]
  v_mfma_f32_16x16x32_bf16 v[92:95], v[128:131], v[140:143], v[92:95]
  ds_read_b64_tr_b16 v[124:125], v15 offset:9216
  ds_read_b64_tr_b16 v[126:127], v16 offset:9216
  s_waitcnt lgkmcnt(9)
  v_mfma_f32_16x16x32_bf16 v[60:63], v[132:135], v[136:139], v[60:63]
  v_mfma_f32_16x16x32_bf16 v[96:99], v[132:135], v[140:143], v[96:99]
  ds_read_b64_tr_b16 v[128:129], v15 offset:9248
  ds_read_b64_tr_b16 v[130:131], v16 offset:9248
  s_waitcnt lgkmcnt(9)
  v_mfma_f32_16x16x32_bf16 v[64:67], v[112:115], v[136:139], v[64:67]
  v_mfma_f32_16x16x32_bf16 v[100:103], v[112:115], v[140:143], v[100:103]
  ds_read_b64_tr_b16 v[132:133], v15 offset:9280
  ds_read_b64_tr_b16 v[134:135], v16 offset:9280
  s_waitcnt lgkmcnt(9)
  v_mfma_f32_16x16x32_bf16 v[68:71], v[116:119], v[136:139], v[68:71]
  v_mfma_f32_16x16x32_bf16 v[104:107], v[116:119], v[140:143], v[104:107]
  ds_read_b64_tr_b16 v[112:113], v15 offset:9312
  ds_read_b64_tr_b16 v[114:115], v16 offset:9312
  s_waitcnt lgkmcnt(8)
  v_mfma_f32_16x16x32_bf16 v[72:75], v[120:123], v[136:139], v[72:75]
  v_mfma_f32_16x16x32_bf16 v[108:111], v[120:123], v[140:143], v[108:111]
  ds_read_b64_tr_b16 v[116:117], v15 offset:9344
  ds_read_b64_tr_b16 v[118:119], v16 offset:9344
  s_waitcnt lgkmcnt(8)
  v_mfma_f32_16x16x32_bf16 v[40:43], v[124:127], v[144:147], v[40:43]
  v_mfma_f32_16x16x32_bf16 v[76:79], v[124:127], v[148:151], v[76:79]
  ds_read_b64_tr_b16 v[120:121], v15 offset:9376
  ds_read_b64_tr_b16 v[122:123], v16 offset:9376
  s_waitcnt lgkmcnt(8)
  v_mfma_f32_16x16x32_bf16 v[44:47], v[128:131], v[144:147], v[44:47]
  v_mfma_f32_16x16x32_bf16 v[80:83], v[128:131], v[148:151], v[80:83]
  ds_read_b64_tr_b16 v[124:125], v15 offset:9408
  ds_read_b64_tr_b16 v[126:127], v16 offset:9408
  s_waitcnt lgkmcnt(8)
  v_mfma_f32_16x16x32_bf16 v[48:51], v[132:135], v[144:147], v[48:51]
  v_mfma_f32_16x16x32_bf16 v[84:87], v[132:135], v[148:151], v[84:87]
  ds_read_b64_tr_b16 v[128:129], v15 offset:9440
  ds_read_b64_tr_b16 v[130:131], v16 offset:9440
  s_waitcnt lgkmcnt(8)
  v_mfma_f32_16x16x32_bf16 v[52:55], v[112:115], v[144:147], v[52:55]
  v_mfma_f32_16x16x32_bf16 v[88:91], v[112:115], v[148:151], v[88:91]
  ds_read_b64_tr_b16 v[132:133], v15 offset:9472
  ds_read_b64_tr_b16 v[134:135], v16 offset:9472
  s_waitcnt lgkmcnt(8)
  v_mfma_f32_16x16x32_bf16 v[56:59], v[116:119], v[144:147], v[56:59]
  v_mfma_f32_16x16x32_bf16 v[92:95], v[116:119], v[148:151], v[92:95]
  s_waitcnt lgkmcnt(6)
  v_mfma_f32_16x16x32_bf16 v[60:63], v[120:123], v[144:147], v[60:63]
  v_mfma_f32_16x16x32_bf16 v[96:99], v[120:123], v[148:151], v[96:99]
  s_waitcnt vmcnt(6) lgkmcnt(0)
  s_barrier
  v_subrev_u32 v13, 0x10000, v13
  v_subrev_u32 v14, 0x10000, v14
  v_subrev_u32 v15, 0x9000, v15
  v_subrev_u32 v16, 0x9000, v16
  ds_read_b128 v[136:139], v13 offset:0
  ds_read_b64_tr_b16 v[112:113], v15 offset:0
  ds_read_b64_tr_b16 v[114:115], v16 offset:0
  ds_read_b128 v[140:143], v13 offset:2048
  ds_read_b64_tr_b16 v[116:117], v15 offset:32
  ds_read_b64_tr_b16 v[118:119], v16 offset:32
  v_mfma_f32_16x16x32_bf16 v[64:67], v[124:127], v[144:147], v[64:67]
  s_add_u32 m0, s21, 0x10000
  s_nop 0
  buffer_load_dwordx4 v5, s[4:7], s30 offen lds
  v_mfma_f32_16x16x32_bf16 v[100:103], v[124:127], v[148:151], v[100:103]
  s_add_u32 m0, s21, 0x12000
  s_nop 0
  buffer_load_dwordx4 v6, s[4:7], s30 offen lds
  ds_read_b64_tr_b16 v[120:121], v15 offset:64
  ds_read_b64_tr_b16 v[122:123], v16 offset:64
  v_mfma_f32_16x16x32_bf16 v[68:71], v[128:131], v[144:147], v[68:71]
  s_add_u32 m0, s21, 0x14000
  s_nop 0
  buffer_load_dwordx4 v7, s[4:7], s30 offen lds
  v_mfma_f32_16x16x32_bf16 v[104:107], v[128:131], v[148:151], v[104:107]
  s_add_u32 m0, s21, 0x16000
  s_nop 0
  buffer_load_dwordx4 v8, s[4:7], s30 offen lds
  s_add_u32 s30, s30, 128
  ds_read_b64_tr_b16 v[124:125], v15 offset:96
  ds_read_b64_tr_b16 v[126:127], v16 offset:96
  v_mfma_f32_16x16x32_bf16 v[72:75], v[132:135], v[144:147], v[72:75]
  s_cmp_lt_u32 s20, 2
  s_cbranch_scc0 1f
  s_add_u32 m0, s21, 0x25000
  s_nop 0
  buffer_load_dwordx4 v11, s[8:11], s31 offen lds
1:
  v_mfma_f32_16x16x32_bf16 v[108:111], v[132:135], v[148:151], v[108:111]
  s_add_u32 m0, s21, 0x21000
  s_nop 0
  buffer_load_dwordx4 v9, s[8:11], s31 offen lds
  ds_read_b64_tr_b16 v[128:129], v15 offset:128
  ds_read_b64_tr_b16 v[130:131], v16 offset:128
  s_waitcnt lgkmcnt(9)
  v_mfma_f32_16x16x32_bf16 v[40:43], v[112:115], v[136:139], v[40:43]
  s_add_u32 m0, s21, 0x23000
  s_nop 0
  buffer_load_dwordx4 v10, s[8:11], s31 offen lds
  s_add_u32 s31, s31, 0x90000
  ds_read_b128 v[144:147], v14 offset:0
  s_waitcnt lgkmcnt(9)
  v_mfma_f32_16x16x32_bf16 v[76:79], v[112:115], v[140:143], v[76:79]
  ds_read_b64_tr_b16 v[132:133], v15 offset:160
  ds_read_b64_tr_b16 v[134:135], v16 offset:160
  s_waitcnt lgkmcnt(9)
  v_mfma_f32_16x16x32_bf16 v[44:47], v[116:119], v[136:139], v[44:47]
  v_mfma_f32_16x16x32_bf16 v[80:83], v[116:119], v[140:143], v[80:83]
  ds_read_b64_tr_b16 v[112:113], v15 offset:192
  ds_read_b64_tr_b16 v[114:115], v16 offset:192
  s_waitcnt lgkmcnt(9)
  v_mfma_f32_16x16x32_bf16 v[48:51], v[120:123], v[136:139], v[48:51]
  v_mfma_f32_16x16x32_bf16 v[84:87], v[120:123], v[140:143], v[84:87]
  ds_read_b64_tr_b16 v[116:117], v15 offset:224
  ds_read_b64_tr_b16 v[118:119], v16 offset:224
  s_waitcnt lgkmcnt(9)
  v_mfma_f32_16x16x32_bf16 v[52:55], v[124:127], v[136:139], v[52:55]
  ds_read_b128 v[148:151], v14 offset:2048
  v_mfma_f32_16x16x32_bf16 v[88:91], v[124:127], v[140:143], v[88:91]
  ds_read_b64_tr_b16 v[120:121], v15 offset:256
  ds_read_b64_tr_b16 v[122:123], v16 offset:256
  s_waitcnt lgkmcnt(10)
  v_mfma_f32_16x16x32_bf16 v[56:59], v[128:131], v[136:139], v[56:59]
  v_mfma_f32_16x16x32_bf16 v[92:95], v[128:131], v[140:143], v[92:95]
  ds_read_b64_tr_b16 v[124:125], v15 offset:9216
  ds_read_b64_tr_b16 v[126:127], v16 offset:9216
  s_waitcnt lgkmcnt(9)
  v_mfma_f32_16x16x32_bf16 v[60:63], v[132:135], v[136:139], v[60:63]
  v_mfma_f32_16x16x32_bf16 v[96:99], v[132:135], v[140:143], v[96:99]
  ds_read_b64_tr_b16 v[128:129], v15 offset:9248
  ds_read_b64_tr_b16 v[130:131], v16 offset:9248
  s_waitcnt lgkmcnt(9)
  v_mfma_f32_16x16x32_bf16 v[64:67], v[112:115], v[136:139], v[64:67]
  v_mfma_f32_16x16x32_bf16 v[100:103], v[112:115], v[140:143], v[100:103]
  ds_read_b64_tr_b16 v[132:133], v15 offset:9280
  ds_read_b64_tr_b16 v[134:135], v16 offset:9280
  s_waitcnt lgkmcnt(9)
  v_mfma_f32_16x16x32_bf16 v[68:71], v[116:119], v[136:139], v[68:71]
  v_mfma_f32_16x16x32_bf16 v[104:107], v[116:119], v[140:143], v[104:107]
  ds_read_b64_tr_b16 v[112:113], v15 offset:9312
  ds_read_b64_tr_b16 v[114:115], v16 offset:9312
  s_waitcnt lgkmcnt(8)
  v_mfma_f32_16x16x32_bf16 v[72:75], v[120:123], v[136:139], v[72:75]
  v_mfma_f32_16x16x32_bf16 v[108:111], v[120:123], v[140:143], v[108:111]
  ds_read_b64_tr_b16 v[116:117], v15 offset:9344
  ds_read_b64_tr_b16 v[118:119], v16 offset:9344
  s_waitcnt lgkmcnt(8)
  v_mfma_f32_16x16x32_bf16 v[40:43], v[124:127], v[144:147], v[40:43]
  v_mfma_f32_16x16x32_bf16 v[76:79], v[124:127], v[148:151], v[76:79]
  ds_read_b64_tr_b16 v[120:121], v15 offset:9376
  ds_read_b64_tr_b16 v[122:123], v16 offset:9376
  s_waitcnt lgkmcnt(8)
  v_mfma_f32_16x16x32_bf16 v[44:47], v[128:131], v[144:147], v[44:47]
  v_mfma_f32_16x16x32_bf16 v[80:83], v[128:131], v[148:151], v[80:83]
  ds_read_b64_tr_b16 v[124:125], v15 offset:9408
  ds_read_b64_tr_b16 v[126:127], v16 offset:9408
  s_waitcnt lgkmcnt(8)
  v_mfma_f32_16x16x32_bf16 v[48:51], v[132:135], v[144:147], v[48:51]
  v_mfma_f32_16x16x32_bf16 v[84:87], v[132:135], v[148:151], v[84:87]
  ds_read_b64_tr_b16 v[128:129], v15 offset:9440
  ds_read_b64_tr_b16 v[130:131], v16 offset:9440
  s_waitcnt lgkmcnt(8)
  v_mfma_f32_16x16x32_bf16 v[52:55], v[112:115], v[144:147], v[52:55]
  v_mfma_f32_16x16x32_bf16 v[88:91], v[112:115], v[148:151], v[88:91]
  ds_read_b64_tr_b16 v[132:133], v15 offset:9472
  ds_read_b64_tr_b16 v[134:135], v16 offset:9472
  s_waitcnt lgkmcnt(8)
  v_mfma_f32_16x16x32_bf16 v[56:59], v[116:119], v[144:147], v[56:59]
  v_mfma_f32_16x16x32_bf16 v[92:95], v[116:119], v[148:151], v[92:95]
  s_waitcnt lgkmcnt(6)
  v_mfma_f32_16x16x32_bf16 v[60:63], v[120:123], v[144:147], v[60:63]
  v_mfma_f32_16x16x32_bf16 v[96:99], v[120:123], v[148:151], v[96:99]
  s_sub_u32 s33, s33, 1
  s_cmp_lg_u32 s33, 0
  s_cbranch_scc1 ffn1_kernel_loop1
  s_waitcnt vmcnt(6) lgkmcnt(0)
  s_barrier
  v_add_u32 v13, 0x8000, v13
  v_add_u32 v14, 0x8000, v14
  v_add_u32 v15, 0x4800, v15
  v_add_u32 v16, 0x4800, v16
  ds_read_b128 v[136:139], v13 offset:0
  ds_read_b64_tr_b16 v[112:113], v15 offset:0
  ds_read_b64_tr_b16 v[114:115], v16 offset:0
  ds_read_b128 v[140:143], v13 offset:2048
  ds_read_b64_tr_b16 v[116:117], v15 offset:32
  ds_read_b64_tr_b16 v[118:119], v16 offset:32
  v_mfma_f32_16x16x32_bf16 v[64:67], v[124:127], v[144:147], v[64:67]
  v_mfma_f32_16x16x32_bf16 v[100:103], v[124:127], v[148:151], v[100:103]
  ds_read_b64_tr_b16 v[120:121], v15 offset:64
  ds_read_b64_tr_b16 v[122:123], v16 offset:64
  v_mfma_f32_16x16x32_bf16 v[68:71], v[128:131], v[144:147], v[68:71]
  v_mfma_f32_16x16x32_bf16 v[104:107], v[128:131], v[148:151], v[104:107]
  ds_read_b64_tr_b16 v[124:125], v15 offset:96
  ds_read_b64_tr_b16 v[126:127], v16 offset:96
  v_mfma_f32_16x16x32_bf16 v[72:75], v[132:135], v[144:147], v[72:75]
  v_mfma_f32_16x16x32_bf16 v[108:111], v[132:135], v[148:151], v[108:111]
  ds_read_b64_tr_b16 v[128:129], v15 offset:128
  ds_read_b64_tr_b16 v[130:131], v16 offset:128
  s_waitcnt lgkmcnt(9)
  v_mfma_f32_16x16x32_bf16 v[40:43], v[112:115], v[136:139], v[40:43]
  ds_read_b128 v[144:147], v14 offset:0
  s_waitcnt lgkmcnt(9)
  v_mfma_f32_16x16x32_bf16 v[76:79], v[112:115], v[140:143], v[76:79]
  ds_read_b64_tr_b16 v[132:133], v15 offset:160
  ds_read_b64_tr_b16 v[134:135], v16 offset:160
  s_waitcnt lgkmcnt(9)
  v_mfma_f32_16x16x32_bf16 v[44:47], v[116:119], v[136:139], v[44:47]
  v_mfma_f32_16x16x32_bf16 v[80:83], v[116:119], v[140:143], v[80:83]
  ds_read_b64_tr_b16 v[112:113], v15 offset:192
  ds_read_b64_tr_b16 v[114:115], v16 offset:192
  s_waitcnt lgkmcnt(9)
  v_mfma_f32_16x16x32_bf16 v[48:51], v[120:123], v[136:139], v[48:51]
  v_mfma_f32_16x16x32_bf16 v[84:87], v[120:123], v[140:143], v[84:87]
  ds_read_b64_tr_b16 v[116:117], v15 offset:224
  ds_read_b64_tr_b16 v[118:119], v16 offset:224
  s_waitcnt lgkmcnt(9)
  v_mfma_f32_16x16x32_bf16 v[52:55], v[124:127], v[136:139], v[52:55]
  ds_read_b128 v[148:151], v14 offset:2048
  v_mfma_f32_16x16x32_bf16 v[88:91], v[124:127], v[140:143], v[88:91]
  ds_read_b64_tr_b16 v[120:121], v15 offset:256
  ds_read_b64_tr_b16 v[122:123], v16 offset:256
  s_waitcnt lgkmcnt(10)
  v_mfma_f32_16x16x32_bf16 v[56:59], v[128:131], v[136:139], v[56:59]
  v_mfma_f32_16x16x32_bf16 v[92:95], v[128:131], v[140:143], v[92:95]
  ds_read_b64_tr_b16 v[124:125], v15 offset:9216
  ds_read_b64_tr_b16 v[126:127], v16 offset:9216
  s_waitcnt lgkmcnt(9)
  v_mfma_f32_16x16x32_bf16 v[60:63], v[132:135], v[136:139], v[60:63]
  v_mfma_f32_16x16x32_bf16 v[96:99], v[132:135], v[140:143], v[96:99]
  ds_read_b64_tr_b16 v[128:129], v15 offset:9248
  ds_read_b64_tr_b16 v[130:131], v16 offset:9248
  s_waitcnt lgkmcnt(9)
  v_mfma_f32_16x16x32_bf16 v[64:67], v[112:115], v[136:139], v[64:67]
  v_mfma_f32_16x16x32_bf16 v[100:103], v[112:115], v[140:143], v[100:103]
  ds_read_b64_tr_b16 v[132:133], v15 offset:9280
  ds_read_b64_tr_b16 v[134:135], v16 offset:9280
  s_waitcnt lgkmcnt(9)
  v_mfma_f32_16x16x32_bf16 v[68:71], v[116:119], v[136:139], v[68:71]
  v_mfma_f32_16x16x32_bf16 v[104:107], v[116:119], v[140:143], v[104:107]
  ds_read_b64_tr_b16 v[112:113], v15 offset:9312
  ds_read_b64_tr_b16 v[114:115], v16 offset:9312
  s_waitcnt lgkmcnt(8)
  v_mfma_f32_16x16x32_bf16 v[72:75], v[120:123], v[136:139], v[72:75]
  v_mfma_f32_16x16x32_bf16 v[108:111], v[120:123], v[140:143], v[108:111]
  ds_read_b64_tr_b16 v[116:117], v15 offset:9344
  ds_read_b64_tr_b16 v[118:119], v16 offset:9344
  s_waitcnt lgkmcnt(8)
  v_mfma_f32_16x16x32_bf16 v[40:43], v[124:127], v[144:147], v[40:43]
  v_mfma_f32_16x16x32_bf16 v[76:79], v[124:127], v[148:151], v[76:79]
  ds_read_b64_tr_b16 v[120:121], v15 offset:9376
  ds_read_b64_tr_b16 v[122:123], v16 offset:9376
  s_waitcnt lgkmcnt(8)
  v_mfma_f32_16x16x32_bf16 v[44:47], v[128:131], v[144:147], v[44:47]
  v_mfma_f32_16x16x32_bf16 v[80:83], v[128:131], v[148:151], v[80:83]
  ds_read_b64_tr_b16 v[124:125], v15 offset:9408
  ds_read_b64_tr_b16 v[126:127], v16 offset:9408
  s_waitcnt lgkmcnt(8)
  v_mfma_f32_16x16x32_bf16 v[48:51], v[132:135], v[144:147], v[48:51]
  v_mfma_f32_16x16x32_bf16 v[84:87], v[132:135], v[148:151], v[84:87]
  ds_read_b64_tr_b16 v[128:129], v15 offset:9440
  ds_read_b64_tr_b16 v[130:131], v16 offset:9440
  s_waitcnt lgkmcnt(8)
  v_mfma_f32_16x16x32_bf16 v[52:55], v[112:115], v[144:147], v[52:55]
  v_mfma_f32_16x16x32_bf16 v[88:91], v[112:115], v[148:151], v[88:91]
  ds_read_b64_tr_b16 v[132:133], v15 offset:9472
  ds_read_b64_tr_b16 v[134:135], v16 offset:9472
  s_waitcnt lgkmcnt(8)
  v_mfma_f32_16x16x32_bf16 v[56:59], v[116:119], v[144:147], v[56:59]
  v_mfma_f32_16x16x32_bf16 v[92:95], v[116:119], v[148:151], v[92:95]
  s_waitcnt lgkmcnt(6)
  v_mfma_f32_16x16x32_bf16 v[60:63], v[120:123], v[144:147], v[60:63]
  v_mfma_f32_16x16x32_bf16 v[96:99], v[120:123], v[148:151], v[96:99]
  s_waitcnt vmcnt(0) lgkmcnt(0)
  s_barrier
  v_add_u32 v13, 0x8000, v13
  v_add_u32 v14, 0x8000, v14
  v_add_u32 v15, 0x4800, v15
  v_add_u32 v16, 0x4800, v16
  ds_read_b128 v[136:139], v13 offset:0
  ds_read_b64_tr_b16 v[112:113], v15 offset:0
  ds_read_b64_tr_b16 v[114:115], v16 offset:0
  ds_read_b128 v[140:143], v13 offset:2048
  ds_read_b64_tr_b16 v[116:117], v15 offset:32
  ds_read_b64_tr_b16 v[118:119], v16 offset:32
  v_mfma_f32_16x16x32_bf16 v[64:67], v[124:127], v[144:147], v[64:67]
  v_mfma_f32_16x16x32_bf16 v[100:103], v[124:127], v[148:151], v[100:103]
  ds_read_b64_tr_b16 v[120:121], v15 offset:64
  ds_read_b64_tr_b16 v[122:123], v16 offset:64
  v_mfma_f32_16x16x32_bf16 v[68:71], v[128:131], v[144:147], v[68:71]
  v_mfma_f32_16x16x32_bf16 v[104:107], v[128:131], v[148:151], v[104:107]
  ds_read_b64_tr_b16 v[124:125], v15 offset:96
  ds_read_b64_tr_b16 v[126:127], v16 offset:96
  v_mfma_f32_16x16x32_bf16 v[72:75], v[132:135], v[144:147], v[72:75]
  v_mfma_f32_16x16x32_bf16 v[108:111], v[132:135], v[148:151], v[108:111]
  ds_read_b64_tr_b16 v[128:129], v15 offset:128
  ds_read_b64_tr_b16 v[130:131], v16 offset:128
  s_waitcnt lgkmcnt(9)
  v_mfma_f32_16x16x32_bf16 v[40:43], v[112:115], v[136:139], v[40:43]
  ds_read_b128 v[144:147], v14 offset:0
  s_waitcnt lgkmcnt(9)
  v_mfma_f32_16x16x32_bf16 v[76:79], v[112:115], v[140:143], v[76:79]
  ds_read_b64_tr_b16 v[132:133], v15 offset:160
  ds_read_b64_tr_b16 v[134:135], v16 offset:160
  s_waitcnt lgkmcnt(9)
  v_mfma_f32_16x16x32_bf16 v[44:47], v[116:119], v[136:139], v[44:47]
  v_mfma_f32_16x16x32_bf16 v[80:83], v[116:119], v[140:143], v[80:83]
  ds_read_b64_tr_b16 v[112:113], v15 offset:192
  ds_read_b64_tr_b16 v[114:115], v16 offset:192
  s_waitcnt lgkmcnt(9)
  v_mfma_f32_16x16x32_bf16 v[48:51], v[120:123], v[136:139], v[48:51]
  v_mfma_f32_16x16x32_bf16 v[84:87], v[120:123], v[140:143], v[84:87]
  ds_read_b64_tr_b16 v[116:117], v15 offset:224
  ds_read_b64_tr_b16 v[118:119], v16 offset:224
  s_waitcnt lgkmcnt(9)
  v_mfma_f32_16x16x32_bf16 v[52:55], v[124:127], v[136:139], v[52:55]
  ds_read_b128 v[148:151], v14 offset:2048
  v_mfma_f32_16x16x32_bf16 v[88:91], v[124:127], v[140:143], v[88:91]
  ds_read_b64_tr_b16 v[120:121], v15 offset:256
  ds_read_b64_tr_b16 v[122:123], v16 offset:256
  s_waitcnt lgkmcnt(10)
  v_mfma_f32_16x16x32_bf16 v[56:59], v[128:131], v[136:139], v[56:59]
  v_mfma_f32_16x16x32_bf16 v[92:95], v[128:131], v[140:143], v[92:95]
  ds_read_b64_tr_b16 v[124:125], v15 offset:9216
  ds_read_b64_tr_b16 v[126:127], v16 offset:9216
  s_waitcnt lgkmcnt(9)
  v_mfma_f32_16x16x32_bf16 v[60:63], v[132:135], v[136:139], v[60:63]
  v_mfma_f32_16x16x32_bf16 v[96:99], v[132:135], v[140:143], v[96:99]
  ds_read_b64_tr_b16 v[128:129], v15 offset:9248
  ds_read_b64_tr_b16 v[130:131], v16 offset:9248
  s_waitcnt lgkmcnt(9)
  v_mfma_f32_16x16x32_bf16 v[64:67], v[112:115], v[136:139], v[64:67]
  v_mfma_f32_16x16x32_bf16 v[100:103], v[112:115], v[140:143], v[100:103]
  ds_read_b64_tr_b16 v[132:133], v15 offset:9280
  ds_read_b64_tr_b16 v[134:135], v16 offset:9280
  s_waitcnt lgkmcnt(9)
  v_mfma_f32_16x16x32_bf16 v[68:71], v[116:119], v[136:139], v[68:71]
  v_mfma_f32_16x16x32_bf16 v[104:107], v[116:119], v[140:143], v[104:107]
  ds_read_b64_tr_b16 v[112:113], v15 offset:9312
  ds_read_b64_tr_b16 v[114:115], v16 offset:9312
  s_waitcnt lgkmcnt(8)
  v_mfma_f32_16x16x32_bf16 v[72:75], v[120:123], v[136:139], v[72:75]
  v_mfma_f32_16x16x32_bf16 v[108:111], v[120:123], v[140:143], v[108:111]
  ds_read_b64_tr_b16 v[116:117], v15 offset:9344
  ds_read_b64_tr_b16 v[118:119], v16 offset:9344
  s_waitcnt lgkmcnt(8)
  v_mfma_f32_16x16x32_bf16 v[40:43], v[124:127], v[144:147], v[40:43]
  v_mfma_f32_16x16x32_bf16 v[76:79], v[124:127], v[148:151], v[76:79]
  ds_read_b64_tr_b16 v[120:121], v15 offset:9376
  ds_read_b64_tr_b16 v[122:123], v16 offset:9376
  s_waitcnt lgkmcnt(8)
  v_mfma_f32_16x16x32_bf16 v[44:47], v[128:131], v[144:147], v[44:47]
  v_mfma_f32_16x16x32_bf16 v[80:83], v[128:131], v[148:151], v[80:83]
  ds_read_b64_tr_b16 v[124:125], v15 offset:9408
  ds_read_b64_tr_b16 v[126:127], v16 offset:9408
  s_waitcnt lgkmcnt(8)
  v_mfma_f32_16x16x32_bf16 v[48:51], v[132:135], v[144:147], v[48:51]
  v_mfma_f32_16x16x32_bf16 v[84:87], v[132:135], v[148:151], v[84:87]
  ds_read_b64_tr_b16 v[128:129], v15 offset:9440
  ds_read_b64_tr_b16 v[130:131], v16 offset:9440
  s_waitcnt lgkmcnt(8)
  v_mfma_f32_16x16x32_bf16 v[52:55], v[112:115], v[144:147], v[52:55]
  v_mfma_f32_16x16x32_bf16 v[88:91], v[112:115], v[148:151], v[88:91]
  ds_read_b64_tr_b16 v[132:133], v15 offset:9472
  ds_read_b64_tr_b16 v[134:135], v16 offset:9472
  s_waitcnt lgkmcnt(8)
  v_mfma_f32_16x16x32_bf16 v[56:59], v[116:119], v[144:147], v[56:59]
  v_mfma_f32_16x16x32_bf16 v[92:95], v[116:119], v[148:151], v[92:95]
  s_waitcnt lgkmcnt(6)
  v_mfma_f32_16x16x32_bf16 v[60:63], v[120:123], v[144:147], v[60:63]
  v_mfma_f32_16x16x32_bf16 v[96:99], v[120:123], v[148:151], v[96:99]
  s_waitcnt lgkmcnt(4)
  v_mfma_f32_16x16x32_bf16 v[64:67], v[124:127], v[144:147], v[64:67]
  v_mfma_f32_16x16x32_bf16 v[100:103], v[124:127], v[148:151], v[100:103]
  s_waitcnt lgkmcnt(2)
  v_mfma_f32_16x16x32_bf16 v[68:71], v[128:131], v[144:147], v[68:71]
  v_mfma_f32_16x16x32_bf16 v[104:107], v[128:131], v[148:151], v[104:107]
  s_waitcnt lgkmcnt(0)
  v_mfma_f32_16x16x32_bf16 v[72:75], v[132:135], v[144:147], v[72:75]
  v_mfma_f32_16x16x32_bf16 v[108:111], v[132:135], v[148:151], v[108:111]
  s_nop 15
  v_and_b32 v2, 15, v1
  v_mul_u32_u24 v2, 9216, v2
  v_lshl_add_u32 v2, v12, 4, v2
  s_mul_i32 s28, s24, 294912
  v_add_u32 v2, s28, v2
  v_lshlrev_b32 v3, 16, v18
  v_and_b32 v4, 0xffff0000, v18
  v_add_f32 v40, v40, v3
  v_add_f32 v41, v41, v4
  v_max_f32 v40, 0, v40
  v_max_f32 v41, 0, v41
  v_mul_f32 v40, v40, v40
  v_mul_f32 v41, v41, v41
  v_add_f32 v76, v76, v3
  v_add_f32 v77, v77, v4
  v_max_f32 v76, 0, v76
  v_max_f32 v77, 0, v77
  v_mul_f32 v76, v76, v76
  v_mul_f32 v77, v77, v77
  v_lshlrev_b32 v3, 16, v19
  v_and_b32 v4, 0xffff0000, v19
  v_add_f32 v42, v42, v3
  v_add_f32 v43, v43, v4
  v_max_f32 v42, 0, v42
  v_max_f32 v43, 0, v43
  v_mul_f32 v42, v42, v42
  v_mul_f32 v43, v43, v43
  v_add_f32 v78, v78, v3
  v_add_f32 v79, v79, v4
  v_max_f32 v78, 0, v78
  v_max_f32 v79, 0, v79
  v_mul_f32 v78, v78, v78
  v_mul_f32 v79, v79, v79
  v_lshlrev_b32 v3, 16, v20
  v_and_b32 v4, 0xffff0000, v20
  v_add_f32 v44, v44, v3
  v_add_f32 v45, v45, v4
  v_max_f32 v44, 0, v44
  v_max_f32 v45, 0, v45
  v_mul_f32 v44, v44, v44
  v_mul_f32 v45, v45, v45
  v_add_f32 v80, v80, v3
  v_add_f32 v81, v81, v4
  v_max_f32 v80, 0, v80
  v_max_f32 v81, 0, v81
  v_mul_f32 v80, v80, v80
  v_mul_f32 v81, v81, v81
  v_lshlrev_b32 v3, 16, v21
  v_and_b32 v4, 0xffff0000, v21
  v_add_f32 v46, v46, v3
  v_add_f32 v47, v47, v4
  v_max_f32 v46, 0, v46
  v_max_f32 v47, 0, v47
  v_mul_f32 v46, v46, v46
  v_mul_f32 v47, v47, v47
  v_add_f32 v82, v82, v3
  v_add_f32 v83, v83, v4
  v_max_f32 v82, 0, v82
  v_max_f32 v83, 0, v83
  v_mul_f32 v82, v82, v82
  v_mul_f32 v83, v83, v83
  v_lshlrev_b32 v3, 16, v22
  v_and_b32 v4, 0xffff0000, v22
  v_add_f32 v48, v48, v3
  v_add_f32 v49, v49, v4
  v_max_f32 v48, 0, v48
  v_max_f32 v49, 0, v49
  v_mul_f32 v48, v48, v48
  v_mul_f32 v49, v49, v49
  v_add_f32 v84, v84, v3
  v_add_f32 v85, v85, v4
  v_max_f32 v84, 0, v84
  v_max_f32 v85, 0, v85
  v_mul_f32 v84, v84, v84
  v_mul_f32 v85, v85, v85
  v_lshlrev_b32 v3, 16, v23
  v_and_b32 v4, 0xffff0000, v23
  v_add_f32 v50, v50, v3
  v_add_f32 v51, v51, v4
  v_max_f32 v50, 0, v50
  v_max_f32 v51, 0, v51
  v_mul_f32 v50, v50, v50
  v_mul_f32 v51, v51, v51
  v_add_f32 v86, v86, v3
  v_add_f32 v87, v87, v4
  v_max_f32 v86, 0, v86
  v_max_f32 v87, 0, v87
  v_mul_f32 v86, v86, v86
  v_mul_f32 v87, v87, v87
  v_lshlrev_b32 v3, 16, v24
  v_and_b32 v4, 0xffff0000, v24
  v_add_f32 v52, v52, v3
  v_add_f32 v53, v53, v4
  v_max_f32 v52, 0, v52
  v_max_f32 v53, 0, v53
  v_mul_f32 v52, v52, v52
  v_mul_f32 v53, v53, v53
  v_add_f32 v88, v88, v3
  v_add_f32 v89, v89, v4
  v_max_f32 v88, 0, v88
  v_max_f32 v89, 0, v89
  v_mul_f32 v88, v88, v88
  v_mul_f32 v89, v89, v89
  v_lshlrev_b32 v3, 16, v25
  v_and_b32 v4, 0xffff0000, v25
  v_add_f32 v54, v54, v3
  v_add_f32 v55, v55, v4
  v_max_f32 v54, 0, v54
  v_max_f32 v55, 0, v55
  v_mul_f32 v54, v54, v54
  v_mul_f32 v55, v55, v55
  v_add_f32 v90, v90, v3
  v_add_f32 v91, v91, v4
  v_max_f32 v90, 0, v90
  v_max_f32 v91, 0, v91
  v_mul_f32 v90, v90, v90
  v_mul_f32 v91, v91, v91
  v_lshlrev_b32 v3, 16, v26
  v_and_b32 v4, 0xffff0000, v26
  v_add_f32 v56, v56, v3
  v_add_f32 v57, v57, v4
  v_max_f32 v56, 0, v56
  v_max_f32 v57, 0, v57
  v_mul_f32 v56, v56, v56
  v_mul_f32 v57, v57, v57
  v_add_f32 v92, v92, v3
  v_add_f32 v93, v93, v4
  v_max_f32 v92, 0, v92
  v_max_f32 v93, 0, v93
  v_mul_f32 v92, v92, v92
  v_mul_f32 v93, v93, v93
  v_lshlrev_b32 v3, 16, v27
  v_and_b32 v4, 0xffff0000, v27
  v_add_f32 v58, v58, v3
  v_add_f32 v59, v59, v4
  v_max_f32 v58, 0, v58
  v_max_f32 v59, 0, v59
  v_mul_f32 v58, v58, v58
  v_mul_f32 v59, v59, v59
  v_add_f32 v94, v94, v3
  v_add_f32 v95, v95, v4
  v_max_f32 v94, 0, v94
  v_max_f32 v95, 0, v95
  v_mul_f32 v94, v94, v94
  v_mul_f32 v95, v95, v95
  v_lshlrev_b32 v3, 16, v28
  v_and_b32 v4, 0xffff0000, v28
  v_add_f32 v60, v60, v3
  v_add_f32 v61, v61, v4
  v_max_f32 v60, 0, v60
  v_max_f32 v61, 0, v61
  v_mul_f32 v60, v60, v60
  v_mul_f32 v61, v61, v61
  v_add_f32 v96, v96, v3
  v_add_f32 v97, v97, v4
  v_max_f32 v96, 0, v96
  v_max_f32 v97, 0, v97
  v_mul_f32 v96, v96, v96
  v_mul_f32 v97, v97, v97
  v_lshlrev_b32 v3, 16, v29
  v_and_b32 v4, 0xffff0000, v29
  v_add_f32 v62, v62, v3
  v_add_f32 v63, v63, v4
  v_max_f32 v62, 0, v62
  v_max_f32 v63, 0, v63
  v_mul_f32 v62, v62, v62
  v_mul_f32 v63, v63, v63
  v_add_f32 v98, v98, v3
  v_add_f32 v99, v99, v4
  v_max_f32 v98, 0, v98
  v_max_f32 v99, 0, v99
  v_mul_f32 v98, v98, v98
  v_mul_f32 v99, v99, v99
  v_lshlrev_b32 v3, 16, v30
  v_and_b32 v4, 0xffff0000, v30
  v_add_f32 v64, v64, v3
  v_add_f32 v65, v65, v4
  v_max_f32 v64, 0, v64
  v_max_f32 v65, 0, v65
  v_mul_f32 v64, v64, v64
  v_mul_f32 v65, v65, v65
  v_add_f32 v100, v100, v3
  v_add_f32 v101, v101, v4
  v_max_f32 v100, 0, v100
  v_max_f32 v101, 0, v101
  v_mul_f32 v100, v100, v100
  v_mul_f32 v101, v101, v101
  v_lshlrev_b32 v3, 16, v31
  v_and_b32 v4, 0xffff0000, v31
  v_add_f32 v66, v66, v3
  v_add_f32 v67, v67, v4
  v_max_f32 v66, 0, v66
  v_max_f32 v67, 0, v67
  v_mul_f32 v66, v66, v66
  v_mul_f32 v67, v67, v67
  v_add_f32 v102, v102, v3
  v_add_f32 v103, v103, v4
  v_max_f32 v102, 0, v102
  v_max_f32 v103, 0, v103
  v_mul_f32 v102, v102, v102
  v_mul_f32 v103, v103, v103
  v_lshlrev_b32 v3, 16, v32
  v_and_b32 v4, 0xffff0000, v32
  v_add_f32 v68, v68, v3
  v_add_f32 v69, v69, v4
  v_max_f32 v68, 0, v68
  v_max_f32 v69, 0, v69
  v_mul_f32 v68, v68, v68
  v_mul_f32 v69, v69, v69
  v_add_f32 v104, v104, v3
  v_add_f32 v105, v105, v4
  v_max_f32 v104, 0, v104
  v_max_f32 v105, 0, v105
  v_mul_f32 v104, v104, v104
  v_mul_f32 v105, v105, v105
  v_lshlrev_b32 v3, 16, v33
  v_and_b32 v4, 0xffff0000, v33
  v_add_f32 v70, v70, v3
  v_add_f32 v71, v71, v4
  v_max_f32 v70, 0, v70
  v_max_f32 v71, 0, v71
  v_mul_f32 v70, v70, v70
  v_mul_f32 v71, v71, v71
  v_add_f32 v106, v106, v3
  v_add_f32 v107, v107, v4
  v_max_f32 v106, 0, v106
  v_max_f32 v107, 0, v107
  v_mul_f32 v106, v106, v106
  v_mul_f32 v107, v107, v107
  v_lshlrev_b32 v3, 16, v34
  v_and_b32 v4, 0xffff0000, v34
  v_add_f32 v72, v72, v3
  v_add_f32 v73, v73, v4
  v_max_f32 v72, 0, v72
  v_max_f32 v73, 0, v73
  v_mul_f32 v72, v72, v72
  v_mul_f32 v73, v73, v73
  v_add_f32 v108, v108, v3
  v_add_f32 v109, v109, v4
  v_max_f32 v108, 0, v108
  v_max_f32 v109, 0, v109
  v_mul_f32 v108, v108, v108
  v_mul_f32 v109, v109, v109
  v_lshlrev_b32 v3, 16, v35
  v_and_b32 v4, 0xffff0000, v35
  v_add_f32 v74, v74, v3
  v_add_f32 v75, v75, v4
  v_max_f32 v74, 0, v74
  v_max_f32 v75, 0, v75
  v_mul_f32 v74, v74, v74
  v_mul_f32 v75, v75, v75
  v_add_f32 v110, v110, v3
  v_add_f32 v111, v111, v4
  v_max_f32 v110, 0, v110
  v_max_f32 v111, 0, v111
  v_mul_f32 v110, v110, v110
  v_mul_f32 v111, v111, v111
  s_cmp_eq_u32 s26, 0
  s_cbranch_scc0 ffn1_kernel_odd2
  s_mov_b32 s28, 0x0
  v_cvt_pk_bf16_f32 v40, v40, v41
  v_cvt_pk_bf16_f32 v41, v42, v43
  v_cvt_pk_bf16_f32 v42, v44, v45
  v_cvt_pk_bf16_f32 v43, v46, v47
  buffer_store_dwordx4 v[40:43], v2, s[12:15], s28 offen offset:0 sc1
  v_cvt_pk_bf16_f32 v48, v48, v49
  v_cvt_pk_bf16_f32 v49, v50, v51
  v_cvt_pk_bf16_f32 v50, v52, v53
  v_cvt_pk_bf16_f32 v51, v54, v55
  buffer_store_dwordx4 v[48:51], v2, s[12:15], s28 offen offset:64 sc1
  v_cvt_pk_bf16_f32 v56, v56, v57
  v_cvt_pk_bf16_f32 v57, v58, v59
  v_cvt_pk_bf16_f32 v58, v60, v61
  v_cvt_pk_bf16_f32 v59, v62, v63
  buffer_store_dwordx4 v[56:59], v2, s[12:15], s28 offen offset:128 sc1
  v_cvt_pk_bf16_f32 v64, v64, v65
  v_cvt_pk_bf16_f32 v65, v66, v67
  v_cvt_pk_bf16_f32 v66, v68, v69
  v_cvt_pk_bf16_f32 v67, v70, v71
  buffer_store_dwordx4 v[64:67], v2, s[12:15], s28 offen offset:192 sc1
  v_cvt_pk_bf16_f32 v72, v72, v73
  v_cvt_pk_bf16_f32 v73, v74, v75
  buffer_store_dwordx2 v[72:73], v2, s[12:15], s28 offen offset:256 sc1
  s_mov_b32 s28, 0x24000
  v_cvt_pk_bf16_f32 v76, v76, v77
  v_cvt_pk_bf16_f32 v77, v78, v79
  v_cvt_pk_bf16_f32 v78, v80, v81
  v_cvt_pk_bf16_f32 v79, v82, v83
  buffer_store_dwordx4 v[76:79], v2, s[12:15], s28 offen offset:0 sc1
  v_cvt_pk_bf16_f32 v84, v84, v85
  v_cvt_pk_bf16_f32 v85, v86, v87
  v_cvt_pk_bf16_f32 v86, v88, v89
  v_cvt_pk_bf16_f32 v87, v90, v91
  buffer_store_dwordx4 v[84:87], v2, s[12:15], s28 offen offset:64 sc1
  v_cvt_pk_bf16_f32 v92, v92, v93
  v_cvt_pk_bf16_f32 v93, v94, v95
  v_cvt_pk_bf16_f32 v94, v96, v97
  v_cvt_pk_bf16_f32 v95, v98, v99
  buffer_store_dwordx4 v[92:95], v2, s[12:15], s28 offen offset:128 sc1
  v_cvt_pk_bf16_f32 v100, v100, v101
  v_cvt_pk_bf16_f32 v101, v102, v103
  v_cvt_pk_bf16_f32 v102, v104, v105
  v_cvt_pk_bf16_f32 v103, v106, v107
  buffer_store_dwordx4 v[100:103], v2, s[12:15], s28 offen offset:192 sc1
  v_cvt_pk_bf16_f32 v108, v108, v109
  v_cvt_pk_bf16_f32 v109, v110, v111
  buffer_store_dwordx2 v[108:109], v2, s[12:15], s28 offen offset:256 sc1
  s_branch ffn1_kernel_join3
ffn1_kernel_odd2:
  s_mov_b32 s28, 0x0
  v_cvt_pk_bf16_f32 v40, v40, v41
  v_cvt_pk_bf16_f32 v41, v42, v43
  buffer_store_dwordx2 v[40:41], v2, s[12:15], s28 offen offset:8 sc1
  v_cvt_pk_bf16_f32 v44, v44, v45
  v_cvt_pk_bf16_f32 v45, v46, v47
  v_cvt_pk_bf16_f32 v46, v48, v49
  v_cvt_pk_bf16_f32 v47, v50, v51
  buffer_store_dwordx4 v[44:47], v2, s[12:15], s28 offen offset:64 sc1
  v_cvt_pk_bf16_f32 v52, v52, v53
  v_cvt_pk_bf16_f32 v53, v54, v55
  v_cvt_pk_bf16_f32 v54, v56, v57
  v_cvt_pk_bf16_f32 v55, v58, v59
  buffer_store_dwordx4 v[52:55], v2, s[12:15], s28 offen offset:128 sc1
  v_cvt_pk_bf16_f32 v60, v60, v61
  v_cvt_pk_bf16_f32 v61, v62, v63
  v_cvt_pk_bf16_f32 v62, v64, v65
  v_cvt_pk_bf16_f32 v63, v66, v67
  buffer_store_dwordx4 v[60:63], v2, s[12:15], s28 offen offset:192 sc1
  v_cvt_pk_bf16_f32 v68, v68, v69
  v_cvt_pk_bf16_f32 v69, v70, v71
  v_cvt_pk_bf16_f32 v70, v72, v73
  v_cvt_pk_bf16_f32 v71, v74, v75
  buffer_store_dwordx4 v[68:71], v2, s[12:15], s28 offen offset:256 sc1
  s_mov_b32 s28, 0x24000
  v_cvt_pk_bf16_f32 v76, v76, v77
  v_cvt_pk_bf16_f32 v77, v78, v79
  buffer_store_dwordx2 v[76:77], v2, s[12:15], s28 offen offset:8 sc1
  v_cvt_pk_bf16_f32 v80, v80, v81
  v_cvt_pk_bf16_f32 v81, v82, v83
  v_cvt_pk_bf16_f32 v82, v84, v85
  v_cvt_pk_bf16_f32 v83, v86, v87
  buffer_store_dwordx4 v[80:83], v2, s[12:15], s28 offen offset:64 sc1
  v_cvt_pk_bf16_f32 v88, v88, v89
  v_cvt_pk_bf16_f32 v89, v90, v91
  v_cvt_pk_bf16_f32 v90, v92, v93
  v_cvt_pk_bf16_f32 v91, v94, v95
  buffer_store_dwordx4 v[88:91], v2, s[12:15], s28 offen offset:128 sc1
  v_cvt_pk_bf16_f32 v96, v96, v97
  v_cvt_pk_bf16_f32 v97, v98, v99
  v_cvt_pk_bf16_f32 v98, v100, v101
  v_cvt_pk_bf16_f32 v99, v102, v103
  buffer_store_dwordx4 v[96:99], v2, s[12:15], s28 offen offset:192 sc1
  v_cvt_pk_bf16_f32 v104, v104, v105
  v_cvt_pk_bf16_f32 v105, v106, v107
  v_cvt_pk_bf16_f32 v106, v108, v109
  v_cvt_pk_bf16_f32 v107, v110, v111
  buffer_store_dwordx4 v[104:107], v2, s[12:15], s28 offen offset:256 sc1
ffn1_kernel_join3:
ffn1_kernel_end_d:
ffn1_kernel_end:
  s_endpgm
.globl ffn2_kernel
.p2align 8
.type ffn2_kernel,@function
ffn2_kernel:
  s_cmp_ge_u32 s2, 256
  s_cbranch_scc1 ffn2_kernel_end
  v_and_b32 v1, 63, v0
  v_lshrrev_b32 v2, 6, v0
  s_nop 0
  v_readfirstlane_b32 s20, v2
  s_load_dwordx2 s[36:37], s[0:1], 72
  s_load_dwordx2 s[40:41], s[0:1], 104
  s_and_b32 s44, s2, 7
  s_lshr_b32 s45, s2, 3
  s_and_b32 s42, s45, 3
  s_lshr_b32 s45, s45, 2
  s_and_b32 s46, s44, 1
  s_lshl_b32 s46, s46, 3
  s_add_u32 s45, s45, s46
  s_lshr_b32 s43, s44, 1
  s_waitcnt lgkmcnt(0)
  s_mul_i32 s46, s45, 1179648
  s_mul_i32 s47, s43, 2304
  s_add_u32 s46, s46, s47
  s_sub_u32 s47, 18874368, s46
  s_add_u32 s4, s40, 0x5ac0000
  s_addc_u32 s5, s41, 0
  s_add_u32 s4, s4, s46
  s_addc_u32 s5, s5, 0
  s_mov_b32 s6, s47
  s_mov_b32 s7, 0x00020000
  s_mul_i32 s46, s43, 1327104
  s_mul_i32 s47, s42, 288
  s_add_u32 s46, s46, s47
  s_sub_u32 s47, 5308416, s46
  s_mov_b32 s8, s36
  s_mov_b32 s9, s37
  s_add_u32 s8, s8, s46
  s_addc_u32 s9, s9, 0
  s_mov_b32 s10, s47
  s_mov_b32 s11, 0x00020000
  s_mul_i32 s46, s43, 4718592
  s_mul_i32 s47, s45, 294912
  s_add_u32 s46, s46, s47
  s_mul_i32 s47, s42, 576
  s_add_u32 s46, s46, s47
  s_sub_u32 s47, 18874368, s46
  s_add_u32 s12, s40, 0x6cc0000
  s_addc_u32 s13, s41, 0
  s_add_u32 s12, s12, s46
  s_addc_u32 s13, s13, 0
  s_mov_b32 s14, s47
  s_mov_b32 s15, 0x00020000
  s_lshl_b32 s21, s20, 10
  s_and_b32 s22, s20, 0
  s_lshr_b32 s23, s20, 0
  s_and_b32 s24, s23, 3
  s_lshr_b32 s25, s23, 2
  s_and_b32 s28, s20, 1
  s_lshl_b32 s28, s28, 2
  v_lshrrev_b32 v2, 4, v1
  v_add_u32 v2, s28, v2
  v_xor_b32 v2, v2, v1
  v_and_b32 v2, 7, v2
  v_lshlrev_b32 v2, 4, v2
  v_lshrrev_b32 v3, 3, v1
  s_lshl_b32 s28, s20, 3
  v_add_u32 v3, s28, v3
  s_mov_b32 s28, 9216
  v_mul_lo_u32 v3, v3, s28
  v_add_u32 v5, v3, v2
  v_add_u32 v6, 0x90000, v5
  s_mov_b32 s29, 1152
  s_lshl_b32 s28, s20, 6
  s_add_u32 s28, s28, 0
  v_add_u32 v2, s28, v1
  v_mul_u32_u24 v3, 3641, v2
  v_lshrrev_b32 v3, 16, v3
  v_mul_u32_u24 v4, 18, v3
  v_sub_u32 v2, v2, v4
  v_lshlrev_b32 v2, 4, v2
  v_mul_lo_u32 v3, v3, s29
  v_add_u32 v7, v3, v2
  s_lshl_b32 s28, s20, 6
  s_add_u32 s28, s28, 512
  v_add_u32 v2, s28, v1
  v_mul_u32_u24 v3, 3641, v2
  v_lshrrev_b32 v3, 16, v3
  v_mul_u32_u24 v4, 18, v3
  v_sub_u32 v2, v2, v4
  v_lshlrev_b32 v2, 4, v2
  v_mul_lo_u32 v3, v3, s29
  v_add_u32 v8, v3, v2
  s_lshl_b32 s28, s20, 6
  s_add_u32 s28, s28, 1024
  v_add_u32 v2, s28, v1
  v_mul_u32_u24 v3, 3641, v2
  v_lshrrev_b32 v3, 16, v3
  v_mul_u32_u24 v4, 18, v3
  v_sub_u32 v2, v2, v4
  v_lshlrev_b32 v2, 4, v2
  v_mul_lo_u32 v3, v3, s29
  v_add_u32 v9, v3, v2
  s_mov_b32 s30, 0
  s_mov_b32 s31, 0
  v_lshrrev_b32 v10, 4, v1
  v_and_b32 v2, 15, v1
  v_lshrrev_b32 v3, 1, v2
  v_xor_b32 v3, v3, v10
  s_lshl_b32 s28, s25, 2
  v_xor_b32 v3, s28, v3
  v_lshlrev_b32 v3, 4, v3
  s_mul_i32 s28, s24, 4096
  v_lshl_add_u32 v3, v2, 7, v3
  v_add_u32 v11, s28, v3
  v_bfe_u32 v2, v1, 2, 2
  v_and_b32 v3, 3, v1
  v_lshlrev_b32 v3, 3, v3
  v_lshl_add_u32 v4, v10, 2, v2
  v_mul_u32_u24 v2, 288, v4
  v_add_u32 v12, v2, v3
  s_mul_i32 s28, s25, 9216
  s_add_u32 s28, s28, 0x10000
  v_add_u32 v12, s28, v12
  s_add_u32 m0, s21, 0x0
  s_nop 0
  buffer_load_dwordx4 v5, s[4:7], s30 offen lds
  s_add_u32 m0, s21, 0x2000
  s_nop 0
  buffer_load_dwordx4 v6, s[4:7], s30 offen lds
  s_add_u32 s30, s30, 128
  s_cmp_lt_u32 s20, 2
  s_cbranch_scc0 1f
  s_add_u32 m0, s21, 0x14000
  s_nop 0
  buffer_load_dwordx4 v9, s[8:11], s31 offen lds
1:
  s_add_u32 m0, s21, 0x10000
  s_nop 0
  buffer_load_dwordx4 v7, s[8:11], s31 offen lds
  s_add_u32 m0, s21, 0x12000
  s_nop 0
  buffer_load_dwordx4 v8, s[8:11], s31 offen lds
  s_add_u32 s31, s31, 0x12000
  s_add_u32 m0, s21, 0x4000
  s_nop 0
  buffer_load_dwordx4 v5, s[4:7], s30 offen lds
  s_add_u32 m0, s21, 0x6000
  s_nop 0
  buffer_load_dwordx4 v6, s[4:7], s30 offen lds
  s_add_u32 s30, s30, 128
  s_cmp_lt_u32 s20, 2
  s_cbranch_scc0 1f
  s_add_u32 m0, s21, 0x18800
  s_nop 0
  buffer_load_dwordx4 v9, s[8:11], s31 offen lds
1:
  s_add_u32 m0, s21, 0x14800
  s_nop 0
  buffer_load_dwordx4 v7, s[8:11], s31 offen lds
  s_add_u32 m0, s21, 0x16800
  s_nop 0
  buffer_load_dwordx4 v8, s[8:11], s31 offen lds
  s_add_u32 s31, s31, 0x12000
  s_add_u32 m0, s21, 0x8000
  s_nop 0
  buffer_load_dwordx4 v5, s[4:7], s30 offen lds
  s_add_u32 m0, s21, 0xa000
  s_nop 0
  buffer_load_dwordx4 v6, s[4:7], s30 offen lds
  s_add_u32 s30, s30, 128
  s_cmp_lt_u32 s20, 2
  s_cbranch_scc0 1f
  s_add_u32 m0, s21, 0x1d000
  s_nop 0
  buffer_load_dwordx4 v9, s[8:11], s31 offen lds
1:
  s_add_u32 m0, s21, 0x19000
  s_nop 0
  buffer_load_dwordx4 v7, s[8:11], s31 offen lds
  s_add_u32 m0, s21, 0x1b000
  s_nop 0
  buffer_load_dwordx4 v8, s[8:11], s31 offen lds
  s_add_u32 s31, s31, 0x12000
  s_add_u32 m0, s21, 0xc000
  s_nop 0
  buffer_load_dwordx4 v5, s[4:7], s30 offen lds
  s_add_u32 m0, s21, 0xe000
  s_nop 0
  buffer_load_dwordx4 v6, s[4:7], s30 offen lds
  s_add_u32 s30, s30, 128
  s_cmp_lt_u32 s20, 2
  s_cbranch_scc0 1f
  s_add_u32 m0, s21, 0x21800
  s_nop 0
  buffer_load_dwordx4 v9, s[8:11], s31 offen lds
1:
  s_add_u32 m0, s21, 0x1d800
  s_nop 0
  buffer_load_dwordx4 v7, s[8:11], s31 offen lds
  s_add_u32 m0, s21, 0x1f800
  s_nop 0
  buffer_load_dwordx4 v8, s[8:11], s31 offen lds
  s_add_u32 s31, s31, 0x12000
  s_waitcnt vmcnt(8)
  s_barrier
  ds_read_b128 v[112:115], v11 offset:0
  ds_read_b64_tr_b16 v[88:89], v12 offset:0
  ds_read_b64_tr_b16 v[90:91], v12 offset:4608
  ds_read_b128 v[116:119], v11 offset:2048
  ds_read_b64_tr_b16 v[92:93], v12 offset:32
  ds_read_b64_tr_b16 v[94:95], v12 offset:4640
  ds_read_b64_tr_b16 v[96:97], v12 offset:64
  ds_read_b64_tr_b16 v[98:99], v12 offset:4672
  ds_read_b64_tr_b16 v[100:101], v12 offset:96
  ds_read_b64_tr_b16 v[102:103], v12 offset:4704
  ds_read_b64_tr_b16 v[104:105], v12 offset:128
  ds_read_b64_tr_b16 v[106:107], v12 offset:4736
  s_waitcnt lgkmcnt(9)
  v_mfma_f32_16x16x32_bf16 v[16:19], v[88:91], v[112:115], 0
  s_waitcnt lgkmcnt(8)
  v_mfma_f32_16x16x32_bf16 v[52:55], v[88:91], v[116:119], 0
  ds_read_b64_tr_b16 v[108:109], v12 offset:160
  ds_read_b64_tr_b16 v[110:111], v12 offset:4768
  s_waitcnt lgkmcnt(8)
  v_mfma_f32_16x16x32_bf16 v[20:23], v[92:95], v[112:115], 0
  v_mfma_f32_16x16x32_bf16 v[56:59], v[92:95], v[116:119], 0
  ds_read_b64_tr_b16 v[88:89], v12 offset:192
  ds_read_b64_tr_b16 v[90:91], v12 offset:4800
  s_waitcnt lgkmcnt(8)
  v_mfma_f32_16x16x32_bf16 v[24:27], v[96:99], v[112:115], 0
  v_mfma_f32_16x16x32_bf16 v[60:63], v[96:99], v[116:119], 0
  ds_read_b64_tr_b16 v[92:93], v12 offset:224
  ds_read_b64_tr_b16 v[94:95], v12 offset:4832
  s_waitcnt lgkmcnt(8)
  v_mfma_f32_16x16x32_bf16 v[28:31], v[100:103], v[112:115], 0
  v_mfma_f32_16x16x32_bf16 v[64:67], v[100:103], v[116:119], 0
  ds_read_b64_tr_b16 v[96:97], v12 offset:256
  ds_read_b64_tr_b16 v[98:99], v12 offset:4864
  s_waitcnt lgkmcnt(8)
  v_mfma_f32_16x16x32_bf16 v[32:35], v[104:107], v[112:115], 0
  v_mfma_f32_16x16x32_bf16 v[68:71], v[104:107], v[116:119], 0
  s_waitcnt lgkmcnt(6)
  v_mfma_f32_16x16x32_bf16 v[36:39], v[108:111], v[112:115], 0
  v_mfma_f32_16x16x32_bf16 v[72:75], v[108:111], v[116:119], 0
  v_add_u32 v11, 0x4000, v11
  v_add_u32 v12, 0x4800, v12
  ds_read_b128 v[120:123], v11 offset:0
  ds_read_b64_tr_b16 v[100:101], v12 offset:0
  ds_read_b64_tr_b16 v[102:103], v12 offset:4608
  ds_read_b128 v[124:127], v11 offset:2048
  ds_read_b64_tr_b16 v[104:105], v12 offset:32
  ds_read_b64_tr_b16 v[106:107], v12 offset:4640
  s_waitcnt lgkmcnt(10)
  v_mfma_f32_16x16x32_bf16 v[40:43], v[88:91], v[112:115], 0
  v_mfma_f32_16x16x32_bf16 v[76:79], v[88:91], v[116:119], 0
  ds_read_b64_tr_b16 v[108:109], v12 offset:64
  ds_read_b64_tr_b16 v[110:111], v12 offset:4672
  s_waitcnt lgkmcnt(10)
  v_mfma_f32_16x16x32_bf16 v[44:47], v[92:95], v[112:115], 0
  v_mfma_f32_16x16x32_bf16 v[80:83], v[92:95], v[116:119], 0
  ds_read_b64_tr_b16 v[88:89], v12 offset:96
  ds_read_b64_tr_b16 v[90:91], v12 offset:4704
  s_waitcnt lgkmcnt(10)
  v_mfma_f32_16x16x32_bf16 v[48:51], v[96:99], v[112:115], 0
  v_mfma_f32_16x16x32_bf16 v[84:87], v[96:99], v[116:119], 0
  ds_read_b64_tr_b16 v[92:93], v12 offset:128
  ds_read_b64_tr_b16 v[94:95], v12 offset:4736
  s_waitcnt lgkmcnt(9)
  v_mfma_f32_16x16x32_bf16 v[16:19], v[100:103], v[120:123], v[16:19]
  s_waitcnt lgkmcnt(8)
  v_mfma_f32_16x16x32_bf16 v[52:55], v[100:103], v[124:127], v[52:55]
  ds_read_b64_tr_b16 v[96:97], v12 offset:160
  ds_read_b64_tr_b16 v[98:99], v12 offset:4768
  s_waitcnt lgkmcnt(8)
  v_mfma_f32_16x16x32_bf16 v[20:23], v[104:107], v[120:123], v[20:23]
  v_mfma_f32_16x16x32_bf16 v[56:59], v[104:107], v[124:127], v[56:59]
  ds_read_b64_tr_b16 v[100:101], v12 offset:192
  ds_read_b64_tr_b16 v[102:103], v12 offset:4800
  s_waitcnt lgkmcnt(8)
  v_mfma_f32_16x16x32_bf16 v[24:27], v[108:111], v[120:123], v[24:27]
  v_mfma_f32_16x16x32_bf16 v[60:63], v[108:111], v[124:127], v[60:63]
  ds_read_b64_tr_b16 v[104:105], v12 offset:224
  ds_read_b64_tr_b16 v[106:107], v12 offset:4832
  s_waitcnt lgkmcnt(8)
  v_mfma_f32_16x16x32_bf16 v[28:31], v[88:91], v[120:123], v[28:31]
  v_mfma_f32_16x16x32_bf16 v[64:67], v[88:91], v[124:127], v[64:67]
  ds_read_b64_tr_b16 v[108:109], v12 offset:256
  ds_read_b64_tr_b16 v[110:111], v12 offset:4864
  s_waitcnt lgkmcnt(8)
  v_mfma_f32_16x16x32_bf16 v[32:35], v[92:95], v[120:123], v[32:35]
  v_mfma_f32_16x16x32_bf16 v[68:71], v[92:95], v[124:127], v[68:71]
  s_waitcnt lgkmcnt(6)
  v_mfma_f32_16x16x32_bf16 v[36:39], v[96:99], v[120:123], v[36:39]
  v_mfma_f32_16x16x32_bf16 v[72:75], v[96:99], v[124:127], v[72:75]
  s_mov_b32 s33, 3
ffn2_kernel_loop1:
  s_waitcnt vmcnt(0) lgkmcnt(0)
  s_barrier
  v_add_u32 v11, 0x4000, v11
  v_add_u32 v12, 0x4800, v12
  ds_read_b128 v[112:115], v11 offset:0
  ds_read_b64_tr_b16 v[88:89], v12 offset:0
  ds_read_b64_tr_b16 v[90:91], v12 offset:4608
  ds_read_b128 v[116:119], v11 offset:2048
  ds_read_b64_tr_b16 v[92:93], v12 offset:32
  ds_read_b64_tr_b16 v[94:95], v12 offset:4640
  v_mfma_f32_16x16x32_bf16 v[40:43], v[100:103], v[120:123], v[40:43]
  s_add_u32 m0, s21, 0x0
  s_nop 0
  buffer_load_dwordx4 v5, s[4:7], s30 offen lds
  v_mfma_f32_16x16x32_bf16 v[76:79], v[100:103], v[124:127], v[76:79]
  s_add_u32 m0, s21, 0x2000
  s_nop 0
  buffer_load_dwordx4 v6, s[4:7], s30 offen lds
  s_add_u32 s30, s30, 128
  ds_read_b64_tr_b16 v[96:97], v12 offset:64
  ds_read_b64_tr_b16 v[98:99], v12 offset:4672
  v_mfma_f32_16x16x32_bf16 v[44:47], v[104:107], v[120:123], v[44:47]
  s_cmp_lt_u32 s20, 2
  s_cbranch_scc0 1f
  s_add_u32 m0, s21, 0x14000
  s_nop 0
  buffer_load_dwordx4 v9, s[8:11], s31 offen lds
1:
  v_mfma_f32_16x16x32_bf16 v[80:83], v[104:107], v[124:127], v[80:83]
  s_add_u32 m0, s21, 0x10000
  s_nop 0
  buffer_load_dwordx4 v7, s[8:11], s31 offen lds
  ds_read_b64_tr_b16 v[100:101], v12 offset:96
  ds_read_b64_tr_b16 v[102:103], v12 offset:4704
  v_mfma_f32_16x16x32_bf16 v[48:51], v[108:111], v[120:123], v[48:51]
  s_add_u32 m0, s21, 0x12000
  s_nop 0
  buffer_load_dwordx4 v8, s[8:11], s31 offen lds
  s_add_u32 s31, s31, 0x12000
  v_mfma_f32_16x16x32_bf16 v[84:87], v[108:111], v[124:127], v[84:87]
  s_add_u32 m0, s21, 0x4000
  s_nop 0
  buffer_load_dwordx4 v5, s[4:7], s30 offen lds
  ds_read_b64_tr_b16 v[104:105], v12 offset:128
  ds_read_b64_tr_b16 v[106:107], v12 offset:4736
  s_waitcnt lgkmcnt(9)
  v_mfma_f32_16x16x32_bf16 v[16:19], v[88:91], v[112:115], v[16:19]
  s_add_u32 m0, s21, 0x6000
  s_nop 0
  buffer_load_dwordx4 v6, s[4:7], s30 offen lds
  s_add_u32 s30, s30, 128
  s_waitcnt lgkmcnt(8)
  v_mfma_f32_16x16x32_bf16 v[52:55], v[88:91], v[116:119], v[52:55]
  s_cmp_lt_u32 s20, 2
  s_cbranch_scc0 1f
  s_add_u32 m0, s21, 0x18800
  s_nop 0
  buffer_load_dwordx4 v9, s[8:11], s31 offen lds
1:
  ds_read_b64_tr_b16 v[108:109], v12 offset:160
  ds_read_b64_tr_b16 v[110:111], v12 offset:4768
  s_waitcnt lgkmcnt(8)
  v_mfma_f32_16x16x32_bf16 v[20:23], v[92:95], v[112:115], v[20:23]
  s_add_u32 m0, s21, 0x14800
  s_nop 0
  buffer_load_dwordx4 v7, s[8:11], s31 offen lds
  v_mfma_f32_16x16x32_bf16 v[56:59], v[92:95], v[116:119], v[56:59]
  s_add_u32 m0, s21, 0x16800
  s_nop 0
  buffer_load_dwordx4 v8, s[8:11], s31 offen lds
  s_add_u32 s31, s31, 0x12000
  ds_read_b64_tr_b16 v[88:89], v12 offset:192
  ds_read_b64_tr_b16 v[90:91], v12 offset:4800
  s_waitcnt lgkmcnt(8)
  v_mfma_f32_16x16x32_bf16 v[24:27], v[96:99], v[112:115], v[24:27]
  v_mfma_f32_16x16x32_bf16 v[60:63], v[96:99], v[116:119], v[60:63]
  ds_read_b64_tr_b16 v[92:93], v12 offset:224
  ds_read_b64_tr_b16 v[94:95], v12 offset:4832
  s_waitcnt lgkmcnt(8)
  v_mfma_f32_16x16x32_bf16 v[28:31], v[100:103], v[112:115], v[28:31]
  v_mfma_f32_16x16x32_bf16 v[64:67], v[100:103], v[116:119], v[64:67]
  ds_read_b64_tr_b16 v[96:97], v12 offset:256
  ds_read_b64_tr_b16 v[98:99], v12 offset:4864
  s_waitcnt lgkmcnt(8)
  v_mfma_f32_16x16x32_bf16 v[32:35], v[104:107], v[112:115], v[32:35]
  v_mfma_f32_16x16x32_bf16 v[68:71], v[104:107], v[116:119], v[68:71]
  s_waitcnt lgkmcnt(6)
  v_mfma_f32_16x16x32_bf16 v[36:39], v[108:111], v[112:115], v[36:39]
  v_mfma_f32_16x16x32_bf16 v[72:75], v[108:111], v[116:119], v[72:75]
  v_add_u32 v11, 0x4000, v11
  v_add_u32 v12, 0x4800, v12
  ds_read_b128 v[120:123], v11 offset:0
  ds_read_b64_tr_b16 v[100:101], v12 offset:0
  ds_read_b64_tr_b16 v[102:103], v12 offset:4608
  ds_read_b128 v[124:127], v11 offset:2048
  ds_read_b64_tr_b16 v[104:105], v12 offset:32
  ds_read_b64_tr_b16 v[106:107], v12 offset:4640
  s_waitcnt lgkmcnt(10)
  v_mfma_f32_16x16x32_bf16 v[40:43], v[88:91], v[112:115], v[40:43]
  v_mfma_f32_16x16x32_bf16 v[76:79], v[88:91], v[116:119], v[76:79]
  ds_read_b64_tr_b16 v[108:109], v12 offset:64
  ds_read_b64_tr_b16 v[110:111], v12 offset:4672
  s_waitcnt lgkmcnt(10)
  v_mfma_f32_16x16x32_bf16 v[44:47], v[92:95], v[112:115], v[44:47]
  v_mfma_f32_16x16x32_bf16 v[80:83], v[92:95], v[116:119], v[80:83]
  ds_read_b64_tr_b16 v[88:89], v12 offset:96
  ds_read_b64_tr_b16 v[90:91], v12 offset:4704
  s_waitcnt lgkmcnt(10)
  v_mfma_f32_16x16x32_bf16 v[48:51], v[96:99], v[112:115], v[48:51]
  v_mfma_f32_16x16x32_bf16 v[84:87], v[96:99], v[116:119], v[84:87]
  ds_read_b64_tr_b16 v[92:93], v12 offset:128
  ds_read_b64_tr_b16 v[94:95], v12 offset:4736
  s_waitcnt lgkmcnt(9)
  v_mfma_f32_16x16x32_bf16 v[16:19], v[100:103], v[120:123], v[16:19]
  s_waitcnt lgkmcnt(8)
  v_mfma_f32_16x16x32_bf16 v[52:55], v[100:103], v[124:127], v[52:55]
  ds_read_b64_tr_b16 v[96:97], v12 offset:160
  ds_read_b64_tr_b16 v[98:99], v12 offset:4768
  s_waitcnt lgkmcnt(8)
  v_mfma_f32_16x16x32_bf16 v[20:23], v[104:107], v[120:123], v[20:23]
  v_mfma_f32_16x16x32_bf16 v[56:59], v[104:107], v[124:127], v[56:59]
  ds_read_b64_tr_b16 v[100:101], v12 offset:192
  ds_read_b64_tr_b16 v[102:103], v12 offset:4800
  s_waitcnt lgkmcnt(8)
  v_mfma_f32_16x16x32_bf16 v[24:27], v[108:111], v[120:123], v[24:27]
  v_mfma_f32_16x16x32_bf16 v[60:63], v[108:111], v[124:127], v[60:63]
  ds_read_b64_tr_b16 v[104:105], v12 offset:224
  ds_read_b64_tr_b16 v[106:107], v12 offset:4832
  s_waitcnt lgkmcnt(8)
  v_mfma_f32_16x16x32_bf16 v[28:31], v[88:91], v[120:123], v[28:31]
  v_mfma_f32_16x16x32_bf16 v[64:67], v[88:91], v[124:127], v[64:67]
  ds_read_b64_tr_b16 v[108:109], v12 offset:256
  ds_read_b64_tr_b16 v[110:111], v12 offset:4864
  s_waitcnt lgkmcnt(8)
  v_mfma_f32_16x16x32_bf16 v[32:35], v[92:95], v[120:123], v[32:35]
  v_mfma_f32_16x16x32_bf16 v[68:71], v[92:95], v[124:127], v[68:71]
  s_waitcnt lgkmcnt(6)
  v_mfma_f32_16x16x32_bf16 v[36:39], v[96:99], v[120:123], v[36:39]
  v_mfma_f32_16x16x32_bf16 v[72:75], v[96:99], v[124:127], v[72:75]
  s_waitcnt vmcnt(0) lgkmcnt(0)
  s_barrier
  v_subrev_u32 v11, 0xc000, v11
  v_subrev_u32 v12, 0xd800, v12
  ds_read_b128 v[112:115], v11 offset:0
  ds_read_b64_tr_b16 v[88:89], v12 offset:0
  ds_read_b64_tr_b16 v[90:91], v12 offset:4608
  ds_read_b128 v[116:119], v11 offset:2048
  ds_read_b64_tr_b16 v[92:93], v12 offset:32
  ds_read_b64_tr_b16 v[94:95], v12 offset:4640
  v_mfma_f32_16x16x32_bf16 v[40:43], v[100:103], v[120:123], v[40:43]
  s_add_u32 m0, s21, 0x8000
  s_nop 0
  buffer_load_dwordx4 v5, s[4:7], s30 offen lds
  v_mfma_f32_16x16x32_bf16 v[76:79], v[100:103], v[124:127], v[76:79]
  s_add_u32 m0, s21, 0xa000
  s_nop 0
  buffer_load_dwordx4 v6, s[4:7], s30 offen lds
  s_add_u32 s30, s30, 128
  ds_read_b64_tr_b16 v[96:97], v12 offset:64
  ds_read_b64_tr_b16 v[98:99], v12 offset:4672
  v_mfma_f32_16x16x32_bf16 v[44:47], v[104:107], v[120:123], v[44:47]
  s_cmp_lt_u32 s20, 2
  s_cbranch_scc0 1f
  s_add_u32 m0, s21, 0x1d000
  s_nop 0
  buffer_load_dwordx4 v9, s[8:11], s31 offen lds
1:
  v_mfma_f32_16x16x32_bf16 v[80:83], v[104:107], v[124:127], v[80:83]
  s_add_u32 m0, s21, 0x19000
  s_nop 0
  buffer_load_dwordx4 v7, s[8:11], s31 offen lds
  ds_read_b64_tr_b16 v[100:101], v12 offset:96
  ds_read_b64_tr_b16 v[102:103], v12 offset:4704
  v_mfma_f32_16x16x32_bf16 v[48:51], v[108:111], v[120:123], v[48:51]
  s_add_u32 m0, s21, 0x1b000
  s_nop 0
  buffer_load_dwordx4 v8, s[8:11], s31 offen lds
  s_add_u32 s31, s31, 0x12000
  v_mfma_f32_16x16x32_bf16 v[84:87], v[108:111], v[124:127], v[84:87]
  s_add_u32 m0, s21, 0xc000
  s_nop 0
  buffer_load_dwordx4 v5, s[4:7], s30 offen lds
  ds_read_b64_tr_b16 v[104:105], v12 offset:128
  ds_read_b64_tr_b16 v[106:107], v12 offset:4736
  s_waitcnt lgkmcnt(9)
  v_mfma_f32_16x16x32_bf16 v[16:19], v[88:91], v[112:115], v[16:19]
  s_add_u32 m0, s21, 0xe000
  s_nop 0
  buffer_load_dwordx4 v6, s[4:7], s30 offen lds
  s_add_u32 s30, s30, 128
  s_waitcnt lgkmcnt(8)
  v_mfma_f32_16x16x32_bf16 v[52:55], v[88:91], v[116:119], v[52:55]
  s_cmp_lt_u32 s20, 2
  s_cbranch_scc0 1f
  s_add_u32 m0, s21, 0x21800
  s_nop 0
  buffer_load_dwordx4 v9, s[8:11], s31 offen lds
1:
  ds_read_b64_tr_b16 v[108:109], v12 offset:160
  ds_read_b64_tr_b16 v[110:111], v12 offset:4768
  s_waitcnt lgkmcnt(8)
  v_mfma_f32_16x16x32_bf16 v[20:23], v[92:95], v[112:115], v[20:23]
  s_add_u32 m0, s21, 0x1d800
  s_nop 0
  buffer_load_dwordx4 v7, s[8:11], s31 offen lds
  v_mfma_f32_16x16x32_bf16 v[56:59], v[92:95], v[116:119], v[56:59]
  s_add_u32 m0, s21, 0x1f800
  s_nop 0
  buffer_load_dwordx4 v8, s[8:11], s31 offen lds
  s_add_u32 s31, s31, 0x12000
  ds_read_b64_tr_b16 v[88:89], v12 offset:192
  ds_read_b64_tr_b16 v[90:91], v12 offset:4800
  s_waitcnt lgkmcnt(8)
  v_mfma_f32_16x16x32_bf16 v[24:27], v[96:99], v[112:115], v[24:27]
  v_mfma_f32_16x16x32_bf16 v[60:63], v[96:99], v[116:119], v[60:63]
  ds_read_b64_tr_b16 v[92:93], v12 offset:224
  ds_read_b64_tr_b16 v[94:95], v12 offset:4832
  s_waitcnt lgkmcnt(8)
  v_mfma_f32_16x16x32_bf16 v[28:31], v[100:103], v[112:115], v[28:31]
  v_mfma_f32_16x16x32_bf16 v[64:67], v[100:103], v[116:119], v[64:67]
  ds_read_b64_tr_b16 v[96:97], v12 offset:256
  ds_read_b64_tr_b16 v[98:99], v12 offset:4864
  s_waitcnt lgkmcnt(8)
  v_mfma_f32_16x16x32_bf16 v[32:35], v[104:107], v[112:115], v[32:35]
  v_mfma_f32_16x16x32_bf16 v[68:71], v[104:107], v[116:119], v[68:71]
  s_waitcnt lgkmcnt(6)
  v_mfma_f32_16x16x32_bf16 v[36:39], v[108:111], v[112:115], v[36:39]
  v_mfma_f32_16x16x32_bf16 v[72:75], v[108:111], v[116:119], v[72:75]
  v_add_u32 v11, 0x4000, v11
  v_add_u32 v12, 0x4800, v12
  ds_read_b128 v[120:123], v11 offset:0
  ds_read_b64_tr_b16 v[100:101], v12 offset:0
  ds_read_b64_tr_b16 v[102:103], v12 offset:4608
  ds_read_b128 v[124:127], v11 offset:2048
  ds_read_b64_tr_b16 v[104:105], v12 offset:32
  ds_read_b64_tr_b16 v[106:107], v12 offset:4640
  s_waitcnt lgkmcnt(10)
  v_mfma_f32_16x16x32_bf16 v[40:43], v[88:91], v[112:115], v[40:43]
  v_mfma_f32_16x16x32_bf16 v[76:79], v[88:91], v[116:119], v[76:79]
  ds_read_b64_tr_b16 v[108:109], v12 offset:64
  ds_read_b64_tr_b16 v[110:111], v12 offset:4672
  s_waitcnt lgkmcnt(10)
  v_mfma_f32_16x16x32_bf16 v[44:47], v[92:95], v[112:115], v[44:47]
  v_mfma_f32_16x16x32_bf16 v[80:83], v[92:95], v[116:119], v[80:83]
  ds_read_b64_tr_b16 v[88:89], v12 offset:96
  ds_read_b64_tr_b16 v[90:91], v12 offset:4704
  s_waitcnt lgkmcnt(10)
  v_mfma_f32_16x16x32_bf16 v[48:51], v[96:99], v[112:115], v[48:51]
  v_mfma_f32_16x16x32_bf16 v[84:87], v[96:99], v[116:119], v[84:87]
  ds_read_b64_tr_b16 v[92:93], v12 offset:128
  ds_read_b64_tr_b16 v[94:95], v12 offset:4736
  s_waitcnt lgkmcnt(9)
  v_mfma_f32_16x16x32_bf16 v[16:19], v[100:103], v[120:123], v[16:19]
  s_waitcnt lgkmcnt(8)
  v_mfma_f32_16x16x32_bf16 v[52:55], v[100:103], v[124:127], v[52:55]
  ds_read_b64_tr_b16 v[96:97], v12 offset:160
  ds_read_b64_tr_b16 v[98:99], v12 offset:4768
  s_waitcnt lgkmcnt(8)
  v_mfma_f32_16x16x32_bf16 v[20:23], v[104:107], v[120:123], v[20:23]
  v_mfma_f32_16x16x32_bf16 v[56:59], v[104:107], v[124:127], v[56:59]
  ds_read_b64_tr_b16 v[100:101], v12 offset:192
  ds_read_b64_tr_b16 v[102:103], v12 offset:4800
  s_waitcnt lgkmcnt(8)
  v_mfma_f32_16x16x32_bf16 v[24:27], v[108:111], v[120:123], v[24:27]
  v_mfma_f32_16x16x32_bf16 v[60:63], v[108:111], v[124:127], v[60:63]
  ds_read_b64_tr_b16 v[104:105], v12 offset:224
  ds_read_b64_tr_b16 v[106:107], v12 offset:4832
  s_waitcnt lgkmcnt(8)
  v_mfma_f32_16x16x32_bf16 v[28:31], v[88:91], v[120:123], v[28:31]
  v_mfma_f32_16x16x32_bf16 v[64:67], v[88:91], v[124:127], v[64:67]
  ds_read_b64_tr_b16 v[108:109], v12 offset:256
  ds_read_b64_tr_b16 v[110:111], v12 offset:4864
  s_waitcnt lgkmcnt(8)
  v_mfma_f32_16x16x32_bf16 v[32:35], v[92:95], v[120:123], v[32:35]
  v_mfma_f32_16x16x32_bf16 v[68:71], v[92:95], v[124:127], v[68:71]
  s_waitcnt lgkmcnt(6)
  v_mfma_f32_16x16x32_bf16 v[36:39], v[96:99], v[120:123], v[36:39]
  v_mfma_f32_16x16x32_bf16 v[72:75], v[96:99], v[124:127], v[72:75]
  s_sub_u32 s33, s33, 1
  s_cmp_lg_u32 s33, 0
  s_cbranch_scc1 ffn2_kernel_loop1
  s_waitcnt vmcnt(0) lgkmcnt(0)
  s_barrier
  v_add_u32 v11, 0x4000, v11
  v_add_u32 v12, 0x4800, v12
  ds_read_b128 v[112:115], v11 offset:0
  ds_read_b64_tr_b16 v[88:89], v12 offset:0
  ds_read_b64_tr_b16 v[90:91], v12 offset:4608
  ds_read_b128 v[116:119], v11 offset:2048
  ds_read_b64_tr_b16 v[92:93], v12 offset:32
  ds_read_b64_tr_b16 v[94:95], v12 offset:4640
  v_mfma_f32_16x16x32_bf16 v[40:43], v[100:103], v[120:123], v[40:43]
  s_add_u32 m0, s21, 0x0
  s_nop 0
  buffer_load_dwordx4 v5, s[4:7], s30 offen lds
  v_mfma_f32_16x16x32_bf16 v[76:79], v[100:103], v[124:127], v[76:79]
  s_add_u32 m0, s21, 0x2000
  s_nop 0
  buffer_load_dwordx4 v6, s[4:7], s30 offen lds
  s_add_u32 s30, s30, 128
  ds_read_b64_tr_b16 v[96:97], v12 offset:64
  ds_read_b64_tr_b16 v[98:99], v12 offset:4672
  v_mfma_f32_16x16x32_bf16 v[44:47], v[104:107], v[120:123], v[44:47]
  s_cmp_lt_u32 s20, 2
  s_cbranch_scc0 1f
  s_add_u32 m0, s21, 0x14000
  s_nop 0
  buffer_load_dwordx4 v9, s[8:11], s31 offen lds
1:
  v_mfma_f32_16x16x32_bf16 v[80:83], v[104:107], v[124:127], v[80:83]
  s_add_u32 m0, s21, 0x10000
  s_nop 0
  buffer_load_dwordx4 v7, s[8:11], s31 offen lds
  ds_read_b64_tr_b16 v[100:101], v12 offset:96
  ds_read_b64_tr_b16 v[102:103], v12 offset:4704
  v_mfma_f32_16x16x32_bf16 v[48:51], v[108:111], v[120:123], v[48:51]
  s_add_u32 m0, s21, 0x12000
  s_nop 0
  buffer_load_dwordx4 v8, s[8:11], s31 offen lds
  s_add_u32 s31, s31, 0x12000
  v_mfma_f32_16x16x32_bf16 v[84:87], v[108:111], v[124:127], v[84:87]
  s_add_u32 m0, s21, 0x4000
  s_nop 0
  buffer_load_dwordx4 v5, s[4:7], s30 offen lds
  ds_read_b64_tr_b16 v[104:105], v12 offset:128
  ds_read_b64_tr_b16 v[106:107], v12 offset:4736
  s_waitcnt lgkmcnt(9)
  v_mfma_f32_16x16x32_bf16 v[16:19], v[88:91], v[112:115], v[16:19]
  s_add_u32 m0, s21, 0x6000
  s_nop 0
  buffer_load_dwordx4 v6, s[4:7], s30 offen lds
  s_add_u32 s30, s30, 128
  s_waitcnt lgkmcnt(8)
  v_mfma_f32_16x16x32_bf16 v[52:55], v[88:91], v[116:119], v[52:55]
  s_cmp_lt_u32 s20, 2
  s_cbranch_scc0 1f
  s_add_u32 m0, s21, 0x18800
  s_nop 0
  buffer_load_dwordx4 v9, s[8:11], s31 offen lds
1:
  ds_read_b64_tr_b16 v[108:109], v12 offset:160
  ds_read_b64_tr_b16 v[110:111], v12 offset:4768
  s_waitcnt lgkmcnt(8)
  v_mfma_f32_16x16x32_bf16 v[20:23], v[92:95], v[112:115], v[20:23]
  s_add_u32 m0, s21, 0x14800
  s_nop 0
  buffer_load_dwordx4 v7, s[8:11], s31 offen lds
  v_mfma_f32_16x16x32_bf16 v[56:59], v[92:95], v[116:119], v[56:59]
  s_add_u32 m0, s21, 0x16800
  s_nop 0
  buffer_load_dwordx4 v8, s[8:11], s31 offen lds
  s_add_u32 s31, s31, 0x12000
  ds_read_b64_tr_b16 v[88:89], v12 offset:192
  ds_read_b64_tr_b16 v[90:91], v12 offset:4800
  s_waitcnt lgkmcnt(8)
  v_mfma_f32_16x16x32_bf16 v[24:27], v[96:99], v[112:115], v[24:27]
  v_mfma_f32_16x16x32_bf16 v[60:63], v[96:99], v[116:119], v[60:63]
  ds_read_b64_tr_b16 v[92:93], v12 offset:224
  ds_read_b64_tr_b16 v[94:95], v12 offset:4832
  s_waitcnt lgkmcnt(8)
  v_mfma_f32_16x16x32_bf16 v[28:31], v[100:103], v[112:115], v[28:31]
  v_mfma_f32_16x16x32_bf16 v[64:67], v[100:103], v[116:119], v[64:67]
  ds_read_b64_tr_b16 v[96:97], v12 offset:256
  ds_read_b64_tr_b16 v[98:99], v12 offset:4864
  s_waitcnt lgkmcnt(8)
  v_mfma_f32_16x16x32_bf16 v[32:35], v[104:107], v[112:115], v[32:35]
  v_mfma_f32_16x16x32_bf16 v[68:71], v[104:107], v[116:119], v[68:71]
  s_waitcnt lgkmcnt(6)
  v_mfma_f32_16x16x32_bf16 v[36:39], v[108:111], v[112:115], v[36:39]
  v_mfma_f32_16x16x32_bf16 v[72:75], v[108:111], v[116:119], v[72:75]
  v_add_u32 v11, 0x4000, v11
  v_add_u32 v12, 0x4800, v12
  ds_read_b128 v[120:123], v11 offset:0
  ds_read_b64_tr_b16 v[100:101], v12 offset:0
  ds_read_b64_tr_b16 v[102:103], v12 offset:4608
  ds_read_b128 v[124:127], v11 offset:2048
  ds_read_b64_tr_b16 v[104:105], v12 offset:32
  ds_read_b64_tr_b16 v[106:107], v12 offset:4640
  s_waitcnt lgkmcnt(10)
  v_mfma_f32_16x16x32_bf16 v[40:43], v[88:91], v[112:115], v[40:43]
  v_mfma_f32_16x16x32_bf16 v[76:79], v[88:91], v[116:119], v[76:79]
  ds_read_b64_tr_b16 v[108:109], v12 offset:64
  ds_read_b64_tr_b16 v[110:111], v12 offset:4672
  s_waitcnt lgkmcnt(10)
  v_mfma_f32_16x16x32_bf16 v[44:47], v[92:95], v[112:115], v[44:47]
  v_mfma_f32_16x16x32_bf16 v[80:83], v[92:95], v[116:119], v[80:83]
  ds_read_b64_tr_b16 v[88:89], v12 offset:96
  ds_read_b64_tr_b16 v[90:91], v12 offset:4704
  s_waitcnt lgkmcnt(10)
  v_mfma_f32_16x16x32_bf16 v[48:51], v[96:99], v[112:115], v[48:51]
  v_mfma_f32_16x16x32_bf16 v[84:87], v[96:99], v[116:119], v[84:87]
  ds_read_b64_tr_b16 v[92:93], v12 offset:128
  ds_read_b64_tr_b16 v[94:95], v12 offset:4736
  s_waitcnt lgkmcnt(9)
  v_mfma_f32_16x16x32_bf16 v[16:19], v[100:103], v[120:123], v[16:19]
  s_waitcnt lgkmcnt(8)
  v_mfma_f32_16x16x32_bf16 v[52:55], v[100:103], v[124:127], v[52:55]
  ds_read_b64_tr_b16 v[96:97], v12 offset:160
  ds_read_b64_tr_b16 v[98:99], v12 offset:4768
  s_waitcnt lgkmcnt(8)
  v_mfma_f32_16x16x32_bf16 v[20:23], v[104:107], v[120:123], v[20:23]
  v_mfma_f32_16x16x32_bf16 v[56:59], v[104:107], v[124:127], v[56:59]
  ds_read_b64_tr_b16 v[100:101], v12 offset:192
  ds_read_b64_tr_b16 v[102:103], v12 offset:4800
  s_waitcnt lgkmcnt(8)
  v_mfma_f32_16x16x32_bf16 v[24:27], v[108:111], v[120:123], v[24:27]
  v_mfma_f32_16x16x32_bf16 v[60:63], v[108:111], v[124:127], v[60:63]
  ds_read_b64_tr_b16 v[104:105], v12 offset:224
  ds_read_b64_tr_b16 v[106:107], v12 offset:4832
  s_waitcnt lgkmcnt(8)
  v_mfma_f32_16x16x32_bf16 v[28:31], v[88:91], v[120:123], v[28:31]
  v_mfma_f32_16x16x32_bf16 v[64:67], v[88:91], v[124:127], v[64:67]
  ds_read_b64_tr_b16 v[108:109], v12 offset:256
  ds_read_b64_tr_b16 v[110:111], v12 offset:4864
  s_waitcnt lgkmcnt(8)
  v_mfma_f32_16x16x32_bf16 v[32:35], v[92:95], v[120:123], v[32:35]
  v_mfma_f32_16x16x32_bf16 v[68:71], v[92:95], v[124:127], v[68:71]
  s_waitcnt lgkmcnt(6)
  v_mfma_f32_16x16x32_bf16 v[36:39], v[96:99], v[120:123], v[36:39]
  v_mfma_f32_16x16x32_bf16 v[72:75], v[96:99], v[124:127], v[72:75]
  s_waitcnt vmcnt(0) lgkmcnt(0)
  s_barrier
  v_subrev_u32 v11, 0xc000, v11
  v_subrev_u32 v12, 0xd800, v12
  ds_read_b128 v[112:115], v11 offset:0
  ds_read_b64_tr_b16 v[88:89], v12 offset:0
  ds_read_b64_tr_b16 v[90:91], v12 offset:4608
  ds_read_b128 v[116:119], v11 offset:2048
  ds_read_b64_tr_b16 v[92:93], v12 offset:32
  ds_read_b64_tr_b16 v[94:95], v12 offset:4640
  v_mfma_f32_16x16x32_bf16 v[40:43], v[100:103], v[120:123], v[40:43]
  v_mfma_f32_16x16x32_bf16 v[76:79], v[100:103], v[124:127], v[76:79]
  ds_read_b64_tr_b16 v[96:97], v12 offset:64
  ds_read_b64_tr_b16 v[98:99], v12 offset:4672
  v_mfma_f32_16x16x32_bf16 v[44:47], v[104:107], v[120:123], v[44:47]
  v_mfma_f32_16x16x32_bf16 v[80:83], v[104:107], v[124:127], v[80:83]
  ds_read_b64_tr_b16 v[100:101], v12 offset:96
  ds_read_b64_tr_b16 v[102:103], v12 offset:4704
  v_mfma_f32_16x16x32_bf16 v[48:51], v[108:111], v[120:123], v[48:51]
  v_mfma_f32_16x16x32_bf16 v[84:87], v[108:111], v[124:127], v[84:87]
  ds_read_b64_tr_b16 v[104:105], v12 offset:128
  ds_read_b64_tr_b16 v[106:107], v12 offset:4736
  s_waitcnt lgkmcnt(9)
  v_mfma_f32_16x16x32_bf16 v[16:19], v[88:91], v[112:115], v[16:19]
  s_waitcnt lgkmcnt(8)
  v_mfma_f32_16x16x32_bf16 v[52:55], v[88:91], v[116:119], v[52:55]
  ds_read_b64_tr_b16 v[108:109], v12 offset:160
  ds_read_b64_tr_b16 v[110:111], v12 offset:4768
  s_waitcnt lgkmcnt(8)
  v_mfma_f32_16x16x32_bf16 v[20:23], v[92:95], v[112:115], v[20:23]
  v_mfma_f32_16x16x32_bf16 v[56:59], v[92:95], v[116:119], v[56:59]
  ds_read_b64_tr_b16 v[88:89], v12 offset:192
  ds_read_b64_tr_b16 v[90:91], v12 offset:4800
  s_waitcnt lgkmcnt(8)
  v_mfma_f32_16x16x32_bf16 v[24:27], v[96:99], v[112:115], v[24:27]
  v_mfma_f32_16x16x32_bf16 v[60:63], v[96:99], v[116:119], v[60:63]
  ds_read_b64_tr_b16 v[92:93], v12 offset:224
  ds_read_b64_tr_b16 v[94:95], v12 offset:4832
  s_waitcnt lgkmcnt(8)
  v_mfma_f32_16x16x32_bf16 v[28:31], v[100:103], v[112:115], v[28:31]
  v_mfma_f32_16x16x32_bf16 v[64:67], v[100:103], v[116:119], v[64:67]
  ds_read_b64_tr_b16 v[96:97], v12 offset:256
  ds_read_b64_tr_b16 v[98:99], v12 offset:4864
  s_waitcnt lgkmcnt(8)
  v_mfma_f32_16x16x32_bf16 v[32:35], v[104:107], v[112:115], v[32:35]
  v_mfma_f32_16x16x32_bf16 v[68:71], v[104:107], v[116:119], v[68:71]
  s_waitcnt lgkmcnt(6)
  v_mfma_f32_16x16x32_bf16 v[36:39], v[108:111], v[112:115], v[36:39]
  v_mfma_f32_16x16x32_bf16 v[72:75], v[108:111], v[116:119], v[72:75]
  v_add_u32 v11, 0x4000, v11
  v_add_u32 v12, 0x4800, v12
  ds_read_b128 v[120:123], v11 offset:0
  ds_read_b64_tr_b16 v[100:101], v12 offset:0
  ds_read_b64_tr_b16 v[102:103], v12 offset:4608
  ds_read_b128 v[124:127], v11 offset:2048
  ds_read_b64_tr_b16 v[104:105], v12 offset:32
  ds_read_b64_tr_b16 v[106:107], v12 offset:4640
  s_waitcnt lgkmcnt(10)
  v_mfma_f32_16x16x32_bf16 v[40:43], v[88:91], v[112:115], v[40:43]
  v_mfma_f32_16x16x32_bf16 v[76:79], v[88:91], v[116:119], v[76:79]
  ds_read_b64_tr_b16 v[108:109], v12 offset:64
  ds_read_b64_tr_b16 v[110:111], v12 offset:4672
  s_waitcnt lgkmcnt(10)
  v_mfma_f32_16x16x32_bf16 v[44:47], v[92:95], v[112:115], v[44:47]
  v_mfma_f32_16x16x32_bf16 v[80:83], v[92:95], v[116:119], v[80:83]
  ds_read_b64_tr_b16 v[88:89], v12 offset:96
  ds_read_b64_tr_b16 v[90:91], v12 offset:4704
  s_waitcnt lgkmcnt(10)
  v_mfma_f32_16x16x32_bf16 v[48:51], v[96:99], v[112:115], v[48:51]
  v_mfma_f32_16x16x32_bf16 v[84:87], v[96:99], v[116:119], v[84:87]
  ds_read_b64_tr_b16 v[92:93], v12 offset:128
  ds_read_b64_tr_b16 v[94:95], v12 offset:4736
  s_waitcnt lgkmcnt(9)
  v_mfma_f32_16x16x32_bf16 v[16:19], v[100:103], v[120:123], v[16:19]
  s_waitcnt lgkmcnt(8)
  v_mfma_f32_16x16x32_bf16 v[52:55], v[100:103], v[124:127], v[52:55]
  ds_read_b64_tr_b16 v[96:97], v12 offset:160
  ds_read_b64_tr_b16 v[98:99], v12 offset:4768
  s_waitcnt lgkmcnt(8)
  v_mfma_f32_16x16x32_bf16 v[20:23], v[104:107], v[120:123], v[20:23]
  v_mfma_f32_16x16x32_bf16 v[56:59], v[104:107], v[124:127], v[56:59]
  ds_read_b64_tr_b16 v[100:101], v12 offset:192
  ds_read_b64_tr_b16 v[102:103], v12 offset:4800
  s_waitcnt lgkmcnt(8)
  v_mfma_f32_16x16x32_bf16 v[24:27], v[108:111], v[120:123], v[24:27]
  v_mfma_f32_16x16x32_bf16 v[60:63], v[108:111], v[124:127], v[60:63]
  ds_read_b64_tr_b16 v[104:105], v12 offset:224
  ds_read_b64_tr_b16 v[106:107], v12 offset:4832
  s_waitcnt lgkmcnt(8)
  v_mfma_f32_16x16x32_bf16 v[28:31], v[88:91], v[120:123], v[28:31]
  v_mfma_f32_16x16x32_bf16 v[64:67], v[88:91], v[124:127], v[64:67]
  ds_read_b64_tr_b16 v[108:109], v12 offset:256
  ds_read_b64_tr_b16 v[110:111], v12 offset:4864
  s_waitcnt lgkmcnt(8)
  v_mfma_f32_16x16x32_bf16 v[32:35], v[92:95], v[120:123], v[32:35]
  v_mfma_f32_16x16x32_bf16 v[68:71], v[92:95], v[124:127], v[68:71]
  s_waitcnt lgkmcnt(6)
  v_mfma_f32_16x16x32_bf16 v[36:39], v[96:99], v[120:123], v[36:39]
  v_mfma_f32_16x16x32_bf16 v[72:75], v[96:99], v[124:127], v[72:75]
  s_waitcnt lgkmcnt(4)
  v_mfma_f32_16x16x32_bf16 v[40:43], v[100:103], v[120:123], v[40:43]
  v_mfma_f32_16x16x32_bf16 v[76:79], v[100:103], v[124:127], v[76:79]
  s_waitcnt lgkmcnt(2)
  v_mfma_f32_16x16x32_bf16 v[44:47], v[104:107], v[120:123], v[44:47]
  v_mfma_f32_16x16x32_bf16 v[80:83], v[104:107], v[124:127], v[80:83]
  s_waitcnt lgkmcnt(0)
  v_mfma_f32_16x16x32_bf16 v[48:51], v[108:111], v[120:123], v[48:51]
  v_mfma_f32_16x16x32_bf16 v[84:87], v[108:111], v[124:127], v[84:87]
  s_nop 15
  s_barrier
  s_mul_i32 s28, s20, 9216
  v_lshlrev_b32 v2, 4, v1
  v_add_u32 v3, s28, v2
  s_xor_b32 s28, s20, 4
  s_mul_i32 s28, s28, 9216
  v_add_u32 v4, s28, v2
  s_cmp_eq_u32 s25, 0
  s_cbranch_scc0 ffn2_kernel_kg12
  ds_write_b128 v3, v[52:55] offset:0
  ds_write_b128 v3, v[56:59] offset:1024
  ds_write_b128 v3, v[60:63] offset:2048
  ds_write_b128 v3, v[64:67] offset:3072
  ds_write_b128 v3, v[68:71] offset:4096
  ds_write_b128 v3, v[72:75] offset:5120
  ds_write_b128 v3, v[76:79] offset:6144
  ds_write_b128 v3, v[80:83] offset:7168
  ds_write_b128 v3, v[84:87] offset:8192
  s_waitcnt lgkmcnt(0)
  s_barrier
  ds_read_b128 v[88:91], v4 offset:0
  ds_read_b128 v[92:95], v4 offset:1024
  ds_read_b128 v[96:99], v4 offset:2048
  ds_read_b128 v[100:103], v4 offset:3072
  ds_read_b128 v[104:107], v4 offset:4096
  ds_read_b128 v[108:111], v4 offset:5120
  ds_read_b128 v[112:115], v4 offset:6144
  ds_read_b128 v[116:119], v4 offset:7168
  ds_read_b128 v[120:123], v4 offset:8192
  s_waitcnt lgkmcnt(8)
  v_add_f32 v16, v16, v88
  v_add_f32 v17, v17, v89
  v_add_f32 v18, v18, v90
  v_add_f32 v19, v19, v91
  s_waitcnt lgkmcnt(7)
  v_add_f32 v20, v20, v92
  v_add_f32 v21, v21, v93
  v_add_f32 v22, v22, v94
  v_add_f32 v23, v23, v95
  s_waitcnt lgkmcnt(6)
  v_add_f32 v24, v24, v96
  v_add_f32 v25, v25, v97
  v_add_f32 v26, v26, v98
  v_add_f32 v27, v27, v99
  s_waitcnt lgkmcnt(5)
  v_add_f32 v28, v28, v100
  v_add_f32 v29, v29, v101
  v_add_f32 v30, v30, v102
  v_add_f32 v31, v31, v103
  s_waitcnt lgkmcnt(4)
  v_add_f32 v32, v32, v104
  v_add_f32 v33, v33, v105
  v_add_f32 v34, v34, v106
  v_add_f32 v35, v35, v107
  s_waitcnt lgkmcnt(3)
  v_add_f32 v36, v36, v108
  v_add_f32 v37, v37, v109
  v_add_f32 v38, v38, v110
  v_add_f32 v39, v39, v111
  s_waitcnt lgkmcnt(2)
  v_add_f32 v40, v40, v112
  v_add_f32 v41, v41, v113
  v_add_f32 v42, v42, v114
  v_add_f32 v43, v43, v115
  s_waitcnt lgkmcnt(1)
  v_add_f32 v44, v44, v116
  v_add_f32 v45, v45, v117
  v_add_f32 v46, v46, v118
  v_add_f32 v47, v47, v119
  s_waitcnt lgkmcnt(0)
  v_add_f32 v48, v48, v120
  v_add_f32 v49, v49, v121
  v_add_f32 v50, v50, v122
  v_add_f32 v51, v51, v123
  v_and_b32 v2, 15, v1
  v_mul_u32_u24 v2, 2304, v2
  v_lshl_add_u32 v2, v10, 4, v2
  s_mul_i32 s28, s24, 73728
  v_add_u32 v2, s28, v2
  s_mov_b32 s28, 0x0
  buffer_store_dwordx4 v[16:19], v2, s[12:15], s28 offen offset:0 sc1
  buffer_store_dwordx4 v[20:23], v2, s[12:15], s28 offen offset:64 sc1
  buffer_store_dwordx4 v[24:27], v2, s[12:15], s28 offen offset:128 sc1
  buffer_store_dwordx4 v[28:31], v2, s[12:15], s28 offen offset:192 sc1
  buffer_store_dwordx4 v[32:35], v2, s[12:15], s28 offen offset:256 sc1
  buffer_store_dwordx4 v[36:39], v2, s[12:15], s28 offen offset:320 sc1
  buffer_store_dwordx4 v[40:43], v2, s[12:15], s28 offen offset:384 sc1
  buffer_store_dwordx4 v[44:47], v2, s[12:15], s28 offen offset:448 sc1
  buffer_store_dwordx4 v[48:51], v2, s[12:15], s28 offen offset:512 sc1
  s_branch ffn2_kernel_end_d
ffn2_kernel_kg12:
  ds_write_b128 v3, v[16:19] offset:0
  ds_write_b128 v3, v[20:23] offset:1024
  ds_write_b128 v3, v[24:27] offset:2048
  ds_write_b128 v3, v[28:31] offset:3072
  ds_write_b128 v3, v[32:35] offset:4096
  ds_write_b128 v3, v[36:39] offset:5120
  ds_write_b128 v3, v[40:43] offset:6144
  ds_write_b128 v3, v[44:47] offset:7168
  ds_write_b128 v3, v[48:51] offset:8192
  s_waitcnt lgkmcnt(0)
  s_barrier
  ds_read_b128 v[88:91], v4 offset:0
  ds_read_b128 v[92:95], v4 offset:1024
  ds_read_b128 v[96:99], v4 offset:2048
  ds_read_b128 v[100:103], v4 offset:3072
  ds_read_b128 v[104:107], v4 offset:4096
  ds_read_b128 v[108:111], v4 offset:5120
  ds_read_b128 v[112:115], v4 offset:6144
  ds_read_b128 v[116:119], v4 offset:7168
  ds_read_b128 v[120:123], v4 offset:8192
  s_waitcnt lgkmcnt(8)
  v_add_f32 v52, v52, v88
  v_add_f32 v53, v53, v89
  v_add_f32 v54, v54, v90
  v_add_f32 v55, v55, v91
  s_waitcnt lgkmcnt(7)
  v_add_f32 v56, v56, v92
  v_add_f32 v57, v57, v93
  v_add_f32 v58, v58, v94
  v_add_f32 v59, v59, v95
  s_waitcnt lgkmcnt(6)
  v_add_f32 v60, v60, v96
  v_add_f32 v61, v61, v97
  v_add_f32 v62, v62, v98
  v_add_f32 v63, v63, v99
  s_waitcnt lgkmcnt(5)
  v_add_f32 v64, v64, v100
  v_add_f32 v65, v65, v101
  v_add_f32 v66, v66, v102
  v_add_f32 v67, v67, v103
  s_waitcnt lgkmcnt(4)
  v_add_f32 v68, v68, v104
  v_add_f32 v69, v69, v105
  v_add_f32 v70, v70, v106
  v_add_f32 v71, v71, v107
  s_waitcnt lgkmcnt(3)
  v_add_f32 v72, v72, v108
  v_add_f32 v73, v73, v109
  v_add_f32 v74, v74, v110
  v_add_f32 v75, v75, v111
  s_waitcnt lgkmcnt(2)
  v_add_f32 v76, v76, v112
  v_add_f32 v77, v77, v113
  v_add_f32 v78, v78, v114
  v_add_f32 v79, v79, v115
  s_waitcnt lgkmcnt(1)
  v_add_f32 v80, v80, v116
  v_add_f32 v81, v81, v117
  v_add_f32 v82, v82, v118
  v_add_f32 v83, v83, v119
  s_waitcnt lgkmcnt(0)
  v_add_f32 v84, v84, v120
  v_add_f32 v85, v85, v121
  v_add_f32 v86, v86, v122
  v_add_f32 v87, v87, v123
  v_and_b32 v2, 15, v1
  v_mul_u32_u24 v2, 2304, v2
  v_lshl_add_u32 v2, v10, 4, v2
  s_mul_i32 s28, s24, 73728
  v_add_u32 v2, s28, v2
  s_mov_b32 s28, 0x9000
  buffer_store_dwordx4 v[52:55], v2, s[12:15], s28 offen offset:0 sc1
  buffer_store_dwordx4 v[56:59], v2, s[12:15], s28 offen offset:64 sc1
  buffer_store_dwordx4 v[60:63], v2, s[12:15], s28 offen offset:128 sc1
  buffer_store_dwordx4 v[64:67], v2, s[12:15], s28 offen offset:192 sc1
  buffer_store_dwordx4 v[68:71], v2, s[12:15], s28 offen offset:256 sc1
  buffer_store_dwordx4 v[72:75], v2, s[12:15], s28 offen offset:320 sc1
  buffer_store_dwordx4 v[76:79], v2, s[12:15], s28 offen offset:384 sc1
  buffer_store_dwordx4 v[80:83], v2, s[12:15], s28 offen offset:448 sc1
  buffer_store_dwordx4 v[84:87], v2, s[12:15], s28 offen offset:512 sc1
ffn2_kernel_end_d:
ffn2_kernel_end:
  s_endpgm
.globl red2_kernel
.p2align 8
.type red2_kernel,@function
red2_kernel:
  s_cmp_ge_u32 s2, 256
  s_cbranch_scc1 red2_kernel_end
  v_lshrrev_b32 v3, 6, v0
  s_load_dwordx2 s[40:41], s[0:1], 104
  s_load_dwordx2 s[42:43], s[0:1], 0
  s_load_dwordx2 s[44:45], s[0:1], 80
  s_load_dwordx2 s[36:37], s[0:1], 88
  v_readfirstlane_b32 s20, v3
  s_lshl_b32 s21, s2, 3
  s_add_u32 s21, s21, s20
  s_mul_i32 s22, s21, 1152
  s_mul_i32 s23, s21, 2304
  v_and_b32 v1, 63, v0
  v_lshlrev_b32 v2, 3, v1
  v_lshlrev_b32 v1, 4, v1
  v_cmp_gt_u32 vcc, 384, v2
  s_mov_b64 s[46:47], vcc
  s_waitcnt lgkmcnt(0)
  s_sub_u32 s24, 18874368, s23
  s_add_u32 s4, s40, 0x6cc0000
  s_addc_u32 s5, s41, 0
  s_add_u32 s4, s4, s23
  s_addc_u32 s5, s5, 0
  s_mov_b32 s6, s24
  s_mov_b32 s7, 0x00020000
  s_add_u32 s8, s40, 0x5640000
  s_addc_u32 s9, s41, 0
  s_add_u32 s8, s8, s22
  s_addc_u32 s9, s9, 0
  s_mov_b32 s10, 0x480
  s_mov_b32 s11, 0x00020000
  s_mov_b32 s12, s36
  s_mov_b32 s13, s37
  s_add_u32 s12, s12, s22
  s_addc_u32 s13, s13, 0
  s_mov_b32 s14, 0x480
  s_mov_b32 s15, 0x00020000
  s_mov_b32 s16, s44
  s_mov_b32 s17, s45
  s_mov_b32 s18, 0x480
  s_mov_b32 s19, 0x00020000
  s_mov_b64 exec, s[46:47]
  s_mov_b32 s25, 0x0
  buffer_load_dwordx4 v[4:7], v1, s[4:7], s25 offen offset:0
  buffer_load_dwordx4 v[8:11], v1, s[4:7], s25 offen offset:768
  buffer_load_dwordx4 v[12:15], v1, s[4:7], s25 offen offset:1536
  s_mov_b32 s25, 0x480000
  buffer_load_dwordx4 v[16:19], v1, s[4:7], s25 offen offset:0
  buffer_load_dwordx4 v[20:23], v1, s[4:7], s25 offen offset:768
  buffer_load_dwordx4 v[24:27], v1, s[4:7], s25 offen offset:1536
  s_mov_b32 s25, 0x900000
  buffer_load_dwordx4 v[28:31], v1, s[4:7], s25 offen offset:0
  buffer_load_dwordx4 v[32:35], v1, s[4:7], s25 offen offset:768
  buffer_load_dwordx4 v[36:39], v1, s[4:7], s25 offen offset:1536
  s_mov_b32 s25, 0xd80000
  buffer_load_dwordx4 v[40:43], v1, s[4:7], s25 offen offset:0
  buffer_load_dwordx4 v[44:47], v1, s[4:7], s25 offen offset:768
  buffer_load_dwordx4 v[48:51], v1, s[4:7], s25 offen offset:1536
  buffer_load_dwordx2 v[52:53], v2, s[8:11], 0 offen offset:0
  buffer_load_dwordx2 v[54:55], v2, s[8:11], 0 offen offset:384
  buffer_load_dwordx2 v[56:57], v2, s[8:11], 0 offen offset:768
  buffer_load_dwordx2 v[58:59], v2, s[16:19], 0 offen offset:0
  buffer_load_dwordx2 v[60:61], v2, s[16:19], 0 offen offset:384
  buffer_load_dwordx2 v[62:63], v2, s[16:19], 0 offen offset:768
  s_waitcnt vmcnt(12)
  v_add_f32 v4, v4, v16
  v_add_f32 v5, v5, v17
  v_add_f32 v6, v6, v18
  v_add_f32 v7, v7, v19
  v_add_f32 v8, v8, v20
  v_add_f32 v9, v9, v21
  v_add_f32 v10, v10, v22
  v_add_f32 v11, v11, v23
  v_add_f32 v12, v12, v24
  v_add_f32 v13, v13, v25
  v_add_f32 v14, v14, v26
  v_add_f32 v15, v15, v27
  s_waitcnt vmcnt(9)
  v_add_f32 v4, v4, v28
  v_add_f32 v5, v5, v29
  v_add_f32 v6, v6, v30
  v_add_f32 v7, v7, v31
  v_add_f32 v8, v8, v32
  v_add_f32 v9, v9, v33
  v_add_f32 v10, v10, v34
  v_add_f32 v11, v11, v35
  v_add_f32 v12, v12, v36
  v_add_f32 v13, v13, v37
  v_add_f32 v14, v14, v38
  v_add_f32 v15, v15, v39
  s_waitcnt vmcnt(6)
  v_add_f32 v4, v4, v40
  v_add_f32 v5, v5, v41
  v_add_f32 v6, v6, v42
  v_add_f32 v7, v7, v43
  v_add_f32 v8, v8, v44
  v_add_f32 v9, v9, v45
  v_add_f32 v10, v10, v46
  v_add_f32 v11, v11, v47
  v_add_f32 v12, v12, v48
  v_add_f32 v13, v13, v49
  v_add_f32 v14, v14, v50
  v_add_f32 v15, v15, v51
  s_waitcnt vmcnt(0)
  v_cvt_pk_bf16_f32 v4, v4, v4
  v_and_b32 v4, 0xffff0000, v4
  v_cvt_pk_bf16_f32 v5, v5, v5
  v_and_b32 v5, 0xffff0000, v5
  v_lshlrev_b32 v64, 16, v58
  v_and_b32 v65, 0xffff0000, v58
  v_add_f32 v4, v4, v64
  v_add_f32 v5, v5, v65
  v_cvt_pk_bf16_f32 v4, v4, v4
  v_and_b32 v4, 0xffff0000, v4
  v_cvt_pk_bf16_f32 v5, v5, v5
  v_and_b32 v5, 0xffff0000, v5
  v_lshlrev_b32 v64, 16, v52
  v_and_b32 v65, 0xffff0000, v52
  v_add_f32 v4, v4, v64
  v_add_f32 v5, v5, v65
  v_cvt_pk_bf16_f32 v52, v4, v5
  v_cvt_pk_bf16_f32 v6, v6, v6
  v_and_b32 v6, 0xffff0000, v6
  v_cvt_pk_bf16_f32 v7, v7, v7
  v_and_b32 v7, 0xffff0000, v7
  v_lshlrev_b32 v64, 16, v59
  v_and_b32 v65, 0xffff0000, v59
  v_add_f32 v6, v6, v64
  v_add_f32 v7, v7, v65
  v_cvt_pk_bf16_f32 v6, v6, v6
  v_and_b32 v6, 0xffff0000, v6
  v_cvt_pk_bf16_f32 v7, v7, v7
  v_and_b32 v7, 0xffff0000, v7
  v_lshlrev_b32 v64, 16, v53
  v_and_b32 v65, 0xffff0000, v53
  v_add_f32 v6, v6, v64
  v_add_f32 v7, v7, v65
  v_cvt_pk_bf16_f32 v53, v6, v7
  v_cvt_pk_bf16_f32 v8, v8, v8
  v_and_b32 v8, 0xffff0000, v8
  v_cvt_pk_bf16_f32 v9, v9, v9
  v_and_b32 v9, 0xffff0000, v9
  v_lshlrev_b32 v64, 16, v60
  v_and_b32 v65, 0xffff0000, v60
  v_add_f32 v8, v8, v64
  v_add_f32 v9, v9, v65
  v_cvt_pk_bf16_f32 v8, v8, v8
  v_and_b32 v8, 0xffff0000, v8
  v_cvt_pk_bf16_f32 v9, v9, v9
  v_and_b32 v9, 0xffff0000, v9
  v_lshlrev_b32 v64, 16, v54
  v_and_b32 v65, 0xffff0000, v54
  v_add_f32 v8, v8, v64
  v_add_f32 v9, v9, v65
  v_cvt_pk_bf16_f32 v54, v8, v9
  v_cvt_pk_bf16_f32 v10, v10, v10
  v_and_b32 v10, 0xffff0000, v10
  v_cvt_pk_bf16_f32 v11, v11, v11
  v_and_b32 v11, 0xffff0000, v11
  v_lshlrev_b32 v64, 16, v61
  v_and_b32 v65, 0xffff0000, v61
  v_add_f32 v10, v10, v64
  v_add_f32 v11, v11, v65
  v_cvt_pk_bf16_f32 v10, v10, v10
  v_and_b32 v10, 0xffff0000, v10
  v_cvt_pk_bf16_f32 v11, v11, v11
  v_and_b32 v11, 0xffff0000, v11
  v_lshlrev_b32 v64, 16, v55
  v_and_b32 v65, 0xffff0000, v55
  v_add_f32 v10, v10, v64
  v_add_f32 v11, v11, v65
  v_cvt_pk_bf16_f32 v55, v10, v11
  v_cvt_pk_bf16_f32 v12, v12, v12
  v_and_b32 v12, 0xffff0000, v12
  v_cvt_pk_bf16_f32 v13, v13, v13
  v_and_b32 v13, 0xffff0000, v13
  v_lshlrev_b32 v64, 16, v62
  v_and_b32 v65, 0xffff0000, v62
  v_add_f32 v12, v12, v64
  v_add_f32 v13, v13, v65
  v_cvt_pk_bf16_f32 v12, v12, v12
  v_and_b32 v12, 0xffff0000, v12
  v_cvt_pk_bf16_f32 v13, v13, v13
  v_and_b32 v13, 0xffff0000, v13
  v_lshlrev_b32 v64, 16, v56
  v_and_b32 v65, 0xffff0000, v56
  v_add_f32 v12, v12, v64
  v_add_f32 v13, v13, v65
  v_cvt_pk_bf16_f32 v56, v12, v13
  v_cvt_pk_bf16_f32 v14, v14, v14
  v_and_b32 v14, 0xffff0000, v14
  v_cvt_pk_bf16_f32 v15, v15, v15
  v_and_b32 v15, 0xffff0000, v15
  v_lshlrev_b32 v64, 16, v63
  v_and_b32 v65, 0xffff0000, v63
  v_add_f32 v14, v14, v64
  v_add_f32 v15, v15, v65
  v_cvt_pk_bf16_f32 v14, v14, v14
  v_and_b32 v14, 0xffff0000, v14
  v_cvt_pk_bf16_f32 v15, v15, v15
  v_and_b32 v15, 0xffff0000, v15
  v_lshlrev_b32 v64, 16, v57
  v_and_b32 v65, 0xffff0000, v57
  v_add_f32 v14, v14, v64
  v_add_f32 v15, v15, v65
  v_cvt_pk_bf16_f32 v57, v14, v15
  buffer_store_dwordx2 v[52:53], v2, s[12:15], 0 offen offset:0 sc1
  buffer_store_dwordx2 v[54:55], v2, s[12:15], 0 offen offset:384 sc1
  buffer_store_dwordx2 v[56:57], v2, s[12:15], 0 offen offset:768 sc1
red2_kernel_end:
  s_endpgm
.section .rodata,"a"
.p2align 6
.amdhsa_kernel kvproj_kernel
  .amdhsa_next_free_vgpr 208
  .amdhsa_next_free_sgpr 58
  .amdhsa_accum_offset 208
  .amdhsa_group_segment_fixed_size 0
  .amdhsa_kernarg_size 112
  .amdhsa_user_sgpr_count 2
  .amdhsa_user_sgpr_kernarg_segment_ptr 1
  .amdhsa_system_sgpr_workgroup_id_x 1
.end_amdhsa_kernel
.p2align 6
.amdhsa_kernel attn_kernel
  .amdhsa_next_free_vgpr 256
  .amdhsa_next_free_sgpr 56
  .amdhsa_accum_offset 256
  .amdhsa_group_segment_fixed_size 0
  .amdhsa_kernarg_size 112
  .amdhsa_user_sgpr_count 2
  .amdhsa_user_sgpr_kernarg_segment_ptr 1
  .amdhsa_system_sgpr_workgroup_id_x 1
.end_amdhsa_kernel
.p2align 6
.amdhsa_kernel oproj_kernel
  .amdhsa_next_free_vgpr 128
  .amdhsa_next_free_sgpr 52
  .amdhsa_accum_offset 128
  .amdhsa_group_segment_fixed_size 0
  .amdhsa_kernarg_size 112
  .amdhsa_user_sgpr_count 2
  .amdhsa_user_sgpr_kernarg_segment_ptr 1
  .amdhsa_system_sgpr_workgroup_id_x 1
.end_amdhsa_kernel
.p2align 6
.amdhsa_kernel red1_kernel
  .amdhsa_next_free_vgpr 78
  .amdhsa_next_free_sgpr 48
  .amdhsa_accum_offset 80
  .amdhsa_group_segment_fixed_size 0
  .amdhsa_kernarg_size 112
  .amdhsa_user_sgpr_count 2
  .amdhsa_user_sgpr_kernarg_segment_ptr 1
  .amdhsa_system_sgpr_workgroup_id_x 1
.end_amdhsa_kernel
.p2align 6
.amdhsa_kernel ffn1_kernel
  .amdhsa_next_free_vgpr 152
  .amdhsa_next_free_sgpr 52
  .amdhsa_accum_offset 152
  .amdhsa_group_segment_fixed_size 0
  .amdhsa_kernarg_size 112
  .amdhsa_user_sgpr_count 2
  .amdhsa_user_sgpr_kernarg_segment_ptr 1
  .amdhsa_system_sgpr_workgroup_id_x 1
.end_amdhsa_kernel
.p2align 6
.amdhsa_kernel ffn2_kernel
  .amdhsa_next_free_vgpr 128
  .amdhsa_next_free_sgpr 52
  .amdhsa_accum_offset 128
  .amdhsa_group_segment_fixed_size 0
  .amdhsa_kernarg_size 112
  .amdhsa_user_sgpr_count 2
  .amdhsa_user_sgpr_kernarg_segment_ptr 1
  .amdhsa_system_sgpr_workgroup_id_x 1
.end_amdhsa_kernel
.p2align 6
.amdhsa_kernel red2_kernel
  .amdhsa_next_free_vgpr 66
  .amdhsa_next_free_sgpr 48
  .amdhsa_accum_offset 68
  .amdhsa_group_segment_fixed_size 0
  .amdhsa_kernarg_size 112
  .amdhsa_user_sgpr_count 2
  .amdhsa_user_sgpr_kernarg_segment_ptr 1
  .amdhsa_system_sgpr_workgroup_id_x 1
.end_amdhsa_kernel
```
